```python
import torch

def _softmax(x, axis=-1):
    return torch.softmax(x, dim=axis)
def _gelu(x):
    return torch.nn.functional.gelu(x, approximate="tanh")
def _silu(x):
    return torch.nn.functional.silu(x)
def _sigmoid(x):
    return torch.sigmoid(x)
def _layernorm(x, axis=-1, eps=1e-5):
    m = x.mean(dim=axis, keepdim=True)
    v = x.var(dim=axis, keepdim=True, unbiased=False)
    return (x - m) / torch.sqrt(v + eps)
def _scatter_add(tgt, idx, src, axis=0):
    return tgt.clone().index_add_(axis, idx, src)
def _segment_sum(src, seg, n):
    out = torch.zeros((n,) + src.shape[1:], dtype=src.dtype)
    return out.index_add_(0, seg, src)
def _pad(x, pw):
    flat = tuple(v for pair in reversed(pw) for v in pair)
    return torch.nn.functional.pad(x, flat)

kernel_name = 'interleave_layers__sliding_local_dilated__glu_gated_reglu__prompt'

def setup_inputs():

    _w = (lambda a: (lambda t: t.to(torch.bfloat16) if t.is_floating_point() else t)(torch.as_tensor(a)))
    def _A_setup():
        B, S, D = 1, 2048, 512
        return {
            "x": _w((lambda *s: torch.randn(*s, dtype=torch.bfloat16) * 0.05)(B, S, D)),
            "wqkv": _w((lambda *s: torch.randn(*s, dtype=torch.bfloat16) * 0.05)(D, 3 * D)),
            "wo": _w((lambda *s: torch.randn(*s, dtype=torch.bfloat16) * 0.05)(D, D)),
        }
    _A_in = _A_setup()

    def _B_setup():
        B, S, D, F = 1, 2048, 512, 1792
        return {
            "x": _w((lambda *s: torch.randn(*s, dtype=torch.bfloat16) * 0.05)(B, S, D)),
            "W_gate": _w((lambda *s: torch.randn(*s, dtype=torch.bfloat16) * 0.8)(D, F) * (2.0 / D) ** 0.5),
            "W_up": _w((lambda *s: torch.randn(*s, dtype=torch.bfloat16) * 0.8)(D, F) * (2.0 / D) ** 0.5),
            "W_down": _w((lambda *s: torch.randn(*s, dtype=torch.bfloat16) * 0.8)(F, D) * (1.0 / F) ** 0.5),
        }
    _B_in = _B_setup()

    return {
        "A_x": _A_in["x"],
        "A_wqkv": _A_in["wqkv"],
        "A_wo": _A_in["wo"],
        "B_x": _B_in["x"],
        "B_W_gate": _B_in["W_gate"],
        "B_W_up": _B_in["W_up"],
        "B_W_down": _B_in["W_down"],
    }

def reference(A_x, A_wqkv, A_wo, B_x, B_W_gate, B_W_up, B_W_down):
    def _A_ref(x, wqkv, wo):
        B, S, D = x.shape
        H = 32; Dh = D // H
        W, dil = 8, 2
        qkv = (lambda x, *d: x.permute(*d))((x @ wqkv).reshape(B, S, 3, H, Dh), 2, 0, 3, 1, 4)
        q, k, v = qkv[0], qkv[1], qkv[2]
        scale = Dh ** -0.5
        pos = torch.arange(S)
        off = torch.arange(W) * dil
        idx = pos[:, None] - off[None, :]
        mask = idx >= 0
        idx_c = torch.where(mask, idx, 0).reshape(-1)
        kg = k[:, :, idx_c, :].reshape(B, H, S, W, Dh)
        vg = v[:, :, idx_c, :].reshape(B, H, S, W, Dh)
        logits = torch.einsum("bhsd,bhswd->bhsw", q, kg) * scale
        logits = torch.where(mask[None, None, :, :], logits, -1e9)
        attn = _softmax(logits, axis=-1)
        o = torch.einsum("bhsw,bhswd->bhsd", attn, vg)
        return (lambda x, *d: x.permute(*d))(o, 0, 2, 1, 3).reshape(B, S, D) @ wo

    def _B_ref(x, W_gate, W_up, W_down):
        gate = torch.einsum("bsd,df->bsf", x, W_gate)
        up = torch.einsum("bsd,df->bsf", x, W_up)
        gate = gate * (lambda x, dt: x.to(dt))(gate > 0, gate.dtype)
        h = gate * up
        return torch.einsum("bsf,fd->bsd", h, W_down)

    x = A_x
    x = x + _A_ref(_layernorm(x, axis=-1), A_wqkv, A_wo)
    x = x + _B_ref(_layernorm(x, axis=-1), B_W_gate, B_W_up, B_W_down)
    x = x + _A_ref(_layernorm(x, axis=-1), A_wqkv, A_wo)
    x = x + _B_ref(_layernorm(x, axis=-1), B_W_gate, B_W_up, B_W_down)
    return x
```

```asm
; @launch grid=(256,1,1) block=(256,1,1) lds=163840
.amdgcn_target "amdgcn-amd-amdhsa--gfx950"
.text
.globl interleave_layers__sliding_local_dilated__glu_gated_reglu__prompt_kernel
.p2align 12
.p2align 8
.type interleave_layers__sliding_local_dilated__glu_gated_reglu__prompt_kernel,@function
interleave_layers__sliding_local_dilated__glu_gated_reglu__prompt_kernel:
    s_cmp_ge_u32 s2, 256
    s_cbranch_scc1 L_main_done
    s_load_dwordx16 s[64:79], s[0:1], 0
    s_load_dwordx2 s[4:5], s[0:1], 72
    s_getpc_b64 s[56:57]
L_pc:
    s_lshr_b32 s58, s2, 3
    s_lshl_b32 s58, s58, 11
    v_lshrrev_b32 v16, 6, v0
    v_lshrrev_b32 v17, 4, v0
    v_lshlrev_b32 v17, 7, v17
    v_add_u32 v17, s58, v17
    v_min_u32 v17, L_code_end-L_pc-4, v17
    v_and_b32 v0, 63, v0
    v_readfirstlane_b32 s20, v16
    global_load_dword a255, v17, s[56:57]
    s_and_b32 s25, s2, 7
    s_bfe_u32 s21, s2, 0x40003
    s_lshr_b32 s53, s2, 7
    s_lshr_b32 s22, s21, 3
    s_and_b32 s23, s21, 7
    v_and_b32 v224, 7, v0
    v_lshrrev_b32 v225, 3, v0
    v_and_b32 v226, 15, v0
    v_lshrrev_b32 v227, 4, v0
    v_lshlrev_b32 v230, 4, v224
    s_lshl_b32 s31, s25, 1
    s_add_u32 s31, s31, s22
    s_lshl_b32 s31, s31, 2
    s_add_u32 s31, s31, s20
    s_lshl_b32 s31, s31, 5
    s_add_u32 s31, s31, s53
    s_lshl_b32 s31, s31, 3
    s_add_u32 s31, s31, s23
    s_lshl_b32 s31, s31, 7
    v_and_b32 v236, 14, v0
    v_lshlrev_b32 v236, 11, v236
    v_lshl_add_u32 v236, v227, 4, v236
    v_and_b32 v231, 1, v0
    v_lshlrev_b32 v231, 6, v231
    v_add3_u32 v236, s31, v236, v231
    s_lshl_b32 s97, s20, 12
    s_cmp_lg_u32 s53, 0
    s_cbranch_scc1 L_follow
    s_mul_hi_u32 s33, s2, 0xaaaaaab
    s_mul_i32 s62, s33, 24
    s_sub_u32 s32, s2, s62
    s_sub_u32 s60, s21, 12
    s_cmp_lt_u32 s2, 96
    s_cselect_b32 s32, s32, s25
    s_cselect_b32 s33, s33, s60
    s_cselect_b32 s34, 3, 1
    s_lshl_b32 s34, s34, 10
    v_mad_u32_u24 v235, v225, s34, v230
    s_lshl_b32 s35, s33, 2
    s_add_u32 s35, s35, s20
    s_lshl_b32 s35, s35, 5
    s_mul_i32 s35, s35, s34
    s_lshl_b32 s61, s32, 7
    s_add_u32 s35, s35, s61
    s_lshl_b32 s36, s34, 3
    s_sub_u32 s36, s36, 1024
    s_lshl_b32 s82, s34, 9
    s_mov_b32 s83, 0x20000
    s_cmp_lt_u32 s2, 96
    s_waitcnt lgkmcnt(0)
    s_load_dword s26, s[4:5], 0
    s_cselect_b32 s80, s66, s68
    s_cselect_b32 s81, s67, s69
    s_and_b32 s81, s81, 0xffff
    s_add_u32 m0, s97, 114688
    s_nop 0
    buffer_load_dwordx4 v235, s[80:83], s35 offen offset:0 lds
    s_add_u32 s60, s35, s36
    buffer_load_dwordx4 v235, s[80:83], s60 offen offset:1024 lds
    s_add_u32 s60, s60, s36
    buffer_load_dwordx4 v235, s[80:83], s60 offen offset:2048 lds
    s_add_u32 s60, s60, s36
    buffer_load_dwordx4 v235, s[80:83], s60 offen offset:3072 lds
    s_mov_b32 s12, s64
    s_and_b32 s13, s65, 0xffff
    s_mov_b32 s14, 2097152
    s_mov_b32 s15, 0x20000
    buffer_load_dwordx4 v[32:35], v236, s[12:15], 0 offen
    buffer_load_dwordx4 v[36:39], v236, s[12:15], 0 offen offset:2048
    s_mov_b32 s8, s4
    s_and_b32 s9, s5, 0xffff
    s_mov_b32 s10, 27262976
    s_mov_b32 s11, 0x20000
    s_lshl_b32 s24, s25, 1
    s_add_u32 s24, s24, s53
    s_lshl_b32 s28, s24, 20
    s_add_u32 s28, s28, 0xa00000
    s_mul_i32 s62, s24, 256
    s_add_u32 s44, 4096, s62
    s_mul_i32 s62, s21, 16
    s_add_u32 s45, s44, s62
    s_mul_i32 s62, s20, 4
    s_add_u32 s45, s45, s62
    s_mul_i32 s62, s22, 4096
    s_add_u32 s59, s28, s62
    s_mul_i32 s62, s20, 1024
    s_add_u32 s59, s59, s62
    s_mul_i32 s62, s23, 128
    s_add_u32 s59, s59, s62
    s_and_b32 s60, s23, 1
    s_mul_i32 s62, s60, -120
    s_add_u32 s49, s59, s62
    s_add_u32 s59, s59, 720896
    v_cmp_gt_u32 vcc, 32, v0
    v_mov_b32 v231, s59
    v_mov_b32 v241, s45
    v_cndmask_b32 v241, v231, v241, vcc
    buffer_load_dword a255, v241, s[8:11], 0 offen sc1
    s_mov_b32 s16, s78
    s_and_b32 s17, s79, 0xffff
    s_mov_b32 s18, 2097152
    s_mov_b32 s19, 0x20000
    v_accvgpr_write_b32 a224, v236
    v_lshlrev_b32 v1, 4, v0
    v_lshlrev_b32 v6, 2, v0
    v_bfe_u32 v232, v0, 2, 2
    v_and_b32 v233, 3, v0
    v_bfe_u32 v234, v0, 4, 1
    v_lshrrev_b32 v228, 5, v0
    s_mul_i32 s62, s24, 2048
    s_add_u32 s60, 147456, s62
    v_lshrrev_b32 v241, 2, v0
    v_lshl_add_u32 v241, v241, 7, s60
    v_lshl_add_u32 v244, v228, 30, v6
    s_mul_i32 s62, s21, 128
    s_add_u32 s60, s60, s62
    s_cmp_eq_u32 s20, 0
    s_cselect_b32 s60, s60, 0x40000000
    s_getreg_b32 s61, hwreg(HW_REG_XCC_ID, 0, 4)
    s_waitcnt lgkmcnt(0)
    s_add_u32 s26, s26, 0x9e3779b1
    s_xor_b32 s61, s61, s26
    v_mov_b32 v242, s61
    buffer_store_dword v242, v244, s[8:11], s60 offen sc1
    v_lshl_add_u32 v230, v227, 3, v232
    v_lshlrev_b32 v230, 7, v230
    v_add_u32 v230, 114688, v230
    s_lshr_b32 s60, s20, 1
    s_and_b32 s61, s20, 1
    s_mul_i32 s62, s22, 65536
    s_add_u32 s30, s28, s62
    s_mul_i32 s62, s23, 4096
    s_add_u32 s30, s30, s62
    s_mul_i32 s62, s60, 32768
    s_add_u32 s30, s30, s62
    s_mul_i32 s62, s61, 256
    s_add_u32 s30, s30, s62
    s_lshl_b32 s60, s60, 6
    s_lshl_b32 s61, s61, 3
    s_add_u32 s60, s60, s61
    v_lshl_add_u32 v240, v233, 4, s60
    v_add_u32 v240, v240, v230
    s_lshl_b32 s60, s20, 5
    v_lshl_add_u32 v238, v233, 3, s60
    v_add_u32 v238, v238, v230
    v_mov_b32 v248, 0x3f803f80
    v_mov_b32 v249, 0x3f803f80
    v_mov_b32 v250, 0x3f803f80
    v_mov_b32 v251, 0x3f803f80
    s_mov_b32 s50, 0x3f803f80
    v_lshlrev_b32 v230, 4, v226
    v_lshl_add_u32 v4, v227, 9, v230
    v_lshlrev_b32 v231, 4, v226
    v_lshl_add_u32 v231, v228, 2, v231
    v_lshl_add_u32 v231, v234, 30, v231
    v_accvgpr_write_b32 a225, v231
    s_and_b32 s60, s32, 7
    s_lshl_b32 s60, s60, 1
    s_lshr_b32 s61, s20, 1
    s_add_u32 s60, s60, s61
    s_mul_i32 s60, s60, 102400
    s_add_u32 s60, s60, 1048576
    s_lshr_b32 s61, s32, 3
    s_lshl_b32 s61, s61, 1
    s_and_b32 s62, s20, 1
    s_add_u32 s61, s61, s62
    s_mul_i32 s62, s33, 24576
    s_add_u32 s76, s60, s62
    s_mul_i32 s62, s61, 1024
    s_add_u32 s76, s76, s62
    s_mul_i32 s62, s33, 128
    s_add_u32 s3, s60, s62
    s_mul_i32 s62, s61, 512
    s_add_u32 s3, s3, s62
    s_add_u32 s3, s3, 98304
    s_mul_i32 s62, s32, 65536
    s_add_u32 s60, 2686976, s62
    s_mul_i32 s62, s33, 16384
    s_add_u32 s60, s60, s62
    s_mul_i32 s62, s20, 1024
    s_add_u32 s60, s60, s62
    s_cmp_lt_u32 s2, 96
    s_cselect_b32 s76, s76, s60
    s_cselect_b32 s3, s3, 0x40000000
    s_cselect_b32 s61, 6, 4
    s_cselect_b64 vcc, -1, 0
    s_lshl_b32 s61, s61, 10
    s_add_u32 s77, s76, s61
    s_add_u32 s78, s77, s61
    s_add_u32 s79, s78, s61
    v_lshlrev_b32 v230, 9, v227
    v_sub_u32 v240, v240, v230
    v_add_u32 v239, 512, v238
    v_add_u32 v230, 2048, v240
    v_cndmask_b32 v238, v240, v238, vcc
    v_cndmask_b32 v239, v230, v239, vcc
    s_waitcnt vmcnt(4)
    s_barrier
    ds_read_b64_tr_b16 v[160:161], v238 offset:0
    ds_read_b64_tr_b16 v[162:163], v239 offset:0
    ds_read_b64_tr_b16 v[164:165], v238 offset:4096
    ds_read_b64_tr_b16 v[166:167], v239 offset:4096
    ds_read_b64_tr_b16 v[168:169], v238 offset:8192
    ds_read_b64_tr_b16 v[170:171], v239 offset:8192
    ds_read_b64_tr_b16 v[172:173], v238 offset:12288
    ds_read_b64_tr_b16 v[174:175], v239 offset:12288
    s_waitcnt lgkmcnt(6)
    buffer_store_dwordx4 v[160:163], v1, s[8:11], s76 offen offset:0 sc1
    v_mfma_f32_16x16x32_bf16 v[208:211], v[248:251], v[160:163], 0
    s_waitcnt lgkmcnt(4)
    buffer_store_dwordx4 v[164:167], v1, s[8:11], s77 offen offset:0 sc1
    v_mfma_f32_16x16x32_bf16 v[208:211], v[248:251], v[164:167], v[208:211]
    s_waitcnt lgkmcnt(2)
    buffer_store_dwordx4 v[168:171], v1, s[8:11], s78 offen offset:0 sc1
    v_mfma_f32_16x16x32_bf16 v[208:211], v[248:251], v[168:171], v[208:211]
    s_waitcnt lgkmcnt(0)
    buffer_store_dwordx4 v[172:175], v1, s[8:11], s79 offen offset:0 sc1
    v_mfma_f32_16x16x32_bf16 v[208:211], v[248:251], v[172:175], v[208:211]
    v_cmp_eq_u32 vcc, 0, v234
    s_nop 6
    v_cvt_pk_bf16_f32 v220, v208, v208
    v_lshlrev_b32 v221, 16, v220
    v_sub_f32 v221, v208, v221
    v_cvt_pk_bf16_f32 v220, v208, v221
    v_cndmask_b32 v220, 0, v220, vcc
    buffer_store_dword v220, v244, s[8:11], s3 offen sc1
    s_waitcnt vmcnt(7)
    s_mov_b32 vcc_lo, 0x55555555
    s_mov_b32 vcc_hi, 0x55555555
    v_cndmask_b32_dpp v8, v36, v32, vcc quad_perm:[1,0,3,2] row_mask:0xf bank_mask:0xf
    v_cndmask_b32_dpp v9, v37, v33, vcc quad_perm:[1,0,3,2] row_mask:0xf bank_mask:0xf
    v_cndmask_b32_dpp v10, v38, v34, vcc quad_perm:[1,0,3,2] row_mask:0xf bank_mask:0xf
    v_cndmask_b32_dpp v11, v39, v35, vcc quad_perm:[1,0,3,2] row_mask:0xf bank_mask:0xf
    s_not_b64 vcc, vcc
    v_cndmask_b32_dpp v12, v32, v36, vcc quad_perm:[1,0,3,2] row_mask:0xf bank_mask:0xf
    v_cndmask_b32_dpp v13, v33, v37, vcc quad_perm:[1,0,3,2] row_mask:0xf bank_mask:0xf
    v_cndmask_b32_dpp v14, v34, v38, vcc quad_perm:[1,0,3,2] row_mask:0xf bank_mask:0xf
    v_cndmask_b32_dpp v15, v35, v39, vcc quad_perm:[1,0,3,2] row_mask:0xf bank_mask:0xf
    s_add_u32 s59, s30, 0
    v_dot2_f32_bf16 v26, v8, s50, 0
    v_dot2_f32_bf16 v27, v8, v8, 0
    v_dot2_f32_bf16 v28, v12, s50, 0
    v_dot2_f32_bf16 v29, v12, v12, 0
    v_dot2_f32_bf16 v26, v9, s50, v26
    v_dot2_f32_bf16 v27, v9, v9, v27
    v_dot2_f32_bf16 v28, v13, s50, v28
    v_dot2_f32_bf16 v29, v13, v13, v29
    v_dot2_f32_bf16 v26, v10, s50, v26
    v_dot2_f32_bf16 v27, v10, v10, v27
    v_dot2_f32_bf16 v28, v14, s50, v28
    v_dot2_f32_bf16 v29, v14, v14, v29
    v_dot2_f32_bf16 v26, v11, s50, v26
    v_dot2_f32_bf16 v27, v11, v11, v27
    v_dot2_f32_bf16 v28, v15, s50, v28
    v_dot2_f32_bf16 v29, v15, v15, v29
    v_accvgpr_read_b32 v25, a225
    s_add_u32 s59, s49, 720896
    v_add_f32 v26, v26, v28
    v_add_f32 v27, v27, v29
    s_nop 1
    v_permlane32_swap_b32 v26, v27
    v_add_f32 v26, v26, v27
    v_mov_b32 v27, v26
    s_nop 1
    v_permlane16_swap_b32 v26, v27
    v_add_f32 v26, v26, v27
    buffer_store_dword v26, v25, s[8:11], s59 offen
    buffer_load_dword v31, v241, s[8:11], 0 offen sc1
    s_branch L_join
L_follow:
    s_sub_u32 s34, s2, 128
    s_mul_hi_u32 s33, s34, 0x924924a
    s_mul_i32 s62, s33, 28
    s_sub_u32 s32, s34, s62
    v_mul_u32_u24 v235, 3584, v225
    v_add_u32 v235, v235, v230
    v_lshl_add_u32 v237, v225, 10, v230
    s_mul_i32 s62, s33, 458752
    s_add_u32 s35, 0, s62
    s_mul_i32 s62, s20, 114688
    s_add_u32 s35, s35, s62
    s_mul_i32 s62, s32, 128
    s_add_u32 s35, s35, s62
    s_mul_i32 s62, s21, 131072
    s_add_u32 s36, 0, s62
    s_mul_i32 s62, s20, 32768
    s_add_u32 s36, s36, s62
    s_mul_i32 s62, s25, 128
    s_add_u32 s36, s36, s62
    s_waitcnt lgkmcnt(0)
    s_load_dword s26, s[4:5], 0
    s_mov_b32 s6, s35
    s_mov_b32 s84, s72
    s_and_b32 s85, s73, 0xffff
    s_mov_b32 s86, 1835008
    s_mov_b32 s87, 0x20000
    s_mov_b32 s88, s74
    s_and_b32 s89, s75, 0xffff
    s_mov_b32 s90, 1835008
    s_mov_b32 s91, 0x20000
    s_mov_b32 s92, s76
    s_and_b32 s93, s77, 0xffff
    s_mov_b32 s94, 1835008
    s_mov_b32 s95, 0x20000
    s_add_u32 m0, s97, 114688
    s_nop 0
    buffer_load_dwordx4 v235, s[84:87], s6 offen offset:0 lds
    s_add_u32 s60, s6, 27648
    buffer_load_dwordx4 v235, s[84:87], s60 offen offset:1024 lds
    s_add_u32 s60, s60, 27648
    buffer_load_dwordx4 v235, s[84:87], s60 offen offset:2048 lds
    s_add_u32 s60, s60, 27648
    buffer_load_dwordx4 v235, s[84:87], s60 offen offset:3072 lds
    s_add_u32 m0, s97, 131072
    s_nop 0
    buffer_load_dwordx4 v235, s[88:91], s6 offen offset:0 lds
    s_add_u32 s60, s6, 27648
    buffer_load_dwordx4 v235, s[88:91], s60 offen offset:1024 lds
    s_add_u32 s60, s60, 27648
    buffer_load_dwordx4 v235, s[88:91], s60 offen offset:2048 lds
    s_add_u32 s60, s60, 27648
    buffer_load_dwordx4 v235, s[88:91], s60 offen offset:3072 lds
    s_mov_b32 s12, s64
    s_and_b32 s13, s65, 0xffff
    s_mov_b32 s14, 2097152
    s_mov_b32 s15, 0x20000
    buffer_load_dwordx4 v[32:35], v236, s[12:15], 0 offen
    buffer_load_dwordx4 v[36:39], v236, s[12:15], 0 offen offset:2048
    s_mov_b32 s8, s4
    s_and_b32 s9, s5, 0xffff
    s_mov_b32 s10, 27262976
    s_mov_b32 s11, 0x20000
    s_lshl_b32 s24, s25, 1
    s_add_u32 s24, s24, s53
    s_lshl_b32 s28, s24, 20
    s_add_u32 s28, s28, 0xa00000
    s_mul_i32 s62, s24, 256
    s_add_u32 s44, 4096, s62
    s_mul_i32 s62, s21, 16
    s_add_u32 s45, s44, s62
    s_mul_i32 s62, s20, 4
    s_add_u32 s45, s45, s62
    s_mul_i32 s62, s22, 4096
    s_add_u32 s59, s28, s62
    s_mul_i32 s62, s20, 1024
    s_add_u32 s59, s59, s62
    s_mul_i32 s62, s23, 128
    s_add_u32 s59, s59, s62
    s_and_b32 s60, s23, 1
    s_mul_i32 s62, s60, -120
    s_add_u32 s49, s59, s62
    s_add_u32 s59, s59, 720896
    v_cmp_gt_u32 vcc, 32, v0
    v_mov_b32 v231, s59
    v_mov_b32 v241, s45
    v_cndmask_b32 v241, v231, v241, vcc
    buffer_load_dword a255, v241, s[8:11], 0 offen sc1
    s_mov_b32 s16, s78
    s_and_b32 s17, s79, 0xffff
    s_mov_b32 s18, 2097152
    s_mov_b32 s19, 0x20000
    v_accvgpr_write_b32 a224, v236
    v_lshlrev_b32 v1, 4, v0
    v_lshlrev_b32 v6, 2, v0
    v_bfe_u32 v232, v0, 2, 2
    v_and_b32 v233, 3, v0
    v_bfe_u32 v234, v0, 4, 1
    v_lshrrev_b32 v228, 5, v0
    s_mul_i32 s62, s24, 2048
    s_add_u32 s60, 147456, s62
    v_lshrrev_b32 v241, 2, v0
    v_lshl_add_u32 v241, v241, 7, s60
    v_lshl_add_u32 v244, v228, 30, v6
    s_mul_i32 s62, s21, 128
    s_add_u32 s60, s60, s62
    s_cmp_eq_u32 s20, 0
    s_cselect_b32 s60, s60, 0x40000000
    s_getreg_b32 s61, hwreg(HW_REG_XCC_ID, 0, 4)
    s_waitcnt lgkmcnt(0)
    s_add_u32 s26, s26, 0x9e3779b1
    s_xor_b32 s61, s61, s26
    v_mov_b32 v242, s61
    buffer_store_dword v242, v244, s[8:11], s60 offen sc1
    v_lshl_add_u32 v230, v227, 3, v232
    v_lshlrev_b32 v230, 7, v230
    v_add_u32 v230, 114688, v230
    s_lshr_b32 s60, s20, 1
    s_and_b32 s61, s20, 1
    s_mul_i32 s62, s22, 65536
    s_add_u32 s30, s28, s62
    s_mul_i32 s62, s23, 4096
    s_add_u32 s30, s30, s62
    s_mul_i32 s62, s60, 32768
    s_add_u32 s30, s30, s62
    s_mul_i32 s62, s61, 256
    s_add_u32 s30, s30, s62
    s_lshl_b32 s60, s60, 6
    s_lshl_b32 s61, s61, 3
    s_add_u32 s60, s60, s61
    v_lshl_add_u32 v240, v233, 4, s60
    v_add_u32 v240, v240, v230
    s_lshl_b32 s60, s20, 5
    v_lshl_add_u32 v238, v233, 3, s60
    v_add_u32 v238, v238, v230
    v_mov_b32 v248, 0x3f803f80
    v_mov_b32 v249, 0x3f803f80
    v_mov_b32 v250, 0x3f803f80
    v_mov_b32 v251, 0x3f803f80
    s_mov_b32 s50, 0x3f803f80
    v_lshlrev_b32 v230, 4, v226
    v_lshl_add_u32 v4, v227, 9, v230
    v_lshlrev_b32 v231, 4, v226
    v_lshl_add_u32 v231, v228, 2, v231
    v_lshl_add_u32 v231, v234, 30, v231
    v_accvgpr_write_b32 a225, v231
    s_add_u32 m0, s97, 147456
    s_nop 0
    buffer_load_dwordx4 v237, s[92:95], s36 offen offset:0 lds
    s_add_u32 s60, s36, 7168
    buffer_load_dwordx4 v237, s[92:95], s60 offen offset:1024 lds
    s_add_u32 s60, s60, 7168
    buffer_load_dwordx4 v237, s[92:95], s60 offen offset:2048 lds
    s_add_u32 s60, s60, 7168
    buffer_load_dwordx4 v237, s[92:95], s60 offen offset:3072 lds
    s_mul_i32 s62, s25, 229376
    s_add_u32 s7, 7012352, s62
    s_mul_i32 s62, s21, 16384
    s_add_u32 s7, s7, s62
    s_mul_i32 s62, s20, 1024
    s_add_u32 s7, s7, s62
    s_lshl_b32 s32, s32, 2
    s_add_u32 s32, s32, s20
    s_mul_hi_u32 s60, s32, 0x24924925
    s_mul_i32 s62, s60, 7
    s_sub_u32 s61, s32, s62
    s_mul_i32 s62, s60, 237568
    s_add_u32 s3, 3211264, s62
    s_sub_u32 s62, 6, s61
    s_bitcmp1_b32 s60, 0
    s_cselect_b32 s61, s61, s62
    s_mul_i32 s62, s33, 57344
    s_add_u32 s35, s3, s62
    s_mul_i32 s62, s61, 2048
    s_add_u32 s35, s35, s62
    s_mul_i32 s62, s61, 13312
    s_add_u32 s3, s3, s62
    s_mul_i32 s62, s33, 8192
    s_add_u32 s36, s3, s62
    s_add_u32 s60, s35, 0
    s_add_u32 s61, s36, 122880
    s_cmp_lt_u32 s33, 3
    s_cselect_b32 s76, s60, s61
    s_add_u32 s60, s35, 14336
    s_add_u32 s61, s36, 124928
    s_cmp_lt_u32 s33, 3
    s_cselect_b32 s77, s60, s61
    s_add_u32 s60, s35, 28672
    s_add_u32 s61, s36, 126976
    s_cmp_lt_u32 s33, 2
    s_cselect_b32 s78, s60, s61
    s_add_u32 s60, s35, 43008
    s_add_u32 s61, s36, 129024
    s_cmp_lt_u32 s33, 2
    s_cselect_b32 s79, s60, s61
    s_mul_i32 s62, s33, 128
    s_add_u32 s3, s3, s62
    s_add_u32 s3, s3, 155648
    s_cmp_lt_u32 s2, 240
    s_cselect_b32 s76, s76, 0x40000000
    s_cselect_b32 s77, s77, 0x40000000
    s_cselect_b32 s78, s78, 0x40000000
    s_cselect_b32 s79, s79, 0x40000000
    s_cselect_b32 s3, s3, 0x40000000
    s_cselect_b32 s7, s7, 0x40000000
    v_mul_u32_u24 v222, 384, v228
    v_add_u32 v222, v222, v6
    s_waitcnt vmcnt(8)
    s_barrier
    ds_read_b64_tr_b16 v[160:161], v238 offset:0
    ds_read_b64_tr_b16 v[162:163], v238 offset:512
    ds_read_b64_tr_b16 v[164:165], v238 offset:4096
    ds_read_b64_tr_b16 v[166:167], v238 offset:4608
    ds_read_b64_tr_b16 v[168:169], v238 offset:8192
    ds_read_b64_tr_b16 v[170:171], v238 offset:8704
    ds_read_b64_tr_b16 v[172:173], v238 offset:12288
    ds_read_b64_tr_b16 v[174:175], v238 offset:12800
    s_waitcnt lgkmcnt(6)
    buffer_store_dwordx4 v[160:163], v1, s[8:11], s76 offen offset:0 sc1
    v_mfma_f32_16x16x32_bf16 v[208:211], v[248:251], v[160:163], 0
    s_waitcnt lgkmcnt(4)
    buffer_store_dwordx4 v[164:167], v1, s[8:11], s77 offen offset:0 sc1
    v_mfma_f32_16x16x32_bf16 v[208:211], v[248:251], v[164:167], v[208:211]
    s_waitcnt lgkmcnt(2)
    buffer_store_dwordx4 v[168:171], v1, s[8:11], s78 offen offset:0 sc1
    v_mfma_f32_16x16x32_bf16 v[208:211], v[248:251], v[168:171], v[208:211]
    s_waitcnt lgkmcnt(0)
    buffer_store_dwordx4 v[172:175], v1, s[8:11], s79 offen offset:0 sc1
    v_mfma_f32_16x16x32_bf16 v[208:211], v[248:251], v[172:175], v[208:211]
    ds_read_b64_tr_b16 v[176:177], v238 offset:16384
    ds_read_b64_tr_b16 v[178:179], v238 offset:16896
    ds_read_b64_tr_b16 v[180:181], v238 offset:20480
    ds_read_b64_tr_b16 v[182:183], v238 offset:20992
    ds_read_b64_tr_b16 v[184:185], v238 offset:24576
    ds_read_b64_tr_b16 v[186:187], v238 offset:25088
    ds_read_b64_tr_b16 v[188:189], v238 offset:28672
    ds_read_b64_tr_b16 v[190:191], v238 offset:29184
    s_waitcnt lgkmcnt(6)
    buffer_store_dwordx4 v[176:179], v1, s[8:11], s76 offen offset:1024 sc1
    v_mfma_f32_16x16x32_bf16 v[212:215], v[248:251], v[176:179], 0
    s_waitcnt lgkmcnt(4)
    buffer_store_dwordx4 v[180:183], v1, s[8:11], s77 offen offset:1024 sc1
    v_mfma_f32_16x16x32_bf16 v[212:215], v[248:251], v[180:183], v[212:215]
    s_waitcnt lgkmcnt(2)
    buffer_store_dwordx4 v[184:187], v1, s[8:11], s78 offen offset:1024 sc1
    v_mfma_f32_16x16x32_bf16 v[212:215], v[248:251], v[184:187], v[212:215]
    s_waitcnt lgkmcnt(0)
    buffer_store_dwordx4 v[188:191], v1, s[8:11], s79 offen offset:1024 sc1
    v_mfma_f32_16x16x32_bf16 v[212:215], v[248:251], v[188:191], v[212:215]
    s_add_u32 s76, s7, 0
    s_add_u32 s77, s7, 4096
    s_add_u32 s78, s7, 8192
    s_add_u32 s79, s7, 12288
    v_cmp_gt_u32 vcc, 32, v0
    s_nop 2
    v_cndmask_b32 v208, v212, v208, vcc
    v_cmp_eq_u32 vcc, 0, v234
    v_cvt_pk_bf16_f32 v220, v208, v208
    v_lshlrev_b32 v221, 16, v220
    v_sub_f32 v221, v208, v221
    v_cvt_pk_bf16_f32 v220, v208, v221
    v_cndmask_b32 v220, 0, v220, vcc
    buffer_store_dword v220, v222, s[8:11], s3 offen sc1
    s_waitcnt vmcnt(9)
    s_barrier
    ds_read_b64_tr_b16 v[192:193], v240 offset:32768
    ds_read_b64_tr_b16 v[194:195], v240 offset:33280
    ds_read_b64_tr_b16 v[196:197], v240 offset:36864
    ds_read_b64_tr_b16 v[198:199], v240 offset:37376
    ds_read_b64_tr_b16 v[200:201], v240 offset:40960
    ds_read_b64_tr_b16 v[202:203], v240 offset:41472
    ds_read_b64_tr_b16 v[204:205], v240 offset:45056
    ds_read_b64_tr_b16 v[206:207], v240 offset:45568
    s_waitcnt lgkmcnt(6)
    buffer_store_dwordx4 v[192:195], v1, s[8:11], s76 offen offset:0 sc1
    s_waitcnt lgkmcnt(4)
    buffer_store_dwordx4 v[196:199], v1, s[8:11], s77 offen offset:0 sc1
    s_waitcnt lgkmcnt(2)
    buffer_store_dwordx4 v[200:203], v1, s[8:11], s78 offen offset:0 sc1
    s_waitcnt lgkmcnt(0)
    buffer_store_dwordx4 v[204:207], v1, s[8:11], s79 offen offset:0 sc1
    s_mov_b32 vcc_lo, 0x55555555
    s_mov_b32 vcc_hi, 0x55555555
    v_cndmask_b32_dpp v8, v36, v32, vcc quad_perm:[1,0,3,2] row_mask:0xf bank_mask:0xf
    v_cndmask_b32_dpp v9, v37, v33, vcc quad_perm:[1,0,3,2] row_mask:0xf bank_mask:0xf
    v_cndmask_b32_dpp v10, v38, v34, vcc quad_perm:[1,0,3,2] row_mask:0xf bank_mask:0xf
    v_cndmask_b32_dpp v11, v39, v35, vcc quad_perm:[1,0,3,2] row_mask:0xf bank_mask:0xf
    s_not_b64 vcc, vcc
    v_cndmask_b32_dpp v12, v32, v36, vcc quad_perm:[1,0,3,2] row_mask:0xf bank_mask:0xf
    v_cndmask_b32_dpp v13, v33, v37, vcc quad_perm:[1,0,3,2] row_mask:0xf bank_mask:0xf
    v_cndmask_b32_dpp v14, v34, v38, vcc quad_perm:[1,0,3,2] row_mask:0xf bank_mask:0xf
    v_cndmask_b32_dpp v15, v35, v39, vcc quad_perm:[1,0,3,2] row_mask:0xf bank_mask:0xf
    s_add_u32 s59, s30, 0
    v_dot2_f32_bf16 v26, v8, s50, 0
    v_dot2_f32_bf16 v27, v8, v8, 0
    v_dot2_f32_bf16 v28, v12, s50, 0
    v_dot2_f32_bf16 v29, v12, v12, 0
    v_dot2_f32_bf16 v26, v9, s50, v26
    v_dot2_f32_bf16 v27, v9, v9, v27
    v_dot2_f32_bf16 v28, v13, s50, v28
    v_dot2_f32_bf16 v29, v13, v13, v29
    v_dot2_f32_bf16 v26, v10, s50, v26
    v_dot2_f32_bf16 v27, v10, v10, v27
    v_dot2_f32_bf16 v28, v14, s50, v28
    v_dot2_f32_bf16 v29, v14, v14, v29
    v_dot2_f32_bf16 v26, v11, s50, v26
    v_dot2_f32_bf16 v27, v11, v11, v27
    v_dot2_f32_bf16 v28, v15, s50, v28
    v_dot2_f32_bf16 v29, v15, v15, v29
    v_accvgpr_read_b32 v25, a225
    s_add_u32 s59, s49, 720896
    v_add_f32 v26, v26, v28
    v_add_f32 v27, v27, v29
    s_nop 1
    v_permlane32_swap_b32 v26, v27
    v_add_f32 v26, v26, v27
    v_mov_b32 v27, v26
    s_nop 1
    v_permlane16_swap_b32 v26, v27
    v_add_f32 v26, v26, v27
    buffer_store_dword v26, v25, s[8:11], s59 offen
    buffer_load_dword v31, v241, s[8:11], 0 offen sc1
L_join:
    s_mul_i32 s62, s20, 32768
    s_add_u32 s29, s28, s62
    s_mul_i32 s62, s21, 2048
    s_add_u32 s31, s29, s62
    s_mov_b32 s80, s64
    s_and_b32 s81, s65, 0xffff
    s_mov_b32 s82, 2097152
    s_mov_b32 s83, 0x20000
    v_xor_b32 v21, v224, v225
    v_lshlrev_b32 v21, 4, v21
    v_lshl_add_u32 v21, v225, 11, v21
    s_mul_i32 s62, s25, 262144
    s_add_u32 s14, 0, s62
    s_mul_i32 s62, s53, 1024
    s_add_u32 s14, s14, s62
    s_mul_i32 s62, s20, 65536
    s_add_u32 s6, s14, s62
    s_mul_i32 s62, s20, 256
    s_add_u32 s14, s14, s62
    s_sub_u32 s14, s14, 16384
    s_cmp_eq_u32 s25, 0
    s_cselect_b32 s14, 0x40000000, s14
    v_xor_b32 v16, v224, v227
    v_lshlrev_b32 v16, 4, v16
    v_lshl_add_u32 v231, v224, 7, v16
    v_add_u32 v231, 102400, v231
    v_accvgpr_write_b32 a227, v231
    v_lshl_add_u32 v16, v226, 7, v16
    v_add_u32 v16, s97, v16
    v_xor_b32 v17, 64, v16
    v_add_u32 v18, 0x10000, v16
    v_add_u32 v19, 0x10000, v17
    s_add_u32 m0, s97, 0
    s_add_u32 s15, s6, 0
    buffer_load_dwordx4 v21, s[80:83], s15 offen offset:0 lds
    v_cmp_ne_u32 vcc, 0, v0
    v_mov_b32 v5, 0x40000000
    v_accvgpr_write_b32 a235, v244
    v_cndmask_b32 v5, 0, v5, vcc
    s_mul_i32 s62, s24, 1024
    s_add_u32 s47, 40960, s62
    s_add_u32 m0, s97, 0
    s_add_u32 s15, s6, 15360
    buffer_load_dwordx4 v21, s[80:83], s15 offen offset:1024 lds
    s_mul_i32 s62, s23, 128
    s_add_u32 s52, s47, s62
    s_mul_i32 s62, s2, 128
    s_add_u32 s75, 81920, s62
    s_add_u32 s52, s52, 2048
    s_add_u32 s51, s28, 0x200000
    s_add_u32 m0, s97, 0
    s_add_u32 s15, s6, 30720
    buffer_load_dwordx4 v21, s[80:83], s15 offen offset:2048 lds
    s_lshl_b32 s96, s20, 11
    s_cmp_eq_u32 s20, 0
    s_cselect_b32 s75, s75, 0x40000000
    s_lshl_b32 s60, s22, 2
    s_add_u32 s60, s60, s20
    s_cmp_eq_u32 s25, 7
    s_cselect_b32 s60, 0, s60
    s_add_u32 m0, s97, 0
    s_add_u32 s15, s6, 46080
    buffer_load_dwordx4 v21, s[80:83], s15 offen offset:3072 lds
    s_cmp_eq_u32 s60, 7
    s_cselect_b32 s51, s51, 0x40000000
    v_bfe_u32 v235, v0, 3, 1
    v_xor_b32 v235, 1, v235
    v_lshlrev_b32 v235, 29, v235
    s_mul_i32 s62, s23, 128
    s_add_u32 m0, s97, 16384
    s_add_u32 s15, s6, 128
    buffer_load_dwordx4 v21, s[80:83], s15 offen offset:0 lds
    s_add_u32 s60, 8192, s62
    v_lshl_add_u32 v231, v226, 3, s60
    v_lshl_add_u32 v231, v227, 28, v231
    v_accvgpr_write_b32 a233, v231
    v_lshlrev_b32 v230, 4, v224
    v_lshl_add_u32 v230, v227, 7, v230
    s_add_u32 m0, s97, 16384
    s_add_u32 s15, s6, 15488
    buffer_load_dwordx4 v21, s[80:83], s15 offen offset:1024 lds
    v_add_u32 v231, 102400, v230
    v_accvgpr_write_b32 a229, v231
    s_lshl_b32 s60, s23, 10
    v_add3_u32 v231, v230, v235, s60
    v_accvgpr_write_b32 a232, v231
    s_add_u32 m0, s97, 16384
    s_add_u32 s15, s6, 30848
    buffer_load_dwordx4 v21, s[80:83], s15 offen offset:2048 lds
    s_add_u32 m0, s97, 16384
    s_add_u32 s15, s6, 46208
    buffer_load_dwordx4 v21, s[80:83], s15 offen offset:3072 lds
    v_mov_b32 v30, s26
    s_waitcnt vmcnt(8)
    s_barrier
    buffer_store_dword v30, v244, s[8:11], s75 offen sc1
    v_xor_b32 v29, s26, v31
    v_cmp_lt_u32 vcc, 15, v29
    s_nop 0
    s_and_b64 vcc, vcc, exec
    s_cbranch_scc1 L_xspin_1
L_xback_2:
    v_cmp_ne_u32 vcc, v242, v31
    s_nop 0
    s_cmp_lg_u64 vcc, 0
    s_cselect_b32 s27, 1, 0
    s_mov_b32 s0, s27
    s_mov_b32 s1, 0
    s_add_u32 s12, s26, 0
    v_mov_b32 v30, s12
    s_cmp_lg_u32 s51, 0x40000000
    s_cbranch_scc1 L_halo_5
L_hback_6:
    s_cmp_lg_u32 s27, 0
    s_cbranch_scc1 L_slow_3
    buffer_store_dword v30, v5, s[8:11], s45 offen
L_sig_4:
    s_cmp_lg_u32 s51, 0x40000000
    s_cbranch_scc1 L_halo_7
L_hback_8:
    s_add_u32 m0, s97, 32768
    s_add_u32 s15, s6, 256
    buffer_load_dwordx4 v21, s[80:83], s15 offen offset:0 lds
    s_lshr_b32 s60, s20, 1
    s_lshl_b32 s60, s60, 5
    s_and_b32 s61, s20, 1
    s_lshl_b32 s61, s61, 1
    s_add_u32 s60, s60, s61
    s_mov_b32 s40, 0x33333333
    s_mov_b32 s41, 0
    s_add_u32 m0, s97, 32768
    s_add_u32 s15, s6, 15616
    buffer_load_dwordx4 v21, s[80:83], s15 offen offset:1024 lds
    s_lshl_b64 s[40:41], s[40:41], s60
    s_lshl_b32 s60, s22, 1
    s_lshl_b32 s62, s20, 4
    s_add_u32 s60, s60, s62
    s_mov_b32 s42, 0x3333
    s_mov_b32 s43, 0
    s_lshl_b64 s[42:43], s[42:43], s60
    s_add_u32 m0, s97, 32768
    s_add_u32 s15, s6, 30976
    buffer_load_dwordx4 v21, s[80:83], s15 offen offset:2048 lds
    s_lshr_b32 s60, s21, 1
    s_mul_i32 s61, s20, 24
    s_add_u32 s60, s60, s61
    v_lshl_add_u32 v230, v225, 3, s60
    s_lshl_b32 s60, s20, 3
    s_add_u32 s60, s60, s23
    s_add_u32 s60, s60, 96
    s_add_u32 m0, s97, 32768
    s_add_u32 s15, s6, 46336
    buffer_load_dwordx4 v21, s[80:83], s15 offen offset:3072 lds
    v_mov_b32 v231, s60
    v_cmp_gt_u32 vcc, 24, v0
    s_nop 1
    v_cndmask_b32 v230, v231, v230, vcc
    v_lshlrev_b32 v230, 7, v230
    v_add_u32 v243, 81920, v230
    s_lshr_b32 s13, s2, 3
    s_lshl_b32 s13, s13, 2
    s_add_u32 m0, s97, 49152
    s_add_u32 s15, s6, 384
    buffer_load_dwordx4 v21, s[80:83], s15 offen offset:0 lds
    s_add_u32 s13, s13, s20
    s_lshl_b32 s13, s13, 7
    s_mul_i32 s62, s20, 114688
    s_add_u32 s33, s28, s62
    s_mul_i32 s62, s21, 7168
    s_add_u32 s33, s33, s62
    s_mul_i32 s62, s20, 2048
    s_add_u32 m0, s97, 49152
    s_add_u32 s15, s6, 15744
    buffer_load_dwordx4 v21, s[80:83], s15 offen offset:1024 lds
    s_add_u32 s34, s28, s62
    s_mul_i32 s62, s23, -4096
    s_add_u32 s64, s30, s62
    s_bitcmp1_b32 s21, 0
    s_cselect_b32 s65, 1, -1
    s_cselect_b32 s60, 0, 6144
    s_lshl_b32 s65, s65, 10
    s_add_u32 m0, s97, 49152
    s_add_u32 s15, s6, 31104
    buffer_load_dwordx4 v21, s[80:83], s15 offen offset:2048 lds
    s_add_u32 s33, s33, s60
    s_lshr_b32 s60, s20, 1
    s_lshl_b32 s61, s22, 1
    s_add_u32 s60, s60, s61
    s_lshl_b32 s66, 0x11111111, s60
    s_mov_b32 s67, s66
    s_mul_i32 s62, s22, 229376
    s_add_u32 m0, s97, 49152
    s_add_u32 s15, s6, 46464
    buffer_load_dwordx4 v21, s[80:83], s15 offen offset:3072 lds
    s_add_u32 s71, s28, s62
    s_mul_i32 s62, s20, 28672
    s_add_u32 s71, s71, s62
    s_add_u32 s56, s20, 1
    s_and_b32 s56, s56, 3
    s_lshr_b32 s60, s56, 1
    s_and_b32 s61, s56, 1
    s_add_u32 m0, s97, 65536
    s_add_u32 s15, s6, 512
    buffer_load_dwordx4 v21, s[80:83], s15 offen offset:0 lds
    s_mul_i32 s62, s60, 114688
    s_add_u32 s68, s71, s62
    s_mul_i32 s62, s61, 256
    s_add_u32 s68, s68, s62
    s_mul_i32 s62, s56, 12288
    s_add_u32 s72, 0, s62
    s_add_u32 s56, s20, 2
    s_add_u32 m0, s97, 65536
    s_add_u32 s15, s6, 15872
    buffer_load_dwordx4 v21, s[80:83], s15 offen offset:1024 lds
    s_and_b32 s56, s56, 3
    s_lshr_b32 s60, s56, 1
    s_and_b32 s61, s56, 1
    s_mul_i32 s62, s60, 114688
    s_add_u32 s69, s71, s62
    s_mul_i32 s62, s61, 256
    s_add_u32 s69, s69, s62
    s_waitcnt vmcnt(16)
    ds_read_b128 v[32:35], v16 offset:0
    ds_read_b128 v[40:43], v17 offset:0
    ds_read_b128 v[36:39], v16 offset:2048
    ds_read_b128 v[44:47], v17 offset:2048
    s_add_u32 m0, s97, 65536
    s_add_u32 s15, s6, 31232
    buffer_load_dwordx4 v21, s[80:83], s15 offen offset:2048 lds
    s_mul_i32 s62, s56, 12288
    s_add_u32 s73, 4096, s62
    s_add_u32 s56, s20, 3
    s_and_b32 s56, s56, 3
    s_lshr_b32 s60, s56, 1
    s_and_b32 s61, s56, 1
    s_mul_i32 s62, s60, 114688
    s_add_u32 m0, s97, 65536
    s_add_u32 s15, s6, 46592
    buffer_load_dwordx4 v21, s[80:83], s15 offen offset:3072 lds
    s_add_u32 s70, s71, s62
    s_mul_i32 s62, s61, 256
    s_add_u32 s70, s70, s62
    s_mul_i32 s62, s56, 12288
    s_add_u32 s74, 8192, s62
    s_add_u32 s56, s20, 4
    s_and_b32 s56, s56, 3
    s_add_u32 m0, s97, 81920
    s_add_u32 s15, s6, 640
    buffer_load_dwordx4 v21, s[80:83], s15 offen offset:0 lds
    s_lshr_b32 s60, s56, 1
    s_and_b32 s61, s56, 1
    s_mul_i32 s62, s60, 114688
    s_add_u32 s71, s71, s62
    s_mul_i32 s62, s61, 256
    s_add_u32 s71, s71, s62
    s_mul_i32 s62, s20, 12288
    s_add_u32 m0, s97, 81920
    s_add_u32 s15, s6, 16000
    buffer_load_dwordx4 v21, s[80:83], s15 offen offset:1024 lds
    s_add_u32 s32, 0, s62
    s_mul_i32 s62, s21, 102400
    s_add_u32 s35, 1048576, s62
    s_mul_i32 s62, s21, 237568
    s_add_u32 s36, 3211264, s62
    s_mul_i32 s62, s23, 65536
    s_add_u32 s37, 2686976, s62
    s_waitcnt vmcnt(16)
    ds_read_b128 v[48:51], v16 offset:16384
    ds_read_b128 v[56:59], v17 offset:16384
    ds_read_b128 v[52:55], v16 offset:18432
    ds_read_b128 v[60:63], v17 offset:18432
    s_add_u32 m0, s97, 81920
    s_add_u32 s15, s6, 31360
    buffer_load_dwordx4 v21, s[80:83], s15 offen offset:2048 lds
    s_mul_i32 s62, s20, 4096
    s_add_u32 s37, s37, s62
    s_mul_i32 s62, s23, 229376
    s_add_u32 s38, 7012352, s62
    s_mul_i32 s62, s20, 57344
    s_add_u32 s38, s38, s62
    s_mul_i32 s62, s20, 512
    s_add_u32 m0, s97, 81920
    s_add_u32 s15, s6, 46720
    buffer_load_dwordx4 v21, s[80:83], s15 offen offset:3072 lds
    s_add_u32 s48, 124928, s62
    s_lshl_b32 s39, s20, 10
    s_add_u32 s98, s35, s97
    s_add_u32 s99, s36, s97
    s_cmp_eq_u32 s25, 0
    s_cselect_b32 s46, 0x40000000, s28
    s_cselect_b64 s[54:55], 0, -1
    s_add_u32 m0, s97, 98304
    s_add_u32 s15, s6, 768
    buffer_load_dwordx4 v21, s[80:83], s15 offen offset:0 lds
    s_add_u32 s53, s46, s96
    s_add_u32 s35, s35, s39
    s_add_u32 s36, s36, s96
    v_add_u32 v2, 0x10000, v1
    v_add_u32 v3, 0x20000, v1
    v_lshrrev_b32 v231, 1, v0
    v_lshlrev_b32 v231, 7, v231
    s_add_u32 m0, s97, 98304
    s_add_u32 s15, s6, 16128
    buffer_load_dwordx4 v21, s[80:83], s15 offen offset:1024 lds
    s_add_u32 s60, s31, 131072
    v_and_b32 v230, 128, v231
    v_add_u32 v231, s60, v231
    v_bfe_u32 v245, v0, 2, 3
    s_add_u32 s60, s30, 0
    v_lshl_add_u32 v230, v245, 9, v230
    v_cmp_gt_u32 vcc, 32, v0
    s_waitcnt vmcnt(14)
    ds_read_b128 v[64:67], v16 offset:32768
    ds_read_b128 v[72:75], v17 offset:32768
    ds_read_b128 v[68:71], v16 offset:34816
    ds_read_b128 v[76:79], v17 offset:34816
    s_add_u32 m0, s97, 98304
    s_add_u32 s15, s6, 31488
    buffer_load_dwordx4 v21, s[80:83], s15 offen offset:2048 lds
    v_add_u32 v230, s60, v230
    v_cndmask_b32 v231, v230, v231, vcc
    v_accvgpr_write_b32 a236, v231
    v_lshlrev_b32 v230, 7, v232
    v_lshl_add_u32 v230, v227, 5, v230
    v_lshl_add_u32 v230, v233, 1, v230
    v_lshlrev_b32 v231, 3, v0
    s_add_u32 m0, s97, 98304
    s_add_u32 s15, s6, 46848
    buffer_load_dwordx4 v21, s[80:83], s15 offen offset:3072 lds
    s_cmp_ge_u32 s20, 2
    s_cselect_b64 vcc, -1, 0
    s_cselect_b32 s61, 2, 8
    v_cndmask_b32 v231, v230, v231, vcc
    s_lshr_b32 s60, s39, 1
    s_add_u32 s60, s60, 114688
    v_add_u32 v231, s60, v231
    buffer_load_dword v22, v6, s[8:11], s44 offen nt
    buffer_load_dword v23, v243, s[8:11], 0 offen sc1
    s_add_u32 m0, s97, 114688
    s_add_u32 s15, s6, 896
    buffer_load_dwordx4 v21, s[80:83], s15 offen offset:0 lds
    v_accvgpr_write_b32 a230, v231
    v_mov_b32 v231, s61
    v_accvgpr_write_b32 a231, v231
    s_mul_i32 s60, s21, 7
    s_add_u32 s61, s60, 6
    s_lshr_b32 s60, s60, 2
    s_lshr_b32 s61, s61, 2
    s_add_u32 m0, s97, 114688
    s_add_u32 s15, s6, 16256
    buffer_load_dwordx4 v21, s[80:83], s15 offen offset:1024 lds
    v_add_u32 v230, s60, v225
    v_min_u32 v230, s61, v230
    s_mul_i32 s60, s20, 28
    v_add_u32 v230, s60, v230
    s_add_u32 s60, s21, 112
    v_cmp_gt_u32 vcc, 24, v0
    v_mov_b32 v231, s60
    s_waitcnt vmcnt(16)
    ds_read_b128 v[80:83], v16 offset:49152
    ds_read_b128 v[88:91], v17 offset:49152
    ds_read_b128 v[84:87], v16 offset:51200
    s_waitcnt lgkmcnt(14)
    ds_read_b128 v[92:95], v17 offset:51200
    s_add_u32 m0, s97, 114688
    s_add_u32 s15, s6, 31616
    buffer_load_dwordx4 v21, s[80:83], s15 offen offset:2048 lds
    v_cndmask_b32 v230, v231, v230, vcc
    s_mul_i32 s60, s20, 7
    s_lshr_b32 s60, s60, 1
    v_and_b32 v231, 3, v225
    v_add_u32 v231, s60, v231
    v_lshl_add_u32 v231, v231, 3, s23
    v_cmp_gt_u32 vcc, 32, v0
    s_nop 1
    v_cndmask_b32 v230, v231, v230, vcc
    v_lshlrev_b32 v230, 7, v230
    v_add_u32 v231, 98304, v230
    v_accvgpr_write_b32 a234, v231
    s_getpc_b64 s[4:5]
L_pc2:
    s_add_u32 m0, s97, 114688
    s_add_u32 s15, s6, 46976
    buffer_load_dwordx4 v21, s[80:83], s15 offen offset:3072 lds
    s_sub_u32 s4, s4, L_pc2-L_pc
    s_subb_u32 s5, s5, 0
    s_or_b32 s60, s25, s20
    s_cmp_eq_u32 s60, 0
    s_cselect_b64 s[56:57], -1, 0
    v_mov_b32 v232, 0xf149f2ca
    v_mov_b32 v233, 0
    v_lshlrev_b32 v235, 2, v227
    v_sub_u32 v235, v226, v235
    v_subrev_u32 v230, 0, v235
    v_mov_b32 v234, 0xffff
    v_cmp_gt_u32 vcc, 8, v230
    v_cmp_gt_i32 s[58:59], -8, v230
    v_cmp_le_i32 s[60:61], 0, v230
    v_cndmask_b32 v231, v232, v233, vcc
    v_accvgpr_write_b32 a240, v231
    v_cndmask_b32 v231, v232, v233, s[58:59]
    v_accvgpr_write_b32 a244, v231
    v_cndmask_b32 v231, v231, v232, s[56:57]
    v_accvgpr_write_b32 a248, v231
    v_cndmask_b32 v228, v233, v234, s[60:61]
    v_subrev_u32 v230, 1, v235
    v_mov_b32 v234, 0xffff0000
    v_cmp_gt_u32 vcc, 8, v230
    v_cmp_gt_i32 s[58:59], -8, v230
    v_cmp_le_i32 s[60:61], 0, v230
    v_cndmask_b32 v231, v232, v233, vcc
    v_accvgpr_write_b32 a241, v231
    v_cndmask_b32 v231, v232, v233, s[58:59]
    v_accvgpr_write_b32 a245, v231
    v_cndmask_b32 v231, v231, v232, s[56:57]
    v_accvgpr_write_b32 a249, v231
    v_cndmask_b32 v231, v233, v234, s[60:61]
    v_or_b32 v231, v231, v228
    v_accvgpr_write_b32 a252, v231
    v_subrev_u32 v230, 2, v235
    v_mov_b32 v234, 0xffff
    v_cmp_gt_u32 vcc, 8, v230
    v_cmp_gt_i32 s[58:59], -8, v230
    v_cmp_le_i32 s[60:61], 0, v230
    v_cndmask_b32 v231, v232, v233, vcc
    v_accvgpr_write_b32 a242, v231
    v_cndmask_b32 v231, v232, v233, s[58:59]
    v_accvgpr_write_b32 a246, v231
    v_cndmask_b32 v231, v231, v232, s[56:57]
    v_accvgpr_write_b32 a250, v231
    v_cndmask_b32 v228, v233, v234, s[60:61]
    v_subrev_u32 v230, 3, v235
    v_mov_b32 v234, 0xffff0000
    v_cmp_gt_u32 vcc, 8, v230
    v_cmp_gt_i32 s[58:59], -8, v230
    v_cmp_le_i32 s[60:61], 0, v230
    v_cndmask_b32 v231, v232, v233, vcc
    v_accvgpr_write_b32 a243, v231
    v_cndmask_b32 v231, v232, v233, s[58:59]
    v_accvgpr_write_b32 a247, v231
    v_cndmask_b32 v231, v231, v232, s[56:57]
    v_accvgpr_write_b32 a251, v231
    v_cndmask_b32 v231, v233, v234, s[60:61]
    v_or_b32 v231, v231, v228
    v_accvgpr_write_b32 a253, v231
    s_branch L_page_13
    .p2align 12
L_page_13:
    s_waitcnt vmcnt(4)
    v_cmp_ne_u32 vcc, s26, v23
    s_nop 0
    s_and_b64 vcc, vcc, exec
    s_cbranch_scc1 L_lspin_9
L_lback_10:
    s_add_u32 s3, s26, 0
    v_subrev_u32 v22, s3, v22
    v_cmp_lt_u32 vcc, 15, v22
    s_nop 0
    s_and_b64 vcc, vcc, s[40:41]
    s_or_b64 vcc, vcc, s[0:1]
    s_cbranch_scc1 L_cspin_11
L_cback_12:
    s_waitcnt lgkmcnt(0)
L_qkv0:
    s_barrier
    s_add_u32 s57, s98, 0
    s_add_u32 m0, s97, 0
    s_nop 0
    buffer_load_dwordx4 v1, s[8:11], s57 offen offset:0 sc1 lds
    buffer_load_dwordx4 v1, s[8:11], s57 offen offset:1024 sc1 lds
    buffer_load_dwordx4 v1, s[8:11], s57 offen offset:2048 sc1 lds
    buffer_load_dwordx4 v1, s[8:11], s57 offen offset:3072 sc1 lds
    ds_read_b128 v[96:99], v18 offset:0
    ds_read_b128 v[104:107], v19 offset:0
    s_add_u32 s57, s98, 16384
    s_add_u32 m0, s97, 16384
    s_nop 0
    buffer_load_dwordx4 v1, s[8:11], s57 offen offset:0 sc1 lds
    ds_read_b128 v[100:103], v18 offset:2048
    ds_read_b128 v[108:111], v19 offset:2048
    buffer_load_dwordx4 v1, s[8:11], s57 offen offset:1024 sc1 lds
    ds_read_b128 v[112:115], v18 offset:16384
    ds_read_b128 v[120:123], v19 offset:16384
    ds_read_b128 v[116:119], v18 offset:18432
    buffer_load_dwordx4 v1, s[8:11], s57 offen offset:2048 sc1 lds
    ds_read_b128 v[124:127], v19 offset:18432
    ds_read_b128 v[128:131], v18 offset:32768
    buffer_load_dwordx4 v1, s[8:11], s57 offen offset:3072 sc1 lds
    ds_read_b128 v[136:139], v19 offset:32768
    ds_read_b128 v[132:135], v18 offset:34816
    ds_read_b128 v[140:143], v19 offset:34816
    s_add_u32 s57, s98, 32768
    s_add_u32 m0, s97, 32768
    s_nop 0
    buffer_load_dwordx4 v1, s[8:11], s57 offen offset:0 sc1 lds
    s_waitcnt vmcnt(9)
    ds_read_b128 v[144:147], v18 offset:49152
    ds_read_b128 v[152:155], v19 offset:49152
    buffer_load_dwordx4 v1, s[8:11], s57 offen offset:1024 sc1 lds
    ds_read_b128 v[148:151], v18 offset:51200
    s_waitcnt lgkmcnt(14)
    ds_read_b128 v[156:159], v19 offset:51200
    buffer_load_dwordx4 v1, s[8:11], s57 offen offset:2048 sc1 lds
    buffer_load_dwordx4 v1, s[8:11], s57 offen offset:3072 sc1 lds
    s_waitcnt lgkmcnt(0)
    v_accvgpr_read_b32 v16, a229
    s_add_u32 s62, s39, 2048
    v_add_u32 v17, s62, v1
    v_add_u32 v18, 0xc000, v17
    v_and_b32 v28, 0x380, v1
    s_waitcnt vmcnt(8)
    s_barrier
    ds_read_b128 v[224:227], v1 offset:0
    ds_read_b128 v[228:231], v1 offset:1024
    ds_read_b128 v[232:235], v1 offset:2048
    ds_read_b128 v[236:239], v1 offset:3072
    ds_read_b128 v[240:243], v1 offset:4096
    ds_read_b128 v[244:247], v1 offset:5120
    s_waitcnt lgkmcnt(3)
    v_mfma_f32_16x16x32_bf16 v[160:163], v[224:227], v[32:35], 0
    s_add_u32 s61, s47, 0
    buffer_load_dword v19, v28, s[8:11], s61 offen sc1
    v_mfma_f32_16x16x32_bf16 v[164:167], v[224:227], v[36:39], 0
    ds_read_b128 v[224:227], v1 offset:6144
    v_mfma_f32_16x16x32_bf16 v[168:171], v[228:231], v[32:35], 0
    v_mfma_f32_16x16x32_bf16 v[172:175], v[228:231], v[36:39], 0
    ds_read_b128 v[228:231], v1 offset:7168
    v_mfma_f32_16x16x32_bf16 v[176:179], v[232:235], v[32:35], 0
    s_add_u32 s60, s34, 720896
    buffer_load_dwordx4 v[212:215], v1, s[8:11], s60 offen sc1
    v_mfma_f32_16x16x32_bf16 v[180:183], v[232:235], v[36:39], 0
    s_waitcnt lgkmcnt(2)
    ds_read_b128 v[232:235], v1 offset:8192
    v_mfma_f32_16x16x32_bf16 v[184:187], v[236:239], v[32:35], 0
    v_mfma_f32_16x16x32_bf16 v[188:191], v[236:239], v[36:39], 0
    ds_read_b128 v[236:239], v1 offset:9216
    v_mfma_f32_16x16x32_bf16 v[192:195], v[32:35], v[240:243], 0
    v_mfma_f32_16x16x32_bf16 v[196:199], v[36:39], v[240:243], 0
    ds_read_b128 v[240:243], v1 offset:10240
    v_mfma_f32_16x16x32_bf16 v[200:203], v[32:35], v[244:247], 0
    buffer_load_dwordx4 v[216:219], v1, s[8:11], s60 offen offset:1024 sc1
    v_mfma_f32_16x16x32_bf16 v[204:207], v[36:39], v[244:247], 0
    s_waitcnt lgkmcnt(2)
    ds_read_b128 v[244:247], v1 offset:11264
    v_mfma_f32_16x16x32_bf16 v[160:163], v[224:227], v[40:43], v[160:163]
    s_add_u32 m0, s96, 102400
    v_mfma_f32_16x16x32_bf16 v[164:167], v[224:227], v[44:47], v[164:167]
    s_add_u32 s15, s14, 0
    ds_read_b128 v[224:227], v1 offset:12288
    v_mfma_f32_16x16x32_bf16 v[168:171], v[228:231], v[40:43], v[168:171]
    buffer_load_dwordx4 v21, s[80:83], s15 offen lds
    v_mfma_f32_16x16x32_bf16 v[172:175], v[228:231], v[44:47], v[172:175]
    ds_read_b128 v[228:231], v1 offset:13312
    v_mfma_f32_16x16x32_bf16 v[176:179], v[232:235], v[40:43], v[176:179]
    v_mfma_f32_16x16x32_bf16 v[180:183], v[232:235], v[44:47], v[180:183]
    s_waitcnt lgkmcnt(2)
    ds_read_b128 v[232:235], v1 offset:14336
    s_add_u32 m0, s96, 103424
    v_mfma_f32_16x16x32_bf16 v[184:187], v[236:239], v[40:43], v[184:187]
    s_add_u32 s15, s14, 128
    buffer_load_dwordx4 v21, s[80:83], s15 offen lds
    v_mfma_f32_16x16x32_bf16 v[188:191], v[236:239], v[44:47], v[188:191]
    ds_read_b128 v[236:239], v1 offset:15360
    v_mfma_f32_16x16x32_bf16 v[192:195], v[40:43], v[240:243], v[192:195]
    v_mfma_f32_16x16x32_bf16 v[196:199], v[44:47], v[240:243], v[196:199]
    s_waitcnt vmcnt(9)
    s_barrier
    ds_read_b128 v[240:243], v1 offset:16384
    v_mfma_f32_16x16x32_bf16 v[200:203], v[40:43], v[244:247], v[200:203]
    s_add_u32 s57, s98, 49152
    s_add_u32 m0, s97, 49152
    v_mfma_f32_16x16x32_bf16 v[204:207], v[44:47], v[244:247], v[204:207]
    s_waitcnt lgkmcnt(2)
    ds_read_b128 v[244:247], v1 offset:17408
    v_mfma_f32_16x16x32_bf16 v[160:163], v[224:227], v[48:51], v[160:163]
    buffer_load_dwordx4 v1, s[8:11], s57 offen offset:0 sc1 lds
    v_mfma_f32_16x16x32_bf16 v[164:167], v[224:227], v[52:55], v[164:167]
    ds_read_b128 v[224:227], v1 offset:18432
    v_mfma_f32_16x16x32_bf16 v[168:171], v[228:231], v[48:51], v[168:171]
    v_mfma_f32_16x16x32_bf16 v[172:175], v[228:231], v[52:55], v[172:175]
    ds_read_b128 v[228:231], v1 offset:19456
    v_mfma_f32_16x16x32_bf16 v[176:179], v[232:235], v[48:51], v[176:179]
    buffer_load_dwordx4 v1, s[8:11], s57 offen offset:1024 sc1 lds
    v_mfma_f32_16x16x32_bf16 v[180:183], v[232:235], v[52:55], v[180:183]
    s_waitcnt lgkmcnt(2)
    ds_read_b128 v[232:235], v1 offset:20480
    v_mfma_f32_16x16x32_bf16 v[184:187], v[236:239], v[48:51], v[184:187]
    v_mfma_f32_16x16x32_bf16 v[188:191], v[236:239], v[52:55], v[188:191]
    ds_read_b128 v[236:239], v1 offset:21504
    v_mfma_f32_16x16x32_bf16 v[192:195], v[48:51], v[240:243], v[192:195]
    buffer_load_dwordx4 v1, s[8:11], s57 offen offset:2048 sc1 lds
    v_mfma_f32_16x16x32_bf16 v[196:199], v[52:55], v[240:243], v[196:199]
    ds_read_b128 v[240:243], v1 offset:22528
    v_mfma_f32_16x16x32_bf16 v[200:203], v[48:51], v[244:247], v[200:203]
    v_mfma_f32_16x16x32_bf16 v[204:207], v[52:55], v[244:247], v[204:207]
    s_waitcnt lgkmcnt(2)
    ds_read_b128 v[244:247], v1 offset:23552
    v_mfma_f32_16x16x32_bf16 v[160:163], v[224:227], v[56:59], v[160:163]
    buffer_load_dwordx4 v1, s[8:11], s57 offen offset:3072 sc1 lds
    v_mfma_f32_16x16x32_bf16 v[164:167], v[224:227], v[60:63], v[164:167]
    ds_read_b128 v[224:227], v1 offset:24576
    v_mfma_f32_16x16x32_bf16 v[168:171], v[228:231], v[56:59], v[168:171]
    v_mfma_f32_16x16x32_bf16 v[172:175], v[228:231], v[60:63], v[172:175]
    ds_read_b128 v[228:231], v1 offset:25600
    v_mfma_f32_16x16x32_bf16 v[176:179], v[232:235], v[56:59], v[176:179]
    s_add_u32 s57, s98, 65536
    s_add_u32 m0, s97, 65536
    v_mfma_f32_16x16x32_bf16 v[180:183], v[232:235], v[60:63], v[180:183]
    s_waitcnt lgkmcnt(2)
    ds_read_b128 v[232:235], v1 offset:26624
    v_mfma_f32_16x16x32_bf16 v[184:187], v[236:239], v[56:59], v[184:187]
    buffer_load_dwordx4 v1, s[8:11], s57 offen offset:0 sc1 lds
    v_mfma_f32_16x16x32_bf16 v[188:191], v[236:239], v[60:63], v[188:191]
    ds_read_b128 v[236:239], v1 offset:27648
    v_mfma_f32_16x16x32_bf16 v[192:195], v[56:59], v[240:243], v[192:195]
    v_mfma_f32_16x16x32_bf16 v[196:199], v[60:63], v[240:243], v[196:199]
    ds_read_b128 v[240:243], v1 offset:28672
    v_mfma_f32_16x16x32_bf16 v[200:203], v[56:59], v[244:247], v[200:203]
    buffer_load_dwordx4 v1, s[8:11], s57 offen offset:1024 sc1 lds
    v_mfma_f32_16x16x32_bf16 v[204:207], v[60:63], v[244:247], v[204:207]
    s_waitcnt lgkmcnt(2)
    ds_read_b128 v[244:247], v1 offset:29696
    v_mfma_f32_16x16x32_bf16 v[160:163], v[224:227], v[64:67], v[160:163]
    v_add_u32 v61, 98304, v6
    s_lshr_b32 s62, s39, 1
    v_mfma_f32_16x16x32_bf16 v[164:167], v[224:227], v[68:71], v[164:167]
    ds_read_b128 v[224:227], v1 offset:30720
    v_add_u32 v62, s62, v61
    v_mfma_f32_16x16x32_bf16 v[168:171], v[228:231], v[64:67], v[168:171]
    s_waitcnt vmcnt(10)
    v_cmp_ne_u32 vcc, s26, v19
    v_accvgpr_read_b32 v40, a240
    v_mfma_f32_16x16x32_bf16 v[172:175], v[228:231], v[68:71], v[172:175]
    ds_read_b128 v[228:231], v1 offset:31744
    v_mfma_f32_16x16x32_bf16 v[176:179], v[232:235], v[64:67], v[176:179]
    v_accvgpr_read_b32 v41, a241
    v_mfma_f32_16x16x32_bf16 v[180:183], v[232:235], v[68:71], v[180:183]
    s_waitcnt lgkmcnt(2)
    s_barrier
    ds_read_b128 v[232:235], v1 offset:32768
    v_mfma_f32_16x16x32_bf16 v[184:187], v[236:239], v[64:67], v[184:187]
    s_and_b64 vcc, vcc, s[54:55]
    s_cbranch_scc1 L_lspin_14
L_lback_15:
    s_add_u32 s61, s46, 737344
    v_mfma_f32_16x16x32_bf16 v[188:191], v[236:239], v[68:71], v[188:191]
    ds_read_b128 v[236:239], v1 offset:33792
    v_and_b32 v19, 7, v0
    v_mfma_f32_16x16x32_bf16 v[192:195], v[64:67], v[240:243], v[192:195]
    v_accvgpr_read_b32 v42, a242
    v_accvgpr_read_b32 v43, a243
    v_mfma_f32_16x16x32_bf16 v[196:199], v[68:71], v[240:243], v[196:199]
    ds_read_b128 v[240:243], v1 offset:34816
    v_lshl_add_u32 v19, v19, 3, v28
    v_mfma_f32_16x16x32_bf16 v[200:203], v[64:67], v[244:247], v[200:203]
    v_accvgpr_read_b32 v44, a244
    v_mfma_f32_16x16x32_bf16 v[204:207], v[68:71], v[244:247], v[204:207]
    s_waitcnt lgkmcnt(2)
    ds_read_b128 v[244:247], v1 offset:35840
    v_mfma_f32_16x16x32_bf16 v[160:163], v[224:227], v[72:75], v[160:163]
    v_accvgpr_read_b32 v32, a227
    v_xor_b32 v33, 64, v32
    v_mfma_f32_16x16x32_bf16 v[164:167], v[224:227], v[76:79], v[164:167]
    ds_read_b128 v[224:227], v1 offset:36864
    v_accvgpr_read_b32 v45, a245
    v_mfma_f32_16x16x32_bf16 v[168:171], v[228:231], v[72:75], v[168:171]
    buffer_load_dwordx2 v[220:221], v19, s[8:11], s61 offen sc1
    v_mfma_f32_16x16x32_bf16 v[172:175], v[228:231], v[76:79], v[172:175]
    ds_read_b128 v[228:231], v1 offset:37888
    ds_read_b128 v[64:67], v17 offset:0
    v_mfma_f32_16x16x32_bf16 v[176:179], v[232:235], v[72:75], v[176:179]
    v_accvgpr_read_b32 v46, a246
    v_accvgpr_read_b32 v47, a247
    v_mfma_f32_16x16x32_bf16 v[180:183], v[232:235], v[76:79], v[180:183]
    s_waitcnt lgkmcnt(3)
    ds_read_b128 v[232:235], v1 offset:38912
    v_mfma_f32_16x16x32_bf16 v[184:187], v[236:239], v[72:75], v[184:187]
    buffer_load_dwordx4 v1, s[8:11], s57 offen offset:2048 sc1 lds
    v_mfma_f32_16x16x32_bf16 v[188:191], v[236:239], v[76:79], v[188:191]
    ds_read_b128 v[236:239], v1 offset:39936
    v_accvgpr_read_b32 v48, a248
    v_mfma_f32_16x16x32_bf16 v[192:195], v[72:75], v[240:243], v[192:195]
    buffer_load_dwordx4 v1, s[8:11], s57 offen offset:3072 sc1 lds
    v_mfma_f32_16x16x32_bf16 v[196:199], v[76:79], v[240:243], v[196:199]
    s_add_u32 s57, s98, 81920
    ds_read_b128 v[240:243], v1 offset:40960
    ds_read_b128 v[68:71], v17 offset:6144
    v_mfma_f32_16x16x32_bf16 v[200:203], v[72:75], v[244:247], v[200:203]
    s_add_u32 m0, s97, 81920
    v_accvgpr_read_b32 v49, a249
    v_accvgpr_read_b32 v50, a250
    v_mfma_f32_16x16x32_bf16 v[204:207], v[76:79], v[244:247], v[204:207]
    s_waitcnt lgkmcnt(3)
    ds_read_b128 v[244:247], v1 offset:41984
    v_mfma_f32_16x16x32_bf16 v[160:163], v[224:227], v[80:83], v[160:163]
    buffer_load_dwordx4 v1, s[8:11], s57 offen offset:0 sc1 lds
    v_mfma_f32_16x16x32_bf16 v[164:167], v[224:227], v[84:87], v[164:167]
    ds_read_b128 v[224:227], v1 offset:43008
    v_accvgpr_read_b32 v51, a251
    v_mfma_f32_16x16x32_bf16 v[168:171], v[228:231], v[80:83], v[168:171]
    buffer_load_dwordx4 v1, s[8:11], s57 offen offset:1024 sc1 lds
    v_mfma_f32_16x16x32_bf16 v[172:175], v[228:231], v[84:87], v[172:175]
    ds_read_b128 v[228:231], v1 offset:44032
    ds_read_b128 v[72:75], v17 offset:12288
    v_mfma_f32_16x16x32_bf16 v[176:179], v[232:235], v[80:83], v[176:179]
    v_accvgpr_read_b32 v52, a252
    v_accvgpr_read_b32 v53, a253
    v_mfma_f32_16x16x32_bf16 v[180:183], v[232:235], v[84:87], v[180:183]
    s_waitcnt lgkmcnt(3)
    ds_read_b128 v[232:235], v1 offset:45056
    v_mfma_f32_16x16x32_bf16 v[184:187], v[236:239], v[80:83], v[184:187]
    buffer_load_dwordx4 v1, s[8:11], s57 offen offset:2048 sc1 lds
    v_mfma_f32_16x16x32_bf16 v[188:191], v[236:239], v[84:87], v[188:191]
    ds_read_b128 v[236:239], v1 offset:46080
    v_mov_b32 v54, s50
    v_mfma_f32_16x16x32_bf16 v[192:195], v[80:83], v[240:243], v[192:195]
    buffer_load_dwordx4 v1, s[8:11], s57 offen offset:3072 sc1 lds
    v_mfma_f32_16x16x32_bf16 v[196:199], v[84:87], v[240:243], v[196:199]
    s_add_u32 s57, s35, 98304
    ds_read_b128 v[240:243], v1 offset:47104
    ds_read_b128 v[76:79], v17 offset:18432
    v_mfma_f32_16x16x32_bf16 v[200:203], v[80:83], v[244:247], v[200:203]
    s_add_u32 m0, s39, 98304
    v_mov_b32 v55, s50
    v_accvgpr_read_b32 v56, a230
    v_mfma_f32_16x16x32_bf16 v[204:207], v[84:87], v[244:247], v[204:207]
    s_waitcnt lgkmcnt(3)
    ds_read_b128 v[244:247], v1 offset:48128
    v_mfma_f32_16x16x32_bf16 v[160:163], v[224:227], v[88:91], v[160:163]
    buffer_load_dwordx4 v1, s[8:11], s57 offen offset:0 sc1 lds
    v_mfma_f32_16x16x32_bf16 v[164:167], v[224:227], v[92:95], v[164:167]
    s_waitcnt vmcnt(14)
    s_waitcnt vmcnt(10)
    s_barrier
    ds_read_b128 v[224:227], v1 offset:49152
    v_mfma_f32_16x16x32_bf16 v[168:171], v[228:231], v[88:91], v[168:171]
    s_add_u32 s57, s37, 0
    v_accvgpr_read_b32 v59, a231
    s_add_u32 s62, s96, 114688
    v_mfma_f32_16x16x32_bf16 v[172:175], v[228:231], v[92:95], v[172:175]
    s_add_u32 m0, s97, 131072
    ds_read_b128 v[228:231], v1 offset:50176
    ds_read_b128 v[80:83], v17 offset:24576
    v_mfma_f32_16x16x32_bf16 v[176:179], v[232:235], v[88:91], v[176:179]
    buffer_load_dwordx4 v1, s[8:11], s57 offen offset:0 sc1 lds
    v_mfma_f32_16x16x32_bf16 v[180:183], v[232:235], v[92:95], v[180:183]
    s_waitcnt lgkmcnt(3)
    ds_read_b128 v[232:235], v1 offset:51200
    v_add_u32 v57, v56, v59
    v_mfma_f32_16x16x32_bf16 v[184:187], v[236:239], v[88:91], v[184:187]
    ds_read_b128 v[252:255], v32 offset:0
    v_lshl_add_u32 v60, v0, 3, s62
    v_mfma_f32_16x16x32_bf16 v[188:191], v[236:239], v[92:95], v[188:191]
    ds_read_b128 v[236:239], v1 offset:52224
    v_mfma_f32_16x16x32_bf16 v[192:195], v[88:91], v[240:243], v[192:195]
    ds_read_b128 v[36:39], v33 offset:0
    v_add_u32 v58, v57, v59
    v_mfma_f32_16x16x32_bf16 v[196:199], v[92:95], v[240:243], v[196:199]
    ds_read_b128 v[240:243], v1 offset:53248
    ds_read_b128 v[84:87], v17 offset:30720
    v_mfma_f32_16x16x32_bf16 v[200:203], v[88:91], v[244:247], v[200:203]
    buffer_load_dwordx4 v1, s[8:11], s57 offen offset:1024 sc1 lds
    v_mfma_f32_16x16x32_bf16 v[204:207], v[92:95], v[244:247], v[204:207]
    s_waitcnt lgkmcnt(5)
    ds_read_b128 v[244:247], v1 offset:54272
    v_add_u32 v59, v58, v59
    v_mfma_f32_16x16x32_bf16 v[160:163], v[224:227], v[96:99], v[160:163]
    s_waitcnt vmcnt(9)
    buffer_load_dwordx4 v1, s[8:11], s57 offen offset:2048 sc1 lds
    v_mfma_f32_16x16x32_bf16 v[164:167], v[224:227], v[100:103], v[164:167]
    ds_read_b128 v[224:227], v1 offset:55296
    v_add_f32_dpp v220, v220, v220 row_ror:8 row_mask:0xf bank_mask:0xf
    v_mfma_f32_16x16x32_bf16 v[168:171], v[228:231], v[96:99], v[168:171]
    buffer_load_dwordx4 v1, s[8:11], s57 offen offset:3072 sc1 lds
    v_mfma_f32_16x16x32_bf16 v[172:175], v[228:231], v[100:103], v[172:175]
    s_waitcnt lgkmcnt(6)
    ds_read_b128 v[228:231], v1 offset:56320
    ds_read_b128 v[88:91], v17 offset:36864
    v_mfma_f32_16x16x32_bf16 v[208:211], v[252:255], v[64:67], 0
    s_add_u32 s57, s37, 16384
    ds_read_b128 v[252:255], v32 offset:1024
    v_add_f32_dpp v221, v221, v221 row_ror:8 row_mask:0xf bank_mask:0xf
    v_mfma_f32_16x16x32_bf16 v[176:179], v[232:235], v[96:99], v[176:179]
    s_add_u32 m0, s97, 147456
    v_add_f32 v212, v212, v214
    v_mfma_f32_16x16x32_bf16 v[180:183], v[232:235], v[100:103], v[180:183]
    s_waitcnt lgkmcnt(4)
    ds_read_b128 v[232:235], v1 offset:57344
    v_mfma_f32_16x16x32_bf16 v[184:187], v[236:239], v[96:99], v[184:187]
    buffer_load_dwordx4 v1, s[8:11], s57 offen offset:0 sc1 lds
    v_mfma_f32_16x16x32_bf16 v[188:191], v[236:239], v[100:103], v[188:191]
    ds_read_b128 v[236:239], v1 offset:58368
    v_add_f32 v213, v213, v215
    v_mfma_f32_16x16x32_bf16 v[192:195], v[96:99], v[240:243], v[192:195]
    buffer_load_dwordx4 v1, s[8:11], s57 offen offset:1024 sc1 lds
    v_mfma_f32_16x16x32_bf16 v[196:199], v[100:103], v[240:243], v[196:199]
    ds_read_b128 v[240:243], v1 offset:59392
    ds_read_b128 v[92:95], v17 offset:43008
    v_mfma_f32_16x16x32_bf16 v[208:211], v[36:39], v[68:71], v[208:211]
    ds_read_b128 v[36:39], v33 offset:1024
    v_add_f32 v216, v216, v218
    v_mfma_f32_16x16x32_bf16 v[200:203], v[96:99], v[244:247], v[200:203]
    buffer_load_dwordx4 v1, s[8:11], s57 offen offset:2048 sc1 lds
    v_mfma_f32_16x16x32_bf16 v[204:207], v[100:103], v[244:247], v[204:207]
    s_waitcnt lgkmcnt(4)
    ds_read_b128 v[244:247], v1 offset:60416
    v_add_f32 v217, v217, v219
    v_mfma_f32_16x16x32_bf16 v[160:163], v[224:227], v[104:107], v[160:163]
    v_accvgpr_read_b32 v63, a234
    v_mov_b32 v222, v220
    v_mfma_f32_16x16x32_bf16 v[164:167], v[224:227], v[108:111], v[164:167]
    ds_read_b128 v[224:227], v1 offset:61440
    v_mov_b32 v223, v221
    v_mfma_f32_16x16x32_bf16 v[168:171], v[228:231], v[104:107], v[168:171]
    buffer_load_dwordx4 v1, s[8:11], s57 offen offset:3072 sc1 lds
    v_mfma_f32_16x16x32_bf16 v[172:175], v[228:231], v[108:111], v[172:175]
    ds_read_b128 v[228:231], v1 offset:62464
    ds_read_b128 v[96:99], v18 offset:0
    v_mfma_f32_16x16x32_bf16 v[208:211], v[252:255], v[72:75], v[208:211]
    ds_read_b128 v[252:255], v32 offset:2048
    v_mfma_f32_16x16x32_bf16 v[176:179], v[232:235], v[104:107], v[176:179]
    buffer_load_dword v63, v63, s[8:11], 0 offen sc1
    v_mfma_f32_16x16x32_bf16 v[180:183], v[232:235], v[108:111], v[180:183]
    s_waitcnt lgkmcnt(4)
    ds_read_b128 v[232:235], v1 offset:63488
    v_mfma_f32_16x16x32_bf16 v[184:187], v[236:239], v[104:107], v[184:187]
    v_permlane32_swap_b32 v212, v216
    v_mfma_f32_16x16x32_bf16 v[188:191], v[236:239], v[108:111], v[188:191]
    ds_read_b128 v[236:239], v1 offset:64512
    v_mfma_f32_16x16x32_bf16 v[192:195], v[104:107], v[240:243], v[192:195]
    v_permlane32_swap_b32 v213, v217
    v_mfma_f32_16x16x32_bf16 v[196:199], v[108:111], v[240:243], v[196:199]
    s_waitcnt vmcnt(14)
    s_barrier
    ds_read_b128 v[240:243], v2 offset:0
    ds_read_b128 v[100:103], v18 offset:6144
    v_mfma_f32_16x16x32_bf16 v[208:211], v[36:39], v[76:79], v[208:211]
    s_add_u32 s57, s37, 32768
    ds_read_b128 v[36:39], v33 offset:2048
    s_add_u32 m0, s97, 0
    v_mfma_f32_16x16x32_bf16 v[200:203], v[104:107], v[244:247], v[200:203]
    buffer_load_dwordx4 v1, s[8:11], s57 offen offset:0 sc1 lds
    v_mfma_f32_16x16x32_bf16 v[204:207], v[108:111], v[244:247], v[204:207]
    s_waitcnt lgkmcnt(4)
    ds_read_b128 v[244:247], v2 offset:1024
    v_mfma_f32_16x16x32_bf16 v[160:163], v[224:227], v[112:115], v[160:163]
    v_permlane32_swap_b32 v220, v222
    v_mfma_f32_16x16x32_bf16 v[164:167], v[224:227], v[116:119], v[164:167]
    ds_read_b128 v[224:227], v2 offset:2048
    v_mfma_f32_16x16x32_bf16 v[168:171], v[228:231], v[112:115], v[168:171]
    buffer_load_dwordx4 v1, s[8:11], s57 offen offset:1024 sc1 lds
    v_mfma_f32_16x16x32_bf16 v[172:175], v[228:231], v[116:119], v[172:175]
    ds_read_b128 v[228:231], v2 offset:3072
    ds_read_b128 v[104:107], v18 offset:12288
    v_permlane32_swap_b32 v221, v223
    v_mfma_f32_16x16x32_bf16 v[208:211], v[252:255], v[80:83], v[208:211]
    ds_read_b128 v[252:255], v32 offset:3072
    v_add_f32 v212, v212, v216
    v_mfma_f32_16x16x32_bf16 v[176:179], v[232:235], v[112:115], v[176:179]
    buffer_load_dwordx4 v1, s[8:11], s57 offen offset:2048 sc1 lds
    v_mfma_f32_16x16x32_bf16 v[180:183], v[232:235], v[116:119], v[180:183]
    s_waitcnt lgkmcnt(4)
    ds_read_b128 v[232:235], v2 offset:4096
    v_add_f32 v213, v213, v217
    v_mfma_f32_16x16x32_bf16 v[184:187], v[236:239], v[112:115], v[184:187]
    v_add_f32 v220, v220, v222
    v_add_f32 v221, v221, v223
    v_mfma_f32_16x16x32_bf16 v[188:191], v[236:239], v[116:119], v[188:191]
    ds_read_b128 v[236:239], v2 offset:5120
    v_mfma_f32_16x16x32_bf16 v[192:195], v[112:115], v[240:243], v[192:195]
    buffer_load_dwordx4 v1, s[8:11], s57 offen offset:3072 sc1 lds
    v_mfma_f32_16x16x32_bf16 v[196:199], v[116:119], v[240:243], v[196:199]
    ds_read_b128 v[240:243], v2 offset:6144
    ds_read_b128 v[108:111], v18 offset:18432
    v_mfma_f32_16x16x32_bf16 v[208:211], v[36:39], v[84:87], v[208:211]
    s_add_u32 s57, s37, 49152
    ds_read_b128 v[36:39], v33 offset:3072
    s_add_u32 m0, s97, 16384
    v_mfma_f32_16x16x32_bf16 v[200:203], v[112:115], v[244:247], v[200:203]
    v_permlane16_swap_b32 v212, v220
    v_mfma_f32_16x16x32_bf16 v[204:207], v[116:119], v[244:247], v[204:207]
    s_waitcnt lgkmcnt(4)
    ds_read_b128 v[244:247], v2 offset:7168
    v_mfma_f32_16x16x32_bf16 v[160:163], v[224:227], v[120:123], v[160:163]
    buffer_load_dwordx4 v1, s[8:11], s57 offen offset:0 sc1 lds
    v_permlane16_swap_b32 v213, v221
    v_mfma_f32_16x16x32_bf16 v[164:167], v[224:227], v[124:127], v[164:167]
    ds_read_b128 v[224:227], v2 offset:8192
    v_add_f32 v212, v212, v220
    v_mfma_f32_16x16x32_bf16 v[168:171], v[228:231], v[120:123], v[168:171]
    buffer_load_dwordx4 v1, s[8:11], s57 offen offset:1024 sc1 lds
    v_mfma_f32_16x16x32_bf16 v[172:175], v[228:231], v[124:127], v[172:175]
    ds_read_b128 v[228:231], v2 offset:9216
    ds_read_b128 v[112:115], v18 offset:24576
    v_mfma_f32_16x16x32_bf16 v[208:211], v[252:255], v[88:91], v[208:211]
    ds_read_b128 v[252:255], v32 offset:4096
    v_add_f32 v213, v213, v221
    v_mfma_f32_16x16x32_bf16 v[176:179], v[232:235], v[120:123], v[176:179]
    buffer_load_dwordx4 v1, s[8:11], s57 offen offset:2048 sc1 lds
    v_mul_f32 v212, 0x3b000000, v212
    v_mfma_f32_16x16x32_bf16 v[180:183], v[232:235], v[124:127], v[180:183]
    s_waitcnt lgkmcnt(4)
    ds_read_b128 v[232:235], v2 offset:10240
    v_mul_f32 v214, v212, v212
    v_mfma_f32_16x16x32_bf16 v[184:187], v[236:239], v[120:123], v[184:187]
    v_mul_f32 v213, 0x3b000000, v213
    v_sub_f32 v213, v213, v214
    v_mfma_f32_16x16x32_bf16 v[188:191], v[236:239], v[124:127], v[188:191]
    ds_read_b128 v[236:239], v2 offset:11264
    v_max_f32 v213, 0, v213
    v_mfma_f32_16x16x32_bf16 v[192:195], v[120:123], v[240:243], v[192:195]
    buffer_load_dwordx4 v1, s[8:11], s57 offen offset:3072 sc1 lds
    v_mfma_f32_16x16x32_bf16 v[196:199], v[124:127], v[240:243], v[196:199]
    ds_read_b128 v[240:243], v2 offset:12288
    v_cvt_pk_bf16_f32 v213, v213, v213
    v_mfma_f32_16x16x32_bf16 v[208:211], v[36:39], v[92:95], v[208:211]
    ds_read_b128 v[36:39], v33 offset:4096
    v_lshlrev_b32 v213, 16, v213
    v_mfma_f32_16x16x32_bf16 v[200:203], v[120:123], v[244:247], v[200:203]
    v_accvgpr_read_b32 v34, a236
    s_add_u32 s61, 0, 0
    v_mfma_f32_16x16x32_bf16 v[204:207], v[124:127], v[244:247], v[204:207]
    s_waitcnt lgkmcnt(3)
    ds_read_b128 v[244:247], v2 offset:13312
    v_add_f32 v213, 0x3727c5ac, v213
    v_mfma_f32_16x16x32_bf16 v[160:163], v[224:227], v[128:131], v[160:163]
    s_add_u32 s15, s13, L_wo0-L_pc+0
    s_min_u32 s15, s15, L_code_end-L_pc-4
    v_mov_b32 v29, s15
    v_mfma_f32_16x16x32_bf16 v[164:167], v[224:227], v[132:135], v[164:167]
    s_waitcnt vmcnt(8)
    ds_read_b128 v[224:227], v2 offset:14336
    v_cmp_ne_u32 vcc, s26, v63
    v_mfma_f32_16x16x32_bf16 v[168:171], v[228:231], v[128:131], v[168:171]
    buffer_load_dword a255, v34, s[8:11], s61 offen sc1
    v_mfma_f32_16x16x32_bf16 v[172:175], v[228:231], v[132:135], v[172:175]
    ds_read_b128 v[228:231], v2 offset:15360
    v_cvt_pk_bf16_f32 v213, v213, v213
    v_mfma_f32_16x16x32_bf16 v[208:211], v[252:255], v[96:99], v[208:211]
    ds_read_b128 v[252:255], v32 offset:5120
    v_lshlrev_b32 v213, 16, v213
    v_mfma_f32_16x16x32_bf16 v[176:179], v[232:235], v[128:131], v[176:179]
    global_load_dword a255, v29, s[4:5]
    v_mfma_f32_16x16x32_bf16 v[180:183], v[232:235], v[132:135], v[180:183]
    s_waitcnt lgkmcnt(3)
    s_barrier
    ds_read_b128 v[232:235], v2 offset:16384
    v_mfma_f32_16x16x32_bf16 v[184:187], v[236:239], v[128:131], v[184:187]
    s_and_b64 vcc, vcc, exec
    s_cbranch_scc1 L_lspin_16
L_lback_17:
    s_add_u32 s58, s38, 8192
    v_mfma_f32_16x16x32_bf16 v[188:191], v[236:239], v[132:135], v[188:191]
    ds_read_b128 v[236:239], v2 offset:17408
    v_mfma_f32_16x16x32_bf16 v[192:195], v[128:131], v[240:243], v[192:195]
    buffer_load_dwordx4 a[32:35], v1, s[8:11], s58 offen offset:0 sc1
    v_mfma_f32_16x16x32_bf16 v[196:199], v[132:135], v[240:243], v[196:199]
    ds_read_b128 v[240:243], v2 offset:18432
    ds_read_b128 v[116:119], v18 offset:30720
    v_sqrt_f32 v213, v213
    v_mfma_f32_16x16x32_bf16 v[208:211], v[36:39], v[100:103], v[208:211]
    ds_read_b128 v[36:39], v33 offset:5120
    v_cvt_pk_bf16_f32 v213, v213, v213
    v_mfma_f32_16x16x32_bf16 v[200:203], v[128:131], v[244:247], v[200:203]
    buffer_load_dwordx4 a[36:39], v1, s[8:11], s58 offen offset:1024 sc1
    v_mfma_f32_16x16x32_bf16 v[204:207], v[132:135], v[244:247], v[204:207]
    s_waitcnt lgkmcnt(4)
    ds_read_b128 v[244:247], v2 offset:19456
    v_lshlrev_b32 v213, 16, v213
    v_mfma_f32_16x16x32_bf16 v[160:163], v[224:227], v[136:139], v[160:163]
    v_rcp_f32 v213, v213
    v_mfma_f32_16x16x32_bf16 v[164:167], v[224:227], v[140:143], v[164:167]
    ds_read_b128 v[224:227], v2 offset:20480
    v_cvt_pk_bf16_f32 v212, -v212, -v212
    v_mfma_f32_16x16x32_bf16 v[168:171], v[228:231], v[136:139], v[168:171]
    buffer_load_dwordx4 a[40:43], v1, s[8:11], s58 offen offset:2048 sc1
    v_mfma_f32_16x16x32_bf16 v[172:175], v[228:231], v[140:143], v[172:175]
    ds_read_b128 v[228:231], v2 offset:21504
    ds_read_b128 v[120:123], v18 offset:36864
    v_mfma_f32_16x16x32_bf16 v[208:211], v[252:255], v[104:107], v[208:211]
    ds_read_b128 v[252:255], v32 offset:6144
    v_add_u32 v19, s48, v6
    v_mfma_f32_16x16x32_bf16 v[176:179], v[232:235], v[136:139], v[176:179]
    v_and_or_b32 v30, v6, 63, s48
    v_and_or_b32 v31, v0, 48, s48
    v_mfma_f32_16x16x32_bf16 v[180:183], v[232:235], v[140:143], v[180:183]
    s_waitcnt lgkmcnt(4)
    ds_read_b128 v[232:235], v2 offset:22528
    ds_write2st64_b32 v19, v213, v212 offset0:0 offset1:1
    v_mfma_f32_16x16x32_bf16 v[184:187], v[236:239], v[136:139], v[184:187]
    buffer_load_dwordx4 a[44:47], v1, s[8:11], s58 offen offset:3072 sc1
    v_mfma_f32_16x16x32_bf16 v[188:191], v[236:239], v[140:143], v[188:191]
    ds_read_b128 v[236:239], v2 offset:23552
    ds_read2_b32 v[20:21], v30 offset0:64 offset1:64
    v_mfma_f32_16x16x32_bf16 v[192:195], v[136:139], v[240:243], v[192:195]
    ds_read2_b32 v[22:23], v30 offset0:96 offset1:96
    ds_read2_b32 v[24:25], v30 offset0:80 offset1:80
    v_mfma_f32_16x16x32_bf16 v[196:199], v[140:143], v[240:243], v[196:199]
    ds_read_b128 v[240:243], v2 offset:24576
    ds_read2_b32 v[26:27], v30 offset0:0 offset1:32
    v_mfma_f32_16x16x32_bf16 v[208:211], v[36:39], v[108:111], v[208:211]
    ds_read_b128 v[36:39], v33 offset:6144
    ds_read_b128 v[212:215], v31 offset:0
    v_mfma_f32_16x16x32_bf16 v[200:203], v[136:139], v[244:247], v[200:203]
    ds_read_b128 v[216:219], v31 offset:128
    v_mfma_f32_16x16x32_bf16 v[204:207], v[140:143], v[244:247], v[204:207]
    s_waitcnt lgkmcnt(10)
    ds_read_b128 v[244:247], v2 offset:25600
    s_add_u32 s58, s38, 12288
    v_mfma_f32_16x16x32_bf16 v[160:163], v[224:227], v[144:147], v[160:163]
    buffer_load_dwordx4 a[48:51], v1, s[8:11], s58 offen offset:0 sc1
    v_mfma_f32_16x16x32_bf16 v[164:167], v[224:227], v[148:151], v[164:167]
    ds_read_b128 v[224:227], v2 offset:26624
    ds_read_b128 v[220:223], v31 offset:64
    v_mfma_f32_16x16x32_bf16 v[168:171], v[228:231], v[144:147], v[168:171]
    v_mfma_f32_16x16x32_bf16 v[172:175], v[228:231], v[148:151], v[172:175]
    ds_read_b128 v[228:231], v2 offset:27648
    v_mfma_f32_16x16x32_bf16 v[208:211], v[252:255], v[112:115], v[208:211]
    ds_read_b128 v[252:255], v32 offset:7168
    v_mfma_f32_16x16x32_bf16 v[176:179], v[232:235], v[144:147], v[176:179]
    v_mfma_f32_16x16x32_bf16 v[180:183], v[232:235], v[148:151], v[180:183]
    s_waitcnt lgkmcnt(4)
    ds_read_b128 v[232:235], v2 offset:28672
    v_mfma_f32_16x16x32_bf16 v[184:187], v[236:239], v[144:147], v[184:187]
    buffer_load_dwordx4 a[52:55], v1, s[8:11], s58 offen offset:1024 sc1
    v_mfma_f32_16x16x32_bf16 v[188:191], v[236:239], v[148:151], v[188:191]
    ds_read_b128 v[236:239], v2 offset:29696
    v_mfma_f32_16x16x32_bf16 v[192:195], v[144:147], v[240:243], v[192:195]
    v_mfma_f32_16x16x32_bf16 v[196:199], v[148:151], v[240:243], v[196:199]
    ds_read_b128 v[240:243], v2 offset:30720
    ds_read_b128 v[124:127], v18 offset:43008
    v_mfma_f32_16x16x32_bf16 v[208:211], v[36:39], v[116:119], v[208:211]
    ds_read_b128 v[36:39], v33 offset:7168
    v_mfma_f32_16x16x32_bf16 v[200:203], v[144:147], v[244:247], v[200:203]
    v_mfma_f32_16x16x32_bf16 v[204:207], v[148:151], v[244:247], v[204:207]
    s_waitcnt lgkmcnt(4)
    ds_read_b128 v[244:247], v2 offset:31744
    v_mfma_f32_16x16x32_bf16 v[160:163], v[224:227], v[152:155], v[160:163]
    buffer_load_dwordx4 a[56:59], v1, s[8:11], s58 offen offset:2048 sc1
    v_mfma_f32_16x16x32_bf16 v[164:167], v[224:227], v[156:159], v[164:167]
    ds_read2st64_b32 v[224:225], v61 offset0:0 offset1:1
    v_mfma_f32_16x16x32_bf16 v[168:171], v[228:231], v[152:155], v[168:171]
    v_mfma_f32_16x16x32_bf16 v[172:175], v[228:231], v[156:159], v[172:175]
    ds_read2st64_b32 v[228:229], v61 offset0:2 offset1:3
    v_mfma_f32_16x16x32_bf16 v[208:211], v[252:255], v[120:123], v[208:211]
    ds_read2st64_b32 v[248:249], v62 offset0:4 offset1:5
    v_mfma_f32_16x16x32_bf16 v[176:179], v[232:235], v[152:155], v[176:179]
    buffer_load_dwordx4 a[60:63], v1, s[8:11], s58 offen offset:3072 sc1
    v_mfma_f32_16x16x32_bf16 v[180:183], v[232:235], v[156:159], v[180:183]
    s_waitcnt lgkmcnt(3)
    ds_read2st64_b32 v[232:233], v61 offset0:4 offset1:5
    v_mfma_f32_16x16x32_bf16 v[184:187], v[236:239], v[152:155], v[184:187]
    v_mfma_f32_16x16x32_bf16 v[188:191], v[236:239], v[156:159], v[188:191]
    ds_read2st64_b32 v[236:237], v61 offset0:6 offset1:7
    v_mfma_f32_16x16x32_bf16 v[192:195], v[152:155], v[240:243], v[192:195]
    v_mfma_f32_16x16x32_bf16 v[196:199], v[156:159], v[240:243], v[196:199]
    ds_read2st64_b32 v[240:241], v61 offset0:8 offset1:9
    v_mfma_f32_16x16x32_bf16 v[208:211], v[36:39], v[124:127], v[208:211]
    s_add_u32 s58, s38, 16384
    v_mfma_f32_16x16x32_bf16 v[200:203], v[152:155], v[244:247], v[200:203]
    buffer_load_dwordx4 a[64:67], v1, s[8:11], s58 offen offset:0 sc1
    v_mfma_f32_16x16x32_bf16 v[204:207], v[156:159], v[244:247], v[204:207]
    s_waitcnt lgkmcnt(3)
    ds_read2st64_b32 v[244:245], v61 offset0:10 offset1:11
    v_mfma_f32_16x16x16_bf16 v[208:211], v[24:25], v[248:249], v[208:211]
    s_waitcnt lgkmcnt(3)
    v_mul_f32 v28, 0x3eb8aa3b, v26
    v_mul_f32 v29, 0x3eb8aa3b, v27
    v_mfma_f32_16x16x16_bf16 v[160:163], v[224:225], v[20:21], v[160:163]
    v_mfma_f32_16x16x16_bf16 v[164:167], v[224:225], v[22:23], v[164:167]
    v_mfma_f32_16x16x16_bf16 v[168:171], v[228:229], v[20:21], v[168:171]
    v_mfma_f32_16x16x16_bf16 v[172:175], v[228:229], v[22:23], v[172:175]
    buffer_load_dwordx4 a[68:71], v1, s[8:11], s58 offen offset:1024 sc1
    v_mfma_f32_16x16x16_bf16 v[176:179], v[232:233], v[20:21], v[176:179]
    v_mul_f32 v208, v208, v220
    v_mul_f32 v209, v209, v221
    v_mfma_f32_16x16x16_bf16 v[180:183], v[232:233], v[22:23], v[180:183]
    s_waitcnt lgkmcnt(0)
    v_mul_f32 v210, v210, v222
    v_mul_f32 v211, v211, v223
    v_mfma_f32_16x16x16_bf16 v[184:187], v[236:237], v[20:21], v[184:187]
    v_cvt_pk_bf16_f32 v16, v208, v209
    v_cvt_pk_bf16_f32 v17, v210, v211
    v_mfma_f32_16x16x16_bf16 v[188:191], v[236:237], v[22:23], v[188:191]
    ds_write_b16 v56, v16
    v_cvt_pk_bf16_f32 v128, v160, v161
    v_mfma_f32_16x16x16_bf16 v[192:195], v[20:21], v[240:241], v[192:195]
    v_cvt_pk_bf16_f32 v129, v162, v163
    ds_write_b16_d16_hi v57, v16
    v_mfma_f32_16x16x16_bf16 v[196:199], v[22:23], v[240:241], v[196:199]
    v_cvt_pk_bf16_f32 v130, v164, v165
    v_cvt_pk_bf16_f32 v131, v166, v167
    v_mfma_f32_16x16x16_bf16 v[200:203], v[20:21], v[244:245], v[200:203]
    ds_write_b16 v58, v17
    v_cvt_pk_bf16_f32 v132, v168, v169
    v_mfma_f32_16x16x16_bf16 v[204:207], v[22:23], v[244:245], v[204:207]
    v_cvt_pk_bf16_f32 v133, v170, v171
    ds_write_b16_d16_hi v59, v17
    v_cvt_pk_bf16_f32 v134, v172, v173
    v_cvt_pk_bf16_f32 v135, v174, v175
    v_pk_mul_f32 v[180:181], v[180:181], v[26:27] op_sel:[0,1] op_sel_hi:[1,1]
    v_pk_mul_f32 v[182:183], v[182:183], v[26:27] op_sel:[0,1] op_sel_hi:[1,1]
    v_cvt_pk_bf16_f32 v140, v180, v181
    v_cvt_pk_bf16_f32 v141, v182, v183
    ds_write_b64 v60, v[140:141] offset:2048
    v_pk_mul_f32 v[176:177], v[176:177], v[26:27] op_sel:[0,0] op_sel_hi:[1,0]
    v_pk_mul_f32 v[178:179], v[178:179], v[26:27] op_sel:[0,0] op_sel_hi:[1,0]
    v_pk_mul_f32 v[188:189], v[188:189], v[26:27] op_sel:[0,1] op_sel_hi:[1,1]
    v_pk_mul_f32 v[190:191], v[190:191], v[26:27] op_sel:[0,1] op_sel_hi:[1,1]
    v_cvt_pk_bf16_f32 v146, v188, v189
    v_cvt_pk_bf16_f32 v147, v190, v191
    ds_write_b64 v60, v[146:147] offset:2560
    v_pk_mul_f32 v[184:185], v[184:185], v[26:27] op_sel:[0,0] op_sel_hi:[1,0]
    v_pk_mul_f32 v[186:187], v[186:187], v[26:27] op_sel:[0,0] op_sel_hi:[1,0]
    v_pk_mul_f32 v[196:197], v[196:197], v[216:217]
    v_pk_mul_f32 v[198:199], v[198:199], v[218:219]
    v_cvt_pk_bf16_f32 v152, v196, v197
    v_cvt_pk_bf16_f32 v153, v198, v199
    ds_write_b64 v60, v[152:153] offset:3072
    v_pk_mul_f32 v[192:193], v[192:193], v[212:213]
    v_pk_mul_f32 v[194:195], v[194:195], v[214:215]
    v_pk_mul_f32 v[204:205], v[204:205], v[216:217]
    v_pk_mul_f32 v[206:207], v[206:207], v[218:219]
    v_cvt_pk_bf16_f32 v158, v204, v205
    v_cvt_pk_bf16_f32 v159, v206, v207
    ds_write_b64 v60, v[158:159] offset:3584
    v_pk_mul_f32 v[200:201], v[200:201], v[212:213]
    v_pk_mul_f32 v[202:203], v[202:203], v[214:215]
    v_mfma_f32_16x16x16_bf16 v[224:227], v[140:141], v[130:131], v[40:43]
    v_cvt_pk_bf16_f32 v138, v176, v177
    v_cvt_pk_bf16_f32 v139, v178, v179
    v_mfma_f32_16x16x16_bf16 v[232:235], v[146:147], v[134:135], v[40:43]
    v_cvt_pk_bf16_f32 v144, v184, v185
    v_cvt_pk_bf16_f32 v145, v186, v187
    v_mfma_f32_16x16x16_bf16 v[228:231], v[138:139], v[130:131], v[44:47]
    s_waitcnt lgkmcnt(0)
    s_barrier
    v_mfma_f32_16x16x16_bf16 v[236:239], v[144:145], v[134:135], v[44:47]
    ds_read_b64 v[136:137], v60 offset:0
    ds_read_b64 v[142:143], v60 offset:512
    v_mfma_f32_16x16x16_bf16 v[240:243], v[138:139], v[128:129], v[40:43]
    s_add_u32 s57, s99, 0
    s_add_u32 m0, s97, 98304
    s_nop 0
    buffer_load_dwordx4 v1, s[8:11], s57 offen offset:0 sc1 lds
    ds_read_b64 v[148:149], v60 offset:1024
    ds_read_b64 v[154:155], v60 offset:1536
    v_mfma_f32_16x16x16_bf16 v[248:251], v[144:145], v[132:133], v[40:43]
    v_cvt_pk_bf16_f32 v150, v192, v193
    v_cvt_pk_bf16_f32 v151, v194, v195
    v_cvt_pk_bf16_f32 v156, v200, v201
    v_cvt_pk_bf16_f32 v157, v202, v203
    v_max_f32 v224, v224, v228
    v_max_f32 v225, v225, v229
    v_max_f32 v226, v226, v230
    v_max_f32 v227, v227, v231
    v_max3_f32 v160, v224, v225, v226
    v_max_f32 v160, v160, v227
    s_waitcnt lgkmcnt(2)
    buffer_load_dwordx4 v1, s[8:11], s57 offen offset:1024 sc1 lds
    v_mfma_f32_16x16x16_bf16 v[244:247], v[136:137], v[128:129], v[48:51]
    v_max_f32 v232, v232, v236
    v_max_f32 v233, v233, v237
    v_mfma_f32_16x16x16_bf16 v[252:255], v[142:143], v[132:133], v[48:51]
    v_max_f32 v234, v234, v238
    v_max_f32 v235, v235, v239
    v_max3_f32 v161, v232, v233, v234
    v_max_f32 v161, v161, v235
    s_add_u32 s60, s31, 131072
    v_max_f32 v240, v240, v244
    v_max_f32 v241, v241, v245
    v_permlane32_swap_b32 v160, v161
    v_max_f32 v242, v242, v246
    v_max_f32 v243, v243, v247
    buffer_load_dwordx4 v1, s[8:11], s57 offen offset:2048 sc1 lds
    v_max3_f32 v162, v240, v241, v242
    v_max_f32 v162, v162, v243
    v_max_f32 v248, v248, v252
    v_max_f32 v249, v249, v253
    v_max_f32 v250, v250, v254
    v_max_f32 v251, v251, v255
    v_max3_f32 v163, v248, v249, v250
    v_max_f32 v163, v163, v251
    v_max_f32 v160, v160, v161
    s_nop 0
    v_permlane32_swap_b32 v162, v163
    v_max_f32 v162, v162, v163
    s_nop 1
    v_permlane16_swap_b32 v160, v162
    v_max_f32 v161, v160, v162
    v_max_f32 v162, v160, v162
    buffer_load_dwordx4 v1, s[8:11], s57 offen offset:3072 sc1 lds
    s_nop 0
    v_permlane16_swap_b32 v161, v162
    v_mul_f32 v160, v161, v29
    v_mul_f32 v161, v161, v29
    v_mul_f32 v163, v162, v28
    v_mul_f32 v162, v162, v28
    v_permlane32_swap_b32 v160, v161
    v_pk_fma_f32 v[224:225], v[224:225], v[28:29], v[160:161] op_sel:[0,1,0] op_sel_hi:[1,1,0] neg_lo:[0,0,1] neg_hi:[0,0,1]
    v_pk_fma_f32 v[226:227], v[226:227], v[28:29], v[160:161] op_sel:[0,1,0] op_sel_hi:[1,1,0] neg_lo:[0,0,1] neg_hi:[0,0,1]
    v_permlane32_swap_b32 v162, v163
    v_pk_fma_f32 v[232:233], v[232:233], v[28:29], v[160:161] op_sel:[0,1,1] op_sel_hi:[1,1,1] neg_lo:[0,0,1] neg_hi:[0,0,1]
    v_pk_fma_f32 v[234:235], v[234:235], v[28:29], v[160:161] op_sel:[0,1,1] op_sel_hi:[1,1,1] neg_lo:[0,0,1] neg_hi:[0,0,1]
    v_pk_fma_f32 v[240:241], v[240:241], v[28:29], v[162:163] op_sel:[0,0,0] op_sel_hi:[1,0,0] neg_lo:[0,0,1] neg_hi:[0,0,1]
    v_pk_fma_f32 v[242:243], v[242:243], v[28:29], v[162:163] op_sel:[0,0,0] op_sel_hi:[1,0,0] neg_lo:[0,0,1] neg_hi:[0,0,1]
    v_pk_fma_f32 v[248:249], v[248:249], v[28:29], v[162:163] op_sel:[0,0,1] op_sel_hi:[1,0,1] neg_lo:[0,0,1] neg_hi:[0,0,1]
    v_pk_fma_f32 v[250:251], v[250:251], v[28:29], v[162:163] op_sel:[0,0,1] op_sel_hi:[1,0,1] neg_lo:[0,0,1] neg_hi:[0,0,1]
    v_exp_f32 v224, v224
    v_exp_f32 v225, v225
    v_exp_f32 v226, v226
    v_exp_f32 v227, v227
    v_cvt_pk_bf16_f32 v164, v224, v225
    v_cvt_pk_bf16_f32 v165, v226, v227
    v_bfi_b32 v172, v52, 0, v164
    v_and_b32 v174, v52, v164
    v_bfi_b32 v173, v53, 0, v165
    v_and_b32 v175, v53, v165
    v_mfma_f32_16x16x16_bf16 v[228:231], v[54:55], v[164:165], 0
    v_exp_f32 v232, v232
    v_exp_f32 v233, v233
    v_mfma_f32_16x16x32_bf16 v[224:227], v[150:153], v[172:175], 0
    v_exp_f32 v234, v234
    v_exp_f32 v235, v235
    v_cvt_pk_bf16_f32 v166, v232, v233
    v_cvt_pk_bf16_f32 v167, v234, v235
    v_bfi_b32 v176, v52, 0, v166
    v_and_b32 v178, v52, v166
    v_bfi_b32 v177, v53, 0, v167
    v_and_b32 v179, v53, v167
    v_mfma_f32_16x16x16_bf16 v[236:239], v[54:55], v[166:167], 0
    v_exp_f32 v240, v240
    v_exp_f32 v241, v241
    v_mfma_f32_16x16x32_bf16 v[232:235], v[156:159], v[176:179], 0
    v_exp_f32 v242, v242
    v_exp_f32 v243, v243
    s_waitcnt lgkmcnt(0)
    v_rcp_f32 v228, v228
    v_cvt_pk_bf16_f32 v168, v240, v241
    v_cvt_pk_bf16_f32 v169, v242, v243
    v_bfi_b32 v180, v52, 0, v168
    v_and_b32 v182, v52, v168
    v_bfi_b32 v181, v53, 0, v169
    v_and_b32 v183, v53, v169
    v_mfma_f32_16x16x16_bf16 v[244:247], v[54:55], v[168:169], 0
    v_exp_f32 v248, v248
    v_exp_f32 v249, v249
    v_mfma_f32_16x16x32_bf16 v[240:243], v[148:151], v[180:183], 0
    v_exp_f32 v250, v250
    v_exp_f32 v251, v251
    v_rcp_f32 v236, v236
    v_cvt_pk_bf16_f32 v170, v248, v249
    v_cvt_pk_bf16_f32 v171, v250, v251
    v_bfi_b32 v184, v52, 0, v170
    v_and_b32 v186, v52, v170
    v_bfi_b32 v185, v53, 0, v171
    v_and_b32 v187, v53, v171
    v_mfma_f32_16x16x16_bf16 v[252:255], v[54:55], v[170:171], 0
    v_rcp_f32 v244, v244
    v_mfma_f32_16x16x32_bf16 v[248:251], v[154:157], v[184:187], 0
    v_mul_f32 v224, v224, v228
    v_mul_f32 v225, v225, v228
    v_mul_f32 v226, v226, v228
    v_mul_f32 v227, v227, v228
    v_cvt_pk_bf16_f32 v192, v224, v225
    v_cvt_pk_bf16_f32 v193, v226, v227
    v_pk_mul_f32 v[232:233], v[232:233], v[236:237] op_sel_hi:[1,0]
    v_pk_mul_f32 v[234:235], v[234:235], v[236:237] op_sel_hi:[1,0]
    v_cvt_pk_bf16_f32 v194, v232, v233
    v_cvt_pk_bf16_f32 v195, v234, v235
    buffer_store_dwordx4 v[192:195], v4, s[8:11], s60 offen offset:256
    v_rcp_f32 v252, v252
    v_pk_mul_f32 v[240:241], v[240:241], v[244:245] op_sel_hi:[1,0]
    v_pk_mul_f32 v[242:243], v[242:243], v[244:245] op_sel_hi:[1,0]
    v_cvt_pk_bf16_f32 v188, v240, v241
    v_cvt_pk_bf16_f32 v189, v242, v243
    v_pk_mul_f32 v[248:249], v[248:249], v[252:253] op_sel_hi:[1,0]
    v_pk_mul_f32 v[250:251], v[250:251], v[252:253] op_sel_hi:[1,0]
    v_cvt_pk_bf16_f32 v190, v248, v249
    v_cvt_pk_bf16_f32 v191, v250, v251
    buffer_store_dwordx4 v[188:191], v4, s[8:11], s60 offen offset:0
    ds_read_b128 v[32:35], v3 offset:0
    ds_read_b128 v[36:39], v3 offset:1024
    ds_read_b128 v[40:43], v3 offset:2048
    ds_read_b128 v[44:47], v3 offset:3072
    ds_read_b128 v[48:51], v3 offset:4096
    ds_read_b128 v[52:55], v3 offset:5120
    ds_read_b128 v[56:59], v3 offset:6144
    ds_read_b128 v[60:63], v3 offset:7168
    ds_read_b128 v[64:67], v3 offset:8192
    ds_read_b128 v[68:71], v3 offset:9216
    ds_read_b128 v[72:75], v3 offset:10240
    ds_read_b128 v[76:79], v3 offset:11264
    ds_read_b128 v[80:83], v3 offset:12288
    ds_read_b128 v[84:87], v3 offset:13312
    ds_read_b128 v[88:91], v3 offset:14336
    s_waitcnt lgkmcnt(14)
    ds_read_b128 v[92:95], v3 offset:15360
    s_waitcnt lgkmcnt(14)
    ds_read_b128 v[176:179], v3 offset:16384
    s_waitcnt lgkmcnt(14)
    ds_read_b128 v[180:183], v3 offset:17408
    s_waitcnt lgkmcnt(14)
    ds_read_b128 v[184:187], v3 offset:18432
    s_waitcnt lgkmcnt(14)
    ds_read_b128 v[188:191], v3 offset:19456
    s_add_u32 s12, s26, 1
    v_mov_b32 v30, s12
    s_cmp_lg_u32 s27, 0
    s_waitcnt vmcnt(0)
    s_cbranch_scc1 L_slow_18
    buffer_store_dword v30, v5, s[8:11], s45 offen
L_sig_19:
L_wo0:
    v_lshlrev_b32 v160, 16, v8
    v_and_b32 v161, 0xffff0000, v8
    v_lshlrev_b32 v162, 16, v9
    v_and_b32 v163, 0xffff0000, v9
    v_lshlrev_b32 v164, 16, v10
    v_and_b32 v165, 0xffff0000, v10
    v_lshlrev_b32 v166, 16, v11
    v_and_b32 v167, 0xffff0000, v11
    v_lshlrev_b32 v168, 16, v12
    v_and_b32 v169, 0xffff0000, v12
    v_lshlrev_b32 v170, 16, v13
    v_and_b32 v171, 0xffff0000, v13
    v_lshlrev_b32 v172, 16, v14
    v_and_b32 v173, 0xffff0000, v14
    v_lshlrev_b32 v174, 16, v15
    v_and_b32 v175, 0xffff0000, v15
    s_mov_b32 s63, 0x40000
    s_cmp_lg_u32 s27, 0
    s_cbranch_scc1 L_far_20
L_poll_22:
    buffer_load_dword v22, v6, s[8:11], s44 offen nt
    s_sub_u32 s63, s63, 1
    s_cbranch_scc1 L_main_done
    s_waitcnt vmcnt(0)
    v_subrev_u32 v22, s12, v22
    v_cmp_lt_u32 vcc, 15, v22
    s_nop 0
    s_and_b64 vcc, vcc, s[66:67]
    s_cbranch_scc1 L_poll_22
L_ok_21:
    s_add_u32 s56, s64, 131072
    buffer_load_dwordx4 v[96:99], v4, s[8:11], s56 offen offset:0 sc1
    buffer_load_dwordx4 v[100:103], v4, s[8:11], s56 offen offset:2048 sc1
    s_add_u32 s56, s64, 135168
    buffer_load_dwordx4 v[104:107], v4, s[8:11], s56 offen offset:0 sc1
    buffer_load_dwordx4 v[108:111], v4, s[8:11], s56 offen offset:2048 sc1
    s_waitcnt lgkmcnt(14)
    ds_read_b128 v[192:195], v3 offset:20480
    s_waitcnt lgkmcnt(14)
    ds_read_b128 v[196:199], v3 offset:21504
    s_waitcnt lgkmcnt(14)
    ds_read_b128 v[200:203], v3 offset:22528
    s_add_u32 s56, s64, 139264
    buffer_load_dwordx4 v[112:115], v4, s[8:11], s56 offen offset:0 sc1
    s_waitcnt lgkmcnt(14)
    ds_read_b128 v[204:207], v3 offset:23552
    s_waitcnt lgkmcnt(14)
    ds_read_b128 v[208:211], v3 offset:24576
    s_waitcnt lgkmcnt(14)
    ds_read_b128 v[212:215], v3 offset:25600
    buffer_load_dwordx4 v[116:119], v4, s[8:11], s56 offen offset:2048 sc1
    s_waitcnt lgkmcnt(14)
    ds_read_b128 v[216:219], v3 offset:26624
    s_waitcnt lgkmcnt(14)
    ds_read_b128 v[220:223], v3 offset:27648
    s_waitcnt lgkmcnt(14)
    ds_read_b128 v[224:227], v3 offset:28672
    s_add_u32 s56, s64, 143360
    buffer_load_dwordx4 v[120:123], v4, s[8:11], s56 offen offset:0 sc1
    s_waitcnt lgkmcnt(14)
    ds_read_b128 v[228:231], v3 offset:29696
    s_waitcnt lgkmcnt(14)
    ds_read_b128 v[232:235], v3 offset:30720
    s_waitcnt lgkmcnt(14)
    ds_read_b128 v[236:239], v3 offset:31744
    buffer_load_dwordx4 v[124:127], v4, s[8:11], s56 offen offset:2048 sc1
    s_barrier
    s_waitcnt lgkmcnt(14)
    ds_read_b128 v[240:243], v1 offset:0
    s_waitcnt lgkmcnt(14)
    ds_read_b128 v[244:247], v1 offset:1024
    s_waitcnt lgkmcnt(14)
    ds_read_b128 v[248:251], v1 offset:2048
    s_waitcnt lgkmcnt(14)
    ds_read_b128 v[252:255], v1 offset:3072
    s_waitcnt vmcnt(7)
    v_mfma_f32_16x16x32_bf16 v[160:163], v[32:35], v[96:99], v[160:163]
    s_add_u32 s56, s64, 147456
    buffer_load_dwordx4 v[128:131], v4, s[8:11], s56 offen offset:0 sc1
    v_mfma_f32_16x16x32_bf16 v[164:167], v[36:39], v[96:99], v[164:167]
    s_waitcnt lgkmcnt(14)
    ds_read_b128 v[32:35], v1 offset:4096
    s_waitcnt lgkmcnt(14)
    ds_read_b128 v[36:39], v1 offset:5120
    v_mfma_f32_16x16x32_bf16 v[168:171], v[40:43], v[96:99], v[168:171]
    s_waitcnt lgkmcnt(14)
    ds_read_b128 v[40:43], v1 offset:6144
    v_mfma_f32_16x16x32_bf16 v[172:175], v[44:47], v[96:99], v[172:175]
    s_waitcnt vmcnt(7)
    s_waitcnt lgkmcnt(14)
    ds_read_b128 v[44:47], v1 offset:7168
    v_mfma_f32_16x16x32_bf16 v[160:163], v[48:51], v[100:103], v[160:163]
    buffer_load_dwordx4 v[132:135], v4, s[8:11], s56 offen offset:2048 sc1
    v_mfma_f32_16x16x32_bf16 v[164:167], v[52:55], v[100:103], v[164:167]
    s_waitcnt lgkmcnt(14)
    ds_read_b128 v[48:51], v1 offset:8192
    s_waitcnt lgkmcnt(14)
    ds_read_b128 v[52:55], v1 offset:9216
    v_mfma_f32_16x16x32_bf16 v[168:171], v[56:59], v[100:103], v[168:171]
    s_waitcnt lgkmcnt(14)
    ds_read_b128 v[56:59], v1 offset:10240
    v_mfma_f32_16x16x32_bf16 v[172:175], v[60:63], v[100:103], v[172:175]
    s_waitcnt vmcnt(7)
    s_waitcnt lgkmcnt(14)
    ds_read_b128 v[60:63], v1 offset:11264
    v_mfma_f32_16x16x32_bf16 v[160:163], v[64:67], v[104:107], v[160:163]
    s_add_u32 s56, s64, 151552
    buffer_load_dwordx4 v[136:139], v4, s[8:11], s56 offen offset:0 sc1
    v_mfma_f32_16x16x32_bf16 v[164:167], v[68:71], v[104:107], v[164:167]
    s_waitcnt lgkmcnt(14)
    ds_read_b128 v[64:67], v1 offset:12288
    s_waitcnt lgkmcnt(14)
    ds_read_b128 v[68:71], v1 offset:13312
    v_mfma_f32_16x16x32_bf16 v[168:171], v[72:75], v[104:107], v[168:171]
    s_waitcnt lgkmcnt(14)
    ds_read_b128 v[72:75], v1 offset:14336
    v_mfma_f32_16x16x32_bf16 v[172:175], v[76:79], v[104:107], v[172:175]
    s_waitcnt vmcnt(7)
    s_waitcnt lgkmcnt(14)
    ds_read_b128 v[76:79], v1 offset:15360
    v_mfma_f32_16x16x32_bf16 v[160:163], v[80:83], v[108:111], v[160:163]
    buffer_load_dwordx4 v[140:143], v4, s[8:11], s56 offen offset:2048 sc1
    v_mfma_f32_16x16x32_bf16 v[164:167], v[84:87], v[108:111], v[164:167]
    s_waitcnt lgkmcnt(14)
    ds_read_b128 v[80:83], v1 offset:16384
    s_waitcnt lgkmcnt(14)
    ds_read_b128 v[84:87], v1 offset:17408
    v_mfma_f32_16x16x32_bf16 v[168:171], v[88:91], v[108:111], v[168:171]
    s_waitcnt lgkmcnt(14)
    ds_read_b128 v[88:91], v1 offset:18432
    v_mfma_f32_16x16x32_bf16 v[172:175], v[92:95], v[108:111], v[172:175]
    s_waitcnt vmcnt(7)
    s_waitcnt lgkmcnt(14)
    ds_read_b128 v[92:95], v1 offset:19456
    v_mfma_f32_16x16x32_bf16 v[160:163], v[176:179], v[112:115], v[160:163]
    s_add_u32 s56, s64, 155648
    buffer_load_dwordx4 v[144:147], v4, s[8:11], s56 offen offset:0 sc1
    v_mfma_f32_16x16x32_bf16 v[164:167], v[180:183], v[112:115], v[164:167]
    s_waitcnt lgkmcnt(14)
    ds_read_b128 v[176:179], v1 offset:20480
    s_waitcnt lgkmcnt(14)
    ds_read_b128 v[180:183], v1 offset:21504
    v_mfma_f32_16x16x32_bf16 v[168:171], v[184:187], v[112:115], v[168:171]
    s_waitcnt lgkmcnt(14)
    ds_read_b128 v[184:187], v1 offset:22528
    v_mfma_f32_16x16x32_bf16 v[172:175], v[188:191], v[112:115], v[172:175]
    s_waitcnt vmcnt(7)
    s_waitcnt lgkmcnt(14)
    ds_read_b128 v[188:191], v1 offset:23552
    v_mfma_f32_16x16x32_bf16 v[160:163], v[192:195], v[116:119], v[160:163]
    buffer_load_dwordx4 v[148:151], v4, s[8:11], s56 offen offset:2048 sc1
    v_mfma_f32_16x16x32_bf16 v[164:167], v[196:199], v[116:119], v[164:167]
    s_waitcnt lgkmcnt(14)
    ds_read_b128 v[192:195], v1 offset:24576
    s_waitcnt lgkmcnt(14)
    ds_read_b128 v[196:199], v1 offset:25600
    v_mfma_f32_16x16x32_bf16 v[168:171], v[200:203], v[116:119], v[168:171]
    s_waitcnt lgkmcnt(14)
    ds_read_b128 v[200:203], v1 offset:26624
    v_mfma_f32_16x16x32_bf16 v[172:175], v[204:207], v[116:119], v[172:175]
    s_waitcnt vmcnt(7)
    s_waitcnt lgkmcnt(14)
    ds_read_b128 v[204:207], v1 offset:27648
    v_mfma_f32_16x16x32_bf16 v[160:163], v[208:211], v[120:123], v[160:163]
    s_add_u32 s56, s64, 159744
    buffer_load_dwordx4 v[152:155], v4, s[8:11], s56 offen offset:0 sc1
    v_mfma_f32_16x16x32_bf16 v[164:167], v[212:215], v[120:123], v[164:167]
    s_waitcnt lgkmcnt(14)
    ds_read_b128 v[208:211], v1 offset:28672
    s_waitcnt lgkmcnt(14)
    ds_read_b128 v[212:215], v1 offset:29696
    v_mfma_f32_16x16x32_bf16 v[168:171], v[216:219], v[120:123], v[168:171]
    s_waitcnt lgkmcnt(14)
    ds_read_b128 v[216:219], v1 offset:30720
    v_mfma_f32_16x16x32_bf16 v[172:175], v[220:223], v[120:123], v[172:175]
    s_waitcnt vmcnt(7)
    s_waitcnt lgkmcnt(14)
    ds_read_b128 v[220:223], v1 offset:31744
    v_mfma_f32_16x16x32_bf16 v[160:163], v[224:227], v[124:127], v[160:163]
    buffer_load_dwordx4 v[156:159], v4, s[8:11], s56 offen offset:2048 sc1
    v_mfma_f32_16x16x32_bf16 v[164:167], v[228:231], v[124:127], v[164:167]
    v_mfma_f32_16x16x32_bf16 v[168:171], v[232:235], v[124:127], v[168:171]
    v_mfma_f32_16x16x32_bf16 v[172:175], v[236:239], v[124:127], v[172:175]
    s_waitcnt vmcnt(7)
    v_mfma_f32_16x16x32_bf16 v[160:163], v[240:243], v[128:131], v[160:163]
    v_mfma_f32_16x16x32_bf16 v[164:167], v[244:247], v[128:131], v[164:167]
    s_add_u32 s57, s99, 16384
    s_add_u32 m0, s97, 114688
    v_mfma_f32_16x16x32_bf16 v[168:171], v[248:251], v[128:131], v[168:171]
    buffer_load_dwordx4 v1, s[8:11], s57 offen offset:0 sc1 lds
    v_mfma_f32_16x16x32_bf16 v[172:175], v[252:255], v[128:131], v[172:175]
    s_waitcnt vmcnt(7)
    v_mfma_f32_16x16x32_bf16 v[160:163], v[32:35], v[132:135], v[160:163]
    v_mfma_f32_16x16x32_bf16 v[164:167], v[36:39], v[132:135], v[164:167]
    v_mfma_f32_16x16x32_bf16 v[168:171], v[40:43], v[132:135], v[168:171]
    buffer_load_dwordx4 v1, s[8:11], s57 offen offset:1024 sc1 lds
    v_mfma_f32_16x16x32_bf16 v[172:175], v[44:47], v[132:135], v[172:175]
    s_waitcnt vmcnt(7)
    v_mfma_f32_16x16x32_bf16 v[160:163], v[48:51], v[136:139], v[160:163]
    v_mfma_f32_16x16x32_bf16 v[164:167], v[52:55], v[136:139], v[164:167]
    v_mfma_f32_16x16x32_bf16 v[168:171], v[56:59], v[136:139], v[168:171]
    buffer_load_dwordx4 v1, s[8:11], s57 offen offset:2048 sc1 lds
    v_mfma_f32_16x16x32_bf16 v[172:175], v[60:63], v[136:139], v[172:175]
    s_waitcnt vmcnt(7)
    v_mfma_f32_16x16x32_bf16 v[160:163], v[64:67], v[140:143], v[160:163]
    v_mfma_f32_16x16x32_bf16 v[164:167], v[68:71], v[140:143], v[164:167]
    v_mfma_f32_16x16x32_bf16 v[168:171], v[72:75], v[140:143], v[168:171]
    v_mfma_f32_16x16x32_bf16 v[172:175], v[76:79], v[140:143], v[172:175]
    s_waitcnt vmcnt(6)
    buffer_load_dwordx4 v1, s[8:11], s57 offen offset:3072 sc1 lds
    v_mfma_f32_16x16x32_bf16 v[160:163], v[80:83], v[144:147], v[160:163]
    s_waitcnt lgkmcnt(14)
    v_mfma_f32_16x16x32_bf16 v[164:167], v[84:87], v[144:147], v[164:167]
    s_waitcnt lgkmcnt(13)
    v_mfma_f32_16x16x32_bf16 v[168:171], v[88:91], v[144:147], v[168:171]
    s_waitcnt lgkmcnt(12)
    v_mfma_f32_16x16x32_bf16 v[172:175], v[92:95], v[144:147], v[172:175]
    s_waitcnt vmcnt(6) lgkmcnt(11)
    v_mfma_f32_16x16x32_bf16 v[160:163], v[176:179], v[148:151], v[160:163]
    s_waitcnt lgkmcnt(10)
    v_mfma_f32_16x16x32_bf16 v[164:167], v[180:183], v[148:151], v[164:167]
    s_waitcnt lgkmcnt(9)
    v_mfma_f32_16x16x32_bf16 v[168:171], v[184:187], v[148:151], v[168:171]
    s_waitcnt lgkmcnt(8)
    v_mfma_f32_16x16x32_bf16 v[172:175], v[188:191], v[148:151], v[172:175]
    s_waitcnt vmcnt(5) lgkmcnt(7)
    v_mfma_f32_16x16x32_bf16 v[160:163], v[192:195], v[152:155], v[160:163]
    s_waitcnt lgkmcnt(6)
    v_mfma_f32_16x16x32_bf16 v[164:167], v[196:199], v[152:155], v[164:167]
    s_waitcnt lgkmcnt(5)
    v_mfma_f32_16x16x32_bf16 v[168:171], v[200:203], v[152:155], v[168:171]
    s_waitcnt lgkmcnt(4)
    v_mfma_f32_16x16x32_bf16 v[172:175], v[204:207], v[152:155], v[172:175]
    s_waitcnt vmcnt(4) lgkmcnt(3)
    v_mfma_f32_16x16x32_bf16 v[160:163], v[208:211], v[156:159], v[160:163]
    s_waitcnt lgkmcnt(2)
    v_mfma_f32_16x16x32_bf16 v[164:167], v[212:215], v[156:159], v[164:167]
    s_waitcnt lgkmcnt(1)
    v_mfma_f32_16x16x32_bf16 v[168:171], v[216:219], v[156:159], v[168:171]
    s_waitcnt lgkmcnt(0)
    v_mfma_f32_16x16x32_bf16 v[172:175], v[220:223], v[156:159], v[172:175]
    s_nop 1
    v_cvt_pk_bf16_f32 v8, v160, v161
    v_cvt_pk_bf16_f32 v9, v162, v163
    v_cvt_pk_bf16_f32 v10, v164, v165
    v_cvt_pk_bf16_f32 v11, v166, v167
    v_cvt_pk_bf16_f32 v12, v168, v169
    v_cvt_pk_bf16_f32 v13, v170, v171
    v_cvt_pk_bf16_f32 v14, v172, v173
    v_cvt_pk_bf16_f32 v15, v174, v175
    s_add_u32 s59, s30, 0
    buffer_store_dwordx4 v[8:11], v4, s[8:11], s59 offen offset:0
    buffer_store_dwordx4 v[12:15], v4, s[8:11], s59 offen offset:2048
    v_dot2_f32_bf16 v26, v8, s50, 0
    v_dot2_f32_bf16 v27, v8, v8, 0
    v_dot2_f32_bf16 v28, v12, s50, 0
    v_dot2_f32_bf16 v29, v12, v12, 0
    v_dot2_f32_bf16 v26, v9, s50, v26
    v_dot2_f32_bf16 v27, v9, v9, v27
    v_dot2_f32_bf16 v28, v13, s50, v28
    v_dot2_f32_bf16 v29, v13, v13, v29
    v_dot2_f32_bf16 v26, v10, s50, v26
    v_dot2_f32_bf16 v27, v10, v10, v27
    v_dot2_f32_bf16 v28, v14, s50, v28
    v_dot2_f32_bf16 v29, v14, v14, v29
    v_dot2_f32_bf16 v26, v11, s50, v26
    v_dot2_f32_bf16 v27, v11, v11, v27
    v_dot2_f32_bf16 v28, v15, s50, v28
    v_dot2_f32_bf16 v29, v15, v15, v29
    v_accvgpr_read_b32 v25, a225
    s_add_u32 s59, s49, 720896
    v_add_f32 v26, v26, v28
    v_add_f32 v27, v27, v29
    s_nop 1
    v_permlane32_swap_b32 v26, v27
    v_add_f32 v26, v26, v27
    v_mov_b32 v27, v26
    s_nop 1
    v_permlane16_swap_b32 v26, v27
    v_add_f32 v26, v26, v27
    buffer_store_dword v26, v25, s[8:11], s59 offen
    s_add_u32 s12, s26, 2
    v_mov_b32 v30, s12
    s_cmp_lg_u32 s27, 0
    s_waitcnt vmcnt(0)
    s_cbranch_scc1 L_slow_23
    buffer_store_dword v30, v5, s[8:11], s45 offen
L_sig_24:
    s_branch L_page_25
    .p2align 12
L_page_25:
L_gu0:
    s_barrier
    ds_read_b128 v[224:227], v2 offset:32768
    ds_read_b128 v[228:231], v2 offset:33792
    ds_read_b128 v[232:235], v2 offset:34816
    ds_read_b128 v[236:239], v2 offset:35840
    ds_read_b128 v[240:243], v2 offset:36864
    ds_read_b128 v[244:247], v2 offset:37888
    s_mov_b32 s63, 0x40000
    s_cmp_lg_u32 s27, 0
    s_cbranch_scc1 L_far_26
L_poll_28:
    buffer_load_dword v22, v6, s[8:11], s44 offen nt
    s_sub_u32 s63, s63, 1
    s_cbranch_scc1 L_main_done
    s_waitcnt vmcnt(0)
    v_subrev_u32 v22, s12, v22
    v_cmp_lt_u32 vcc, 15, v22
    s_nop 0
    s_and_b64 vcc, vcc, s[40:41]
    s_cbranch_scc1 L_poll_28
L_ok_27:
    s_add_u32 s56, s29, 0
    buffer_load_dwordx4 v[32:35], v4, s[8:11], s56 offen offset:0 sc1
    buffer_load_dwordx4 v[36:39], v4, s[8:11], s56 offen offset:256 sc1
    buffer_load_dwordx4 v[40:43], v4, s[8:11], s56 offen offset:2048 sc1
    buffer_load_dwordx4 v[44:47], v4, s[8:11], s56 offen offset:2304 sc1
    s_add_u32 s60, s34, 720896
    s_waitcnt vmcnt(3) lgkmcnt(4)
    v_mfma_f32_16x16x32_bf16 v[112:115], v[224:227], v[32:35], 0
    s_waitcnt vmcnt(2)
    s_add_u32 s56, s29, 4096
    v_mfma_f32_16x16x32_bf16 v[120:123], v[224:227], v[36:39], 0
    ds_read_b128 v[248:251], v2 offset:38912
    v_mfma_f32_16x16x32_bf16 v[116:119], v[228:231], v[32:35], 0
    buffer_load_dwordx4 v[48:51], v4, s[8:11], s56 offen offset:0 sc1
    v_mfma_f32_16x16x32_bf16 v[124:127], v[228:231], v[36:39], 0
    s_waitcnt lgkmcnt(3)
    ds_read_b128 v[252:255], v2 offset:39936
    v_mfma_f32_16x16x32_bf16 v[128:131], v[232:235], v[32:35], 0
    buffer_load_dwordx4 v[52:55], v4, s[8:11], s56 offen offset:256 sc1
    v_mfma_f32_16x16x32_bf16 v[136:139], v[232:235], v[36:39], 0
    ds_read_b128 v[224:227], v2 offset:40960
    v_mfma_f32_16x16x32_bf16 v[132:135], v[236:239], v[32:35], 0
    buffer_load_dwordx4 v[56:59], v4, s[8:11], s56 offen offset:2048 sc1
    v_mfma_f32_16x16x32_bf16 v[140:143], v[236:239], v[36:39], 0
    s_waitcnt lgkmcnt(3)
    ds_read_b128 v[228:231], v2 offset:41984
    s_add_u32 s57, s99, 32768
    v_mfma_f32_16x16x32_bf16 v[144:147], v[240:243], v[32:35], 0
    s_add_u32 m0, s97, 131072
    v_mfma_f32_16x16x32_bf16 v[152:155], v[240:243], v[36:39], 0
    ds_read_b128 v[232:235], v2 offset:43008
    buffer_load_dwordx4 v1, s[8:11], s57 offen offset:0 sc1 lds
    v_mfma_f32_16x16x32_bf16 v[148:151], v[244:247], v[32:35], 0
    buffer_load_dwordx4 v[60:63], v4, s[8:11], s56 offen offset:2304 sc1
    v_mfma_f32_16x16x32_bf16 v[156:159], v[244:247], v[36:39], 0
    s_waitcnt lgkmcnt(3)
    ds_read_b128 v[236:239], v2 offset:44032
    v_mfma_f32_16x16x32_bf16 v[160:163], v[248:251], v[32:35], 0
    buffer_load_dwordx4 v1, s[8:11], s57 offen offset:1024 sc1 lds
    v_mfma_f32_16x16x32_bf16 v[168:171], v[248:251], v[36:39], 0
    ds_read_b128 v[240:243], v2 offset:45056
    v_mfma_f32_16x16x32_bf16 v[164:167], v[252:255], v[32:35], 0
    buffer_load_dwordx4 v1, s[8:11], s57 offen offset:2048 sc1 lds
    v_mfma_f32_16x16x32_bf16 v[172:175], v[252:255], v[36:39], 0
    s_waitcnt lgkmcnt(3)
    ds_read_b128 v[244:247], v2 offset:46080
    s_add_u32 s56, s29, 8192
    v_mfma_f32_16x16x32_bf16 v[176:179], v[224:227], v[32:35], 0
    buffer_load_dwordx4 v[64:67], v4, s[8:11], s56 offen offset:0 sc1
    v_mfma_f32_16x16x32_bf16 v[184:187], v[224:227], v[36:39], 0
    ds_read_b128 v[248:251], v2 offset:47104
    v_mfma_f32_16x16x32_bf16 v[180:183], v[228:231], v[32:35], 0
    buffer_load_dwordx4 v1, s[8:11], s57 offen offset:3072 sc1 lds
    v_mfma_f32_16x16x32_bf16 v[188:191], v[228:231], v[36:39], 0
    s_waitcnt lgkmcnt(3)
    ds_read_b128 v[252:255], v2 offset:48128
    v_mfma_f32_16x16x32_bf16 v[192:195], v[232:235], v[32:35], 0
    buffer_load_dwordx4 v[68:71], v4, s[8:11], s56 offen offset:256 sc1
    v_mfma_f32_16x16x32_bf16 v[200:203], v[232:235], v[36:39], 0
    s_add_u32 s57, s99, 49152
    ds_read_b128 v[224:227], v2 offset:49152
    s_add_u32 m0, s97, 147456
    v_mfma_f32_16x16x32_bf16 v[196:199], v[236:239], v[32:35], 0
    buffer_load_dwordx4 v1, s[8:11], s57 offen offset:0 sc1 lds
    v_mfma_f32_16x16x32_bf16 v[204:207], v[236:239], v[36:39], 0
    s_waitcnt lgkmcnt(3)
    ds_read_b128 v[228:231], v2 offset:50176
    v_mfma_f32_16x16x32_bf16 v[208:211], v[240:243], v[32:35], 0
    buffer_load_dwordx4 v1, s[8:11], s57 offen offset:1024 sc1 lds
    v_mfma_f32_16x16x32_bf16 v[216:219], v[240:243], v[36:39], 0
    ds_read_b128 v[232:235], v2 offset:51200
    v_mfma_f32_16x16x32_bf16 v[212:215], v[244:247], v[32:35], 0
    buffer_load_dwordx4 v[16:19], v1, s[8:11], s60 offen sc1
    v_mfma_f32_16x16x32_bf16 v[220:223], v[244:247], v[36:39], 0
    s_waitcnt vmcnt(13) lgkmcnt(3)
    ds_read_b128 v[236:239], v2 offset:52224
    v_mfma_f32_16x16x32_bf16 v[112:115], v[248:251], v[40:43], v[112:115]
    buffer_load_dwordx4 v[20:23], v1, s[8:11], s60 offen offset:1024 sc1
    v_mfma_f32_16x16x32_bf16 v[120:123], v[248:251], v[44:47], v[120:123]
    ds_read_b128 v[240:243], v2 offset:53248
    v_mfma_f32_16x16x32_bf16 v[116:119], v[252:255], v[40:43], v[116:119]
    buffer_load_dwordx4 v[72:75], v4, s[8:11], s56 offen offset:2048 sc1
    v_mfma_f32_16x16x32_bf16 v[124:127], v[252:255], v[44:47], v[124:127]
    s_waitcnt lgkmcnt(3)
    ds_read_b128 v[244:247], v2 offset:54272
    v_mfma_f32_16x16x32_bf16 v[128:131], v[224:227], v[40:43], v[128:131]
    v_mfma_f32_16x16x32_bf16 v[136:139], v[224:227], v[44:47], v[136:139]
    ds_read_b128 v[248:251], v2 offset:55296
    v_mfma_f32_16x16x32_bf16 v[132:135], v[228:231], v[40:43], v[132:135]
    buffer_load_dwordx4 v1, s[8:11], s57 offen offset:2048 sc1 lds
    v_mfma_f32_16x16x32_bf16 v[140:143], v[228:231], v[44:47], v[140:143]
    s_waitcnt lgkmcnt(3)
    ds_read_b128 v[252:255], v2 offset:56320
    v_mfma_f32_16x16x32_bf16 v[144:147], v[232:235], v[40:43], v[144:147]
    buffer_load_dwordx4 v[76:79], v4, s[8:11], s56 offen offset:2304 sc1
    v_mfma_f32_16x16x32_bf16 v[152:155], v[232:235], v[44:47], v[152:155]
    ds_read_b128 v[224:227], v2 offset:57344
    v_mfma_f32_16x16x32_bf16 v[148:151], v[236:239], v[40:43], v[148:151]
    buffer_load_dwordx4 v1, s[8:11], s57 offen offset:3072 sc1 lds
    v_mfma_f32_16x16x32_bf16 v[156:159], v[236:239], v[44:47], v[156:159]
    s_waitcnt lgkmcnt(3)
    ds_read_b128 v[228:231], v2 offset:58368
    v_mfma_f32_16x16x32_bf16 v[160:163], v[240:243], v[40:43], v[160:163]
    v_mfma_f32_16x16x32_bf16 v[168:171], v[240:243], v[44:47], v[168:171]
    s_add_u32 s56, s29, 12288
    ds_read_b128 v[232:235], v2 offset:59392
    v_mfma_f32_16x16x32_bf16 v[164:167], v[244:247], v[40:43], v[164:167]
    buffer_load_dwordx4 v[80:83], v4, s[8:11], s56 offen offset:0 sc1
    v_mfma_f32_16x16x32_bf16 v[172:175], v[244:247], v[44:47], v[172:175]
    s_waitcnt lgkmcnt(3)
    ds_read_b128 v[236:239], v2 offset:60416
    v_mfma_f32_16x16x32_bf16 v[176:179], v[248:251], v[40:43], v[176:179]
    v_mfma_f32_16x16x32_bf16 v[184:187], v[248:251], v[44:47], v[184:187]
    s_add_u32 s57, s99, 65536
    ds_read_b128 v[240:243], v2 offset:61440
    s_add_u32 m0, s97, 0
    v_mfma_f32_16x16x32_bf16 v[180:183], v[252:255], v[40:43], v[180:183]
    buffer_load_dwordx4 v1, s[8:11], s57 offen offset:0 sc1 lds
    v_mfma_f32_16x16x32_bf16 v[188:191], v[252:255], v[44:47], v[188:191]
    s_waitcnt lgkmcnt(3)
    ds_read_b128 v[244:247], v2 offset:62464
    v_mfma_f32_16x16x32_bf16 v[192:195], v[224:227], v[40:43], v[192:195]
    v_mfma_f32_16x16x32_bf16 v[200:203], v[224:227], v[44:47], v[200:203]
    ds_read_b128 v[248:251], v2 offset:63488
    v_mfma_f32_16x16x32_bf16 v[196:199], v[228:231], v[40:43], v[196:199]
    buffer_load_dwordx4 v1, s[8:11], s57 offen offset:1024 sc1 lds
    v_mfma_f32_16x16x32_bf16 v[204:207], v[228:231], v[44:47], v[204:207]
    s_waitcnt lgkmcnt(3)
    ds_read_b128 v[252:255], v2 offset:64512
    v_mfma_f32_16x16x32_bf16 v[208:211], v[232:235], v[40:43], v[208:211]
    s_waitcnt vmcnt(12)
    s_barrier
    v_mfma_f32_16x16x32_bf16 v[216:219], v[232:235], v[44:47], v[216:219]
    ds_read_b128 v[224:227], v3 offset:0
    v_mfma_f32_16x16x32_bf16 v[212:215], v[236:239], v[40:43], v[212:215]
    buffer_load_dwordx4 v[84:87], v4, s[8:11], s56 offen offset:256 sc1
    v_mfma_f32_16x16x32_bf16 v[220:223], v[236:239], v[44:47], v[220:223]
    s_waitcnt lgkmcnt(3)
    ds_read_b128 v[228:231], v3 offset:1024
    v_mfma_f32_16x16x32_bf16 v[112:115], v[240:243], v[48:51], v[112:115]
    buffer_load_dwordx4 v1, s[8:11], s57 offen offset:2048 sc1 lds
    v_mfma_f32_16x16x32_bf16 v[120:123], v[240:243], v[52:55], v[120:123]
    ds_read_b128 v[232:235], v3 offset:2048
    v_mfma_f32_16x16x32_bf16 v[116:119], v[244:247], v[48:51], v[116:119]
    v_mfma_f32_16x16x32_bf16 v[124:127], v[244:247], v[52:55], v[124:127]
    s_waitcnt lgkmcnt(3)
    ds_read_b128 v[236:239], v3 offset:3072
    v_mfma_f32_16x16x32_bf16 v[128:131], v[248:251], v[48:51], v[128:131]
    s_add_u32 s15, s13, L_gu0-L_pc+0
    s_min_u32 s15, s15, L_code_end-L_pc-4
    v_mov_b32 v28, s15
    v_mfma_f32_16x16x32_bf16 v[136:139], v[248:251], v[52:55], v[136:139]
    ds_read_b128 v[240:243], v3 offset:4096
    v_mfma_f32_16x16x32_bf16 v[132:135], v[252:255], v[48:51], v[132:135]
    buffer_load_dwordx4 v[88:91], v4, s[8:11], s56 offen offset:2048 sc1
    v_mfma_f32_16x16x32_bf16 v[140:143], v[252:255], v[52:55], v[140:143]
    s_waitcnt lgkmcnt(3)
    ds_read_b128 v[244:247], v3 offset:5120
    v_mfma_f32_16x16x32_bf16 v[144:147], v[224:227], v[48:51], v[144:147]
    global_load_dword a255, v28, s[4:5]
    v_mfma_f32_16x16x32_bf16 v[152:155], v[224:227], v[52:55], v[152:155]
    ds_read_b128 v[248:251], v3 offset:6144
    v_mfma_f32_16x16x32_bf16 v[148:151], v[228:231], v[48:51], v[148:151]
    buffer_load_dwordx4 v1, s[8:11], s57 offen offset:3072 sc1 lds
    v_mfma_f32_16x16x32_bf16 v[156:159], v[228:231], v[52:55], v[156:159]
    s_waitcnt lgkmcnt(3)
    ds_read_b128 v[252:255], v3 offset:7168
    v_mfma_f32_16x16x32_bf16 v[160:163], v[232:235], v[48:51], v[160:163]
    buffer_load_dwordx4 v[92:95], v4, s[8:11], s56 offen offset:2304 sc1
    v_mfma_f32_16x16x32_bf16 v[168:171], v[232:235], v[52:55], v[168:171]
    s_waitcnt vmcnt(13)
    ds_read_b128 v[224:227], v3 offset:8192
    v_mfma_f32_16x16x32_bf16 v[164:167], v[236:239], v[48:51], v[164:167]
    s_add_u32 s57, s99, 81920
    s_add_u32 m0, s97, 16384
    v_mfma_f32_16x16x32_bf16 v[172:175], v[236:239], v[52:55], v[172:175]
    s_waitcnt lgkmcnt(3)
    ds_read_b128 v[228:231], v3 offset:9216
    v_mfma_f32_16x16x32_bf16 v[176:179], v[240:243], v[48:51], v[176:179]
    buffer_load_dwordx4 v1, s[8:11], s57 offen offset:0 sc1 lds
    v_mfma_f32_16x16x32_bf16 v[184:187], v[240:243], v[52:55], v[184:187]
    ds_read_b128 v[232:235], v3 offset:10240
    v_add_f32 v16, v16, v18
    v_mfma_f32_16x16x32_bf16 v[180:183], v[244:247], v[48:51], v[180:183]
    buffer_load_dwordx4 v1, s[8:11], s57 offen offset:1024 sc1 lds
    v_mfma_f32_16x16x32_bf16 v[188:191], v[244:247], v[52:55], v[188:191]
    s_waitcnt lgkmcnt(3)
    ds_read_b128 v[236:239], v3 offset:11264
    v_mfma_f32_16x16x32_bf16 v[192:195], v[248:251], v[48:51], v[192:195]
    v_mfma_f32_16x16x32_bf16 v[200:203], v[248:251], v[52:55], v[200:203]
    s_add_u32 s56, s29, 16384
    ds_read_b128 v[240:243], v3 offset:12288
    v_add_f32 v17, v17, v19
    v_mfma_f32_16x16x32_bf16 v[196:199], v[252:255], v[48:51], v[196:199]
    buffer_load_dwordx4 v[96:99], v4, s[8:11], s56 offen offset:0 sc1
    v_mfma_f32_16x16x32_bf16 v[204:207], v[252:255], v[52:55], v[204:207]
    s_waitcnt lgkmcnt(3)
    ds_read_b128 v[244:247], v3 offset:13312
    v_mfma_f32_16x16x32_bf16 v[208:211], v[224:227], v[48:51], v[208:211]
    v_mfma_f32_16x16x32_bf16 v[216:219], v[224:227], v[52:55], v[216:219]
    ds_read_b128 v[248:251], v3 offset:14336
    v_add_f32 v20, v20, v22
    v_mfma_f32_16x16x32_bf16 v[212:215], v[228:231], v[48:51], v[212:215]
    buffer_load_dwordx4 v1, s[8:11], s57 offen offset:2048 sc1 lds
    v_mfma_f32_16x16x32_bf16 v[220:223], v[228:231], v[52:55], v[220:223]
    s_waitcnt lgkmcnt(3)
    ds_read_b128 v[252:255], v3 offset:15360
    v_mfma_f32_16x16x32_bf16 v[112:115], v[232:235], v[56:59], v[112:115]
    s_waitcnt vmcnt(13)
    s_barrier
    v_mfma_f32_16x16x32_bf16 v[120:123], v[232:235], v[60:63], v[120:123]
    ds_read_b128 v[224:227], v3 offset:16384
    v_mfma_f32_16x16x32_bf16 v[116:119], v[236:239], v[56:59], v[116:119]
    v_add_f32 v21, v21, v23
    v_mfma_f32_16x16x32_bf16 v[124:127], v[236:239], v[60:63], v[124:127]
    s_waitcnt lgkmcnt(3)
    ds_read_b128 v[228:231], v3 offset:17408
    buffer_load_dwordx4 v[100:103], v4, s[8:11], s56 offen offset:256 sc1
    v_mfma_f32_16x16x32_bf16 v[128:131], v[240:243], v[56:59], v[128:131]
    v_mfma_f32_16x16x32_bf16 v[136:139], v[240:243], v[60:63], v[136:139]
    ds_read_b128 v[232:235], v3 offset:18432
    v_mfma_f32_16x16x32_bf16 v[132:135], v[244:247], v[56:59], v[132:135]
    v_permlane32_swap_b32 v16, v20
    v_mfma_f32_16x16x32_bf16 v[140:143], v[244:247], v[60:63], v[140:143]
    s_waitcnt lgkmcnt(3)
    ds_read_b128 v[236:239], v3 offset:19456
    buffer_load_dwordx4 v1, s[8:11], s57 offen offset:3072 sc1 lds
    v_mfma_f32_16x16x32_bf16 v[144:147], v[248:251], v[56:59], v[144:147]
    buffer_load_dwordx4 v[104:107], v4, s[8:11], s56 offen offset:2048 sc1
    v_mfma_f32_16x16x32_bf16 v[152:155], v[248:251], v[60:63], v[152:155]
    ds_read_b128 v[240:243], v3 offset:20480
    v_mfma_f32_16x16x32_bf16 v[148:151], v[252:255], v[56:59], v[148:151]
    v_permlane32_swap_b32 v17, v21
    v_mfma_f32_16x16x32_bf16 v[156:159], v[252:255], v[60:63], v[156:159]
    s_waitcnt lgkmcnt(3)
    ds_read_b128 v[244:247], v3 offset:21504
    s_add_u32 s57, s99, 98304
    v_mfma_f32_16x16x32_bf16 v[160:163], v[224:227], v[56:59], v[160:163]
    s_add_u32 m0, s97, 98304
    v_mfma_f32_16x16x32_bf16 v[168:171], v[224:227], v[60:63], v[168:171]
    ds_read_b128 v[248:251], v3 offset:22528
    v_mfma_f32_16x16x32_bf16 v[164:167], v[228:231], v[56:59], v[164:167]
    buffer_load_dwordx4 v1, s[8:11], s57 offen offset:0 sc1 lds
    v_mfma_f32_16x16x32_bf16 v[172:175], v[228:231], v[60:63], v[172:175]
    s_waitcnt lgkmcnt(3)
    ds_read_b128 v[252:255], v3 offset:23552
    v_add_f32 v16, v16, v20
    v_mfma_f32_16x16x32_bf16 v[176:179], v[232:235], v[56:59], v[176:179]
    buffer_load_dwordx4 v[108:111], v4, s[8:11], s56 offen offset:2304 sc1
    v_mfma_f32_16x16x32_bf16 v[184:187], v[232:235], v[60:63], v[184:187]
    ds_read_b128 v[224:227], v3 offset:24576
    v_mfma_f32_16x16x32_bf16 v[180:183], v[236:239], v[56:59], v[180:183]
    s_add_u32 s56, s29, 20480
    v_mfma_f32_16x16x32_bf16 v[188:191], v[236:239], v[60:63], v[188:191]
    s_waitcnt lgkmcnt(3)
    ds_read_b128 v[228:231], v3 offset:25600
    v_add_f32 v17, v17, v21
    v_mfma_f32_16x16x32_bf16 v[192:195], v[240:243], v[56:59], v[192:195]
    buffer_load_dwordx4 v[32:35], v4, s[8:11], s56 offen offset:0 sc1
    v_mfma_f32_16x16x32_bf16 v[200:203], v[240:243], v[60:63], v[200:203]
    ds_read_b128 v[232:235], v3 offset:26624
    v_mfma_f32_16x16x32_bf16 v[196:199], v[244:247], v[56:59], v[196:199]
    v_mfma_f32_16x16x32_bf16 v[204:207], v[244:247], v[60:63], v[204:207]
    s_waitcnt lgkmcnt(3)
    ds_read_b128 v[236:239], v3 offset:27648
    v_mov_b32 v18, v16
    v_mfma_f32_16x16x32_bf16 v[208:211], v[248:251], v[56:59], v[208:211]
    buffer_load_dwordx4 v1, s[8:11], s57 offen offset:1024 sc1 lds
    v_mfma_f32_16x16x32_bf16 v[216:219], v[248:251], v[60:63], v[216:219]
    ds_read_b128 v[240:243], v3 offset:28672
    v_mfma_f32_16x16x32_bf16 v[212:215], v[252:255], v[56:59], v[212:215]
    buffer_load_dwordx4 v1, s[8:11], s57 offen offset:2048 sc1 lds
    v_mfma_f32_16x16x32_bf16 v[220:223], v[252:255], v[60:63], v[220:223]
    s_waitcnt lgkmcnt(3)
    ds_read_b128 v[244:247], v3 offset:29696
    v_mfma_f32_16x16x32_bf16 v[112:115], v[224:227], v[64:67], v[112:115]
    v_mov_b32 v19, v17
    v_mfma_f32_16x16x32_bf16 v[120:123], v[224:227], v[68:71], v[120:123]
    ds_read_b128 v[248:251], v3 offset:30720
    v_mfma_f32_16x16x32_bf16 v[116:119], v[228:231], v[64:67], v[116:119]
    buffer_load_dwordx4 v[36:39], v4, s[8:11], s56 offen offset:256 sc1
    v_mfma_f32_16x16x32_bf16 v[124:127], v[228:231], v[68:71], v[124:127]
    s_waitcnt lgkmcnt(3)
    ds_read_b128 v[252:255], v3 offset:31744
    v_mfma_f32_16x16x32_bf16 v[128:131], v[232:235], v[64:67], v[128:131]
    s_waitcnt vmcnt(14)
    s_barrier
    v_mfma_f32_16x16x32_bf16 v[136:139], v[232:235], v[68:71], v[136:139]
    ds_read_b128 v[224:227], v1 offset:0
    v_add_u32 v21, 0, v6
    v_mfma_f32_16x16x32_bf16 v[132:135], v[236:239], v[64:67], v[132:135]
    buffer_load_dwordx4 v1, s[8:11], s57 offen offset:3072 sc1 lds
    v_mfma_f32_16x16x32_bf16 v[140:143], v[236:239], v[68:71], v[140:143]
    s_waitcnt lgkmcnt(3)
    ds_read_b128 v[228:231], v1 offset:1024
    v_mfma_f32_16x16x32_bf16 v[144:147], v[240:243], v[64:67], v[144:147]
    v_add_u32 v22, 65536, v6
    v_mfma_f32_16x16x32_bf16 v[152:155], v[240:243], v[68:71], v[152:155]
    ds_read_b128 v[232:235], v1 offset:2048
    v_mfma_f32_16x16x32_bf16 v[148:151], v[244:247], v[64:67], v[148:151]
    buffer_load_dwordx4 v[40:43], v4, s[8:11], s56 offen offset:2048 sc1
    v_mfma_f32_16x16x32_bf16 v[156:159], v[244:247], v[68:71], v[156:159]
    s_waitcnt lgkmcnt(3)
    ds_read_b128 v[236:239], v1 offset:3072
    v_mfma_f32_16x16x32_bf16 v[160:163], v[248:251], v[64:67], v[160:163]
    s_add_u32 s57, s99, 114688
    s_add_u32 m0, s97, 114688
    v_mfma_f32_16x16x32_bf16 v[168:171], v[248:251], v[68:71], v[168:171]
    ds_read_b128 v[240:243], v1 offset:4096
    v_add_u32 v23, 131072, v6
    v_mfma_f32_16x16x32_bf16 v[164:167], v[252:255], v[64:67], v[164:167]
    buffer_load_dwordx4 v1, s[8:11], s57 offen offset:0 sc1 lds
    v_mfma_f32_16x16x32_bf16 v[172:175], v[252:255], v[68:71], v[172:175]
    s_waitcnt lgkmcnt(3)
    ds_read_b128 v[244:247], v1 offset:5120
    v_mfma_f32_16x16x32_bf16 v[176:179], v[224:227], v[64:67], v[176:179]
    buffer_load_dwordx4 v1, s[8:11], s57 offen offset:1024 sc1 lds
    v_mfma_f32_16x16x32_bf16 v[184:187], v[224:227], v[68:71], v[184:187]
    ds_read_b128 v[248:251], v1 offset:6144
    v_mfma_f32_16x16x32_bf16 v[180:183], v[228:231], v[64:67], v[180:183]
    v_permlane16_swap_b32 v16, v18
    v_mfma_f32_16x16x32_bf16 v[188:191], v[228:231], v[68:71], v[188:191]
    s_waitcnt lgkmcnt(3)
    ds_read_b128 v[252:255], v1 offset:7168
    v_mfma_f32_16x16x32_bf16 v[192:195], v[232:235], v[64:67], v[192:195]
    buffer_load_dwordx4 v[44:47], v4, s[8:11], s56 offen offset:2304 sc1
    v_mfma_f32_16x16x32_bf16 v[200:203], v[232:235], v[68:71], v[200:203]
    ds_read_b128 v[224:227], v1 offset:8192
    v_mfma_f32_16x16x32_bf16 v[196:199], v[236:239], v[64:67], v[196:199]
    v_permlane16_swap_b32 v17, v19
    v_mfma_f32_16x16x32_bf16 v[204:207], v[236:239], v[68:71], v[204:207]
    s_waitcnt lgkmcnt(3)
    ds_read_b128 v[228:231], v1 offset:9216
    v_mfma_f32_16x16x32_bf16 v[208:211], v[240:243], v[64:67], v[208:211]
    buffer_load_dwordx4 v1, s[8:11], s57 offen offset:2048 sc1 lds
    v_mfma_f32_16x16x32_bf16 v[216:219], v[240:243], v[68:71], v[216:219]
    ds_read_b128 v[232:235], v1 offset:10240
    v_mfma_f32_16x16x32_bf16 v[212:215], v[244:247], v[64:67], v[212:215]
    s_add_u32 s56, s29, 24576
    v_add_f32 v16, v16, v18
    v_mfma_f32_16x16x32_bf16 v[220:223], v[244:247], v[68:71], v[220:223]
    s_waitcnt lgkmcnt(3)
    ds_read_b128 v[236:239], v1 offset:11264
    v_mfma_f32_16x16x32_bf16 v[112:115], v[248:251], v[72:75], v[112:115]
    buffer_load_dwordx4 v[48:51], v4, s[8:11], s56 offen offset:0 sc1
    v_mfma_f32_16x16x32_bf16 v[120:123], v[248:251], v[76:79], v[120:123]
    ds_read_b128 v[240:243], v1 offset:12288
    v_mfma_f32_16x16x32_bf16 v[116:119], v[252:255], v[72:75], v[116:119]
    v_add_f32 v17, v17, v19
    v_mfma_f32_16x16x32_bf16 v[124:127], v[252:255], v[76:79], v[124:127]
    s_waitcnt lgkmcnt(3)
    ds_read_b128 v[244:247], v1 offset:13312
    v_mfma_f32_16x16x32_bf16 v[128:131], v[224:227], v[72:75], v[128:131]
    buffer_load_dwordx4 v1, s[8:11], s57 offen offset:3072 sc1 lds
    v_mfma_f32_16x16x32_bf16 v[136:139], v[224:227], v[76:79], v[136:139]
    s_add_u32 s57, s99, 131072
    ds_read_b128 v[248:251], v1 offset:14336
    s_add_u32 m0, s97, 131072
    v_mfma_f32_16x16x32_bf16 v[132:135], v[228:231], v[72:75], v[132:135]
    v_mul_f32 v16, 0x3b000000, v16
    v_mfma_f32_16x16x32_bf16 v[140:143], v[228:231], v[76:79], v[140:143]
    s_waitcnt lgkmcnt(3)
    ds_read_b128 v[252:255], v1 offset:15360
    v_mfma_f32_16x16x32_bf16 v[144:147], v[232:235], v[72:75], v[144:147]
    s_waitcnt vmcnt(15)
    s_barrier
    v_mfma_f32_16x16x32_bf16 v[152:155], v[232:235], v[76:79], v[152:155]
    ds_read_b128 v[224:227], v1 offset:16384
    buffer_load_dwordx4 v1, s[8:11], s57 offen offset:0 sc1 lds
    v_mfma_f32_16x16x32_bf16 v[148:151], v[236:239], v[72:75], v[148:151]
    buffer_load_dwordx4 v[52:55], v4, s[8:11], s56 offen offset:256 sc1
    v_mfma_f32_16x16x32_bf16 v[156:159], v[236:239], v[76:79], v[156:159]
    s_waitcnt lgkmcnt(3)
    ds_read_b128 v[228:231], v1 offset:17408
    v_mul_f32 v18, v16, v16
    v_mfma_f32_16x16x32_bf16 v[160:163], v[240:243], v[72:75], v[160:163]
    v_mfma_f32_16x16x32_bf16 v[168:171], v[240:243], v[76:79], v[168:171]
    ds_read_b128 v[232:235], v1 offset:18432
    v_mfma_f32_16x16x32_bf16 v[164:167], v[244:247], v[72:75], v[164:167]
    buffer_load_dwordx4 v1, s[8:11], s57 offen offset:1024 sc1 lds
    v_mfma_f32_16x16x32_bf16 v[172:175], v[244:247], v[76:79], v[172:175]
    s_waitcnt lgkmcnt(3)
    ds_read_b128 v[236:239], v1 offset:19456
    v_mul_f32 v17, 0x3b000000, v17
    v_mfma_f32_16x16x32_bf16 v[176:179], v[248:251], v[72:75], v[176:179]
    v_mfma_f32_16x16x32_bf16 v[184:187], v[248:251], v[76:79], v[184:187]
    ds_read_b128 v[240:243], v1 offset:20480
    v_mfma_f32_16x16x32_bf16 v[180:183], v[252:255], v[72:75], v[180:183]
    buffer_load_dwordx4 v[56:59], v4, s[8:11], s56 offen offset:2048 sc1
    v_mfma_f32_16x16x32_bf16 v[188:191], v[252:255], v[76:79], v[188:191]
    s_waitcnt lgkmcnt(3)
    ds_read_b128 v[244:247], v1 offset:21504
    v_sub_f32 v17, v17, v18
    v_mfma_f32_16x16x32_bf16 v[192:195], v[224:227], v[72:75], v[192:195]
    v_mfma_f32_16x16x32_bf16 v[200:203], v[224:227], v[76:79], v[200:203]
    ds_read_b128 v[248:251], v1 offset:22528
    v_mfma_f32_16x16x32_bf16 v[196:199], v[228:231], v[72:75], v[196:199]
    buffer_load_dwordx4 v1, s[8:11], s57 offen offset:2048 sc1 lds
    v_mfma_f32_16x16x32_bf16 v[204:207], v[228:231], v[76:79], v[204:207]
    s_waitcnt lgkmcnt(3)
    ds_read_b128 v[252:255], v1 offset:23552
    v_mfma_f32_16x16x32_bf16 v[208:211], v[232:235], v[72:75], v[208:211]
    v_max_f32 v17, 0, v17
    v_mfma_f32_16x16x32_bf16 v[216:219], v[232:235], v[76:79], v[216:219]
    ds_read_b128 v[224:227], v1 offset:24576
    v_mfma_f32_16x16x32_bf16 v[212:215], v[236:239], v[72:75], v[212:215]
    buffer_load_dwordx4 v1, s[8:11], s57 offen offset:3072 sc1 lds
    v_mfma_f32_16x16x32_bf16 v[220:223], v[236:239], v[76:79], v[220:223]
    s_waitcnt lgkmcnt(3)
    ds_read_b128 v[228:231], v1 offset:25600
    v_mfma_f32_16x16x32_bf16 v[112:115], v[240:243], v[80:83], v[112:115]
    v_cvt_pk_bf16_f32 v17, v17, v17
    v_mfma_f32_16x16x32_bf16 v[120:123], v[240:243], v[84:87], v[120:123]
    ds_read_b128 v[232:235], v1 offset:26624
    v_mfma_f32_16x16x32_bf16 v[116:119], v[244:247], v[80:83], v[116:119]
    buffer_load_dwordx4 v[60:63], v4, s[8:11], s56 offen offset:2304 sc1
    v_mfma_f32_16x16x32_bf16 v[124:127], v[244:247], v[84:87], v[124:127]
    s_waitcnt lgkmcnt(3)
    ds_read_b128 v[236:239], v1 offset:27648
    s_add_u32 s57, s99, 147456
    v_mfma_f32_16x16x32_bf16 v[128:131], v[248:251], v[80:83], v[128:131]
    s_add_u32 m0, s97, 147456
    v_lshlrev_b32 v17, 16, v17
    v_mfma_f32_16x16x32_bf16 v[136:139], v[248:251], v[84:87], v[136:139]
    ds_read_b128 v[240:243], v1 offset:28672
    buffer_load_dwordx4 v1, s[8:11], s57 offen offset:0 sc1 lds
    v_mfma_f32_16x16x32_bf16 v[132:135], v[252:255], v[80:83], v[132:135]
    s_add_u32 s56, s29, 28672
    v_mfma_f32_16x16x32_bf16 v[140:143], v[252:255], v[84:87], v[140:143]
    s_waitcnt lgkmcnt(3)
    ds_read_b128 v[244:247], v1 offset:29696
    v_mfma_f32_16x16x32_bf16 v[144:147], v[224:227], v[80:83], v[144:147]
    v_add_f32 v17, 0x3727c5ac, v17
    v_mfma_f32_16x16x32_bf16 v[152:155], v[224:227], v[84:87], v[152:155]
    ds_read_b128 v[248:251], v1 offset:30720
    buffer_load_dwordx4 v[64:67], v4, s[8:11], s56 offen offset:0 sc1
    v_mfma_f32_16x16x32_bf16 v[148:151], v[228:231], v[80:83], v[148:151]
    v_mfma_f32_16x16x32_bf16 v[156:159], v[228:231], v[84:87], v[156:159]
    s_waitcnt lgkmcnt(3)
    ds_read_b128 v[252:255], v1 offset:31744
    v_mfma_f32_16x16x32_bf16 v[160:163], v[232:235], v[80:83], v[160:163]
    s_waitcnt vmcnt(16)
    s_barrier
    v_mfma_f32_16x16x32_bf16 v[168:171], v[232:235], v[84:87], v[168:171]
    ds_read_b128 v[224:227], v2 offset:32768
    v_cvt_pk_bf16_f32 v17, v17, v17
    v_mfma_f32_16x16x32_bf16 v[164:167], v[236:239], v[80:83], v[164:167]
    buffer_load_dwordx4 v1, s[8:11], s57 offen offset:1024 sc1 lds
    v_mfma_f32_16x16x32_bf16 v[172:175], v[236:239], v[84:87], v[172:175]
    s_waitcnt lgkmcnt(3)
    ds_read_b128 v[228:231], v2 offset:33792
    v_mfma_f32_16x16x32_bf16 v[176:179], v[240:243], v[80:83], v[176:179]
    buffer_load_dwordx4 v1, s[8:11], s57 offen offset:2048 sc1 lds
    v_mfma_f32_16x16x32_bf16 v[184:187], v[240:243], v[84:87], v[184:187]
    ds_read_b128 v[232:235], v2 offset:34816
    v_lshlrev_b32 v17, 16, v17
    v_mfma_f32_16x16x32_bf16 v[180:183], v[244:247], v[80:83], v[180:183]
    buffer_load_dwordx4 v[68:71], v4, s[8:11], s56 offen offset:256 sc1
    v_mfma_f32_16x16x32_bf16 v[188:191], v[244:247], v[84:87], v[188:191]
    s_waitcnt lgkmcnt(3)
    ds_read_b128 v[236:239], v2 offset:35840
    v_mfma_f32_16x16x32_bf16 v[192:195], v[248:251], v[80:83], v[192:195]
    v_mfma_f32_16x16x32_bf16 v[200:203], v[248:251], v[84:87], v[200:203]
    ds_read_b128 v[240:243], v2 offset:36864
    v_mfma_f32_16x16x32_bf16 v[196:199], v[252:255], v[80:83], v[196:199]
    v_sqrt_f32 v17, v17
    v_mfma_f32_16x16x32_bf16 v[204:207], v[252:255], v[84:87], v[204:207]
    s_waitcnt lgkmcnt(3)
    ds_read_b128 v[244:247], v2 offset:37888
    buffer_load_dwordx4 v1, s[8:11], s57 offen offset:3072 sc1 lds
    v_mfma_f32_16x16x32_bf16 v[208:211], v[224:227], v[80:83], v[208:211]
    v_mfma_f32_16x16x32_bf16 v[216:219], v[224:227], v[84:87], v[216:219]
    ds_read_b128 v[248:251], v2 offset:38912
    v_mfma_f32_16x16x32_bf16 v[212:215], v[228:231], v[80:83], v[212:215]
    v_cvt_pk_bf16_f32 v17, v17, v17
    v_mfma_f32_16x16x32_bf16 v[220:223], v[228:231], v[84:87], v[220:223]
    s_waitcnt lgkmcnt(3)
    ds_read_b128 v[252:255], v2 offset:39936
    buffer_load_dwordx4 v[72:75], v4, s[8:11], s56 offen offset:2048 sc1
    v_mfma_f32_16x16x32_bf16 v[112:115], v[232:235], v[88:91], v[112:115]
    s_add_u32 s57, s99, 163840
    s_add_u32 m0, s97, 0
    v_mfma_f32_16x16x32_bf16 v[120:123], v[232:235], v[92:95], v[120:123]
    ds_read_b128 v[224:227], v2 offset:40960
    v_mfma_f32_16x16x32_bf16 v[116:119], v[236:239], v[88:91], v[116:119]
    v_lshlrev_b32 v17, 16, v17
    v_mfma_f32_16x16x32_bf16 v[124:127], v[236:239], v[92:95], v[124:127]
    s_waitcnt lgkmcnt(3)
    ds_read_b128 v[228:231], v2 offset:41984
    buffer_load_dwordx4 v1, s[8:11], s57 offen offset:0 sc1 lds
    v_mfma_f32_16x16x32_bf16 v[128:131], v[240:243], v[88:91], v[128:131]
    buffer_load_dwordx4 v1, s[8:11], s57 offen offset:1024 sc1 lds
    v_mfma_f32_16x16x32_bf16 v[136:139], v[240:243], v[92:95], v[136:139]
    ds_read_b128 v[232:235], v2 offset:43008
    v_mfma_f32_16x16x32_bf16 v[132:135], v[244:247], v[88:91], v[132:135]
    v_rcp_f32 v17, v17
    v_mfma_f32_16x16x32_bf16 v[140:143], v[244:247], v[92:95], v[140:143]
    s_waitcnt lgkmcnt(3)
    ds_read_b128 v[236:239], v2 offset:44032
    v_mfma_f32_16x16x32_bf16 v[144:147], v[248:251], v[88:91], v[144:147]
    buffer_load_dwordx4 v[76:79], v4, s[8:11], s56 offen offset:2304 sc1
    v_mfma_f32_16x16x32_bf16 v[152:155], v[248:251], v[92:95], v[152:155]
    ds_read_b128 v[240:243], v2 offset:45056
    v_mfma_f32_16x16x32_bf16 v[148:151], v[252:255], v[88:91], v[148:151]
    v_mfma_f32_16x16x32_bf16 v[156:159], v[252:255], v[92:95], v[156:159]
    s_waitcnt lgkmcnt(3)
    ds_read_b128 v[244:247], v2 offset:46080
    v_cvt_pk_bf16_f32 v24, -v16, -v16
    v_mfma_f32_16x16x32_bf16 v[160:163], v[224:227], v[88:91], v[160:163]
    buffer_load_dwordx4 v1, s[8:11], s57 offen offset:2048 sc1 lds
    v_mfma_f32_16x16x32_bf16 v[168:171], v[224:227], v[92:95], v[168:171]
    ds_read_b128 v[248:251], v2 offset:47104
    v_mfma_f32_16x16x32_bf16 v[164:167], v[228:231], v[88:91], v[164:167]
    v_mfma_f32_16x16x32_bf16 v[172:175], v[228:231], v[92:95], v[172:175]
    s_waitcnt lgkmcnt(3)
    ds_read_b128 v[252:255], v2 offset:48128
    v_cvt_pk_bf16_f32 v25, -v16, -v16
    v_mfma_f32_16x16x32_bf16 v[176:179], v[232:235], v[88:91], v[176:179]
    s_waitcnt vmcnt(18)
    s_barrier
    v_mfma_f32_16x16x32_bf16 v[184:187], v[232:235], v[92:95], v[184:187]
    ds_read_b128 v[224:227], v2 offset:49152
    v_mfma_f32_16x16x32_bf16 v[180:183], v[236:239], v[88:91], v[180:183]
    buffer_load_dwordx4 v1, s[8:11], s57 offen offset:3072 sc1 lds
    v_mfma_f32_16x16x32_bf16 v[188:191], v[236:239], v[92:95], v[188:191]
    s_waitcnt lgkmcnt(3)
    ds_read_b128 v[228:231], v2 offset:50176
    v_cvt_pk_bf16_f32 v26, -v16, -v16
    v_mfma_f32_16x16x32_bf16 v[192:195], v[240:243], v[88:91], v[192:195]
    v_mfma_f32_16x16x32_bf16 v[200:203], v[240:243], v[92:95], v[200:203]
    ds_read_b128 v[232:235], v2 offset:51200
    v_mfma_f32_16x16x32_bf16 v[196:199], v[244:247], v[88:91], v[196:199]
    buffer_load_dwordx4 a[72:75], v1, s[8:11], s58 offen offset:2048 sc1
    v_mfma_f32_16x16x32_bf16 v[204:207], v[244:247], v[92:95], v[204:207]
    s_waitcnt lgkmcnt(3)
    ds_read_b128 v[236:239], v2 offset:52224
    v_mfma_f32_16x16x32_bf16 v[208:211], v[248:251], v[88:91], v[208:211]
    s_add_u32 s57, s99, 180224
    v_cvt_pk_bf16_f32 v27, -v16, -v16
    s_add_u32 m0, s97, 16384
    v_mfma_f32_16x16x32_bf16 v[216:219], v[248:251], v[92:95], v[216:219]
    ds_read_b128 v[240:243], v2 offset:53248
    v_mfma_f32_16x16x32_bf16 v[212:215], v[252:255], v[88:91], v[212:215]
    buffer_load_dwordx4 v1, s[8:11], s57 offen offset:0 sc1 lds
    v_mfma_f32_16x16x32_bf16 v[220:223], v[252:255], v[92:95], v[220:223]
    s_waitcnt lgkmcnt(3)
    ds_read_b128 v[244:247], v2 offset:54272
    v_mfma_f32_16x16x32_bf16 v[112:115], v[224:227], v[96:99], v[112:115]
    v_mul_f32 v17, v17, v17
    v_mfma_f32_16x16x32_bf16 v[120:123], v[224:227], v[100:103], v[120:123]
    ds_read_b128 v[248:251], v2 offset:55296
    v_mfma_f32_16x16x32_bf16 v[116:119], v[228:231], v[96:99], v[116:119]
    v_mfma_f32_16x16x32_bf16 v[124:127], v[228:231], v[100:103], v[124:127]
    s_waitcnt lgkmcnt(3)
    ds_read_b128 v[252:255], v2 offset:56320
    v_mfma_f32_16x16x32_bf16 v[128:131], v[232:235], v[96:99], v[128:131]
    s_lshr_b32 s60, s39, 3
    buffer_load_dwordx4 a[76:79], v1, s[8:11], s58 offen offset:3072 sc1
    v_mfma_f32_16x16x32_bf16 v[136:139], v[232:235], v[100:103], v[136:139]
    s_add_u32 s60, s60, 110592
    ds_read_b128 v[224:227], v2 offset:57344
    v_mfma_f32_16x16x32_bf16 v[132:135], v[236:239], v[96:99], v[132:135]
    buffer_load_dwordx4 v1, s[8:11], s57 offen offset:1024 sc1 lds
    v_mfma_f32_16x16x32_bf16 v[140:143], v[236:239], v[100:103], v[140:143]
    s_waitcnt lgkmcnt(3)
    ds_read_b128 v[228:231], v2 offset:58368
    v_mfma_f32_16x16x32_bf16 v[144:147], v[240:243], v[96:99], v[144:147]
    v_mfma_f32_16x16x32_bf16 v[152:155], v[240:243], v[100:103], v[152:155]
    ds_read_b128 v[232:235], v2 offset:59392
    v_and_or_b32 v16, v6, 63, s60
    v_mfma_f32_16x16x32_bf16 v[148:151], v[244:247], v[96:99], v[148:151]
    v_mfma_f32_16x16x32_bf16 v[156:159], v[244:247], v[100:103], v[156:159]
    s_waitcnt lgkmcnt(3)
    ds_read_b128 v[236:239], v2 offset:60416
    v_mfma_f32_16x16x32_bf16 v[160:163], v[248:251], v[96:99], v[160:163]
    buffer_load_dwordx4 v1, s[8:11], s57 offen offset:2048 sc1 lds
    v_mfma_f32_16x16x32_bf16 v[168:171], v[248:251], v[100:103], v[168:171]
    ds_read_b128 v[240:243], v2 offset:61440
    v_and_b32 v18, 32, v0
    v_mfma_f32_16x16x32_bf16 v[164:167], v[252:255], v[96:99], v[164:167]
    v_mfma_f32_16x16x32_bf16 v[172:175], v[252:255], v[100:103], v[172:175]
    s_waitcnt lgkmcnt(3)
    ds_read_b128 v[244:247], v2 offset:62464
    v_mfma_f32_16x16x32_bf16 v[176:179], v[224:227], v[96:99], v[176:179]
    v_mfma_f32_16x16x32_bf16 v[184:187], v[224:227], v[100:103], v[184:187]
    s_add_u32 s58, s38, 36864
    ds_read_b128 v[248:251], v2 offset:63488
    v_lshl_add_u32 v16, v18, 1, v16
    v_mfma_f32_16x16x32_bf16 v[180:183], v[228:231], v[96:99], v[180:183]
    buffer_load_dwordx4 a[144:147], v1, s[8:11], s58 offen offset:0 sc1
    v_mfma_f32_16x16x32_bf16 v[188:191], v[228:231], v[100:103], v[188:191]
    s_waitcnt lgkmcnt(3)
    ds_read_b128 v[252:255], v2 offset:64512
    v_mfma_f32_16x16x32_bf16 v[192:195], v[232:235], v[96:99], v[192:195]
    s_waitcnt vmcnt(19)
    s_barrier
    v_mfma_f32_16x16x32_bf16 v[200:203], v[232:235], v[100:103], v[200:203]
    ds_read_b128 v[224:227], v3 offset:0
    v_mfma_f32_16x16x32_bf16 v[196:199], v[236:239], v[96:99], v[196:199]
    v_permlane32_swap_b32 v24, v26
    v_mfma_f32_16x16x32_bf16 v[204:207], v[236:239], v[100:103], v[204:207]
    s_waitcnt lgkmcnt(3)
    ds_read_b128 v[228:231], v3 offset:1024
    buffer_load_dwordx4 v1, s[8:11], s57 offen offset:3072 sc1 lds
    v_mfma_f32_16x16x32_bf16 v[208:211], v[240:243], v[96:99], v[208:211]
    v_mfma_f32_16x16x32_bf16 v[216:219], v[240:243], v[100:103], v[216:219]
    ds_read_b128 v[232:235], v3 offset:2048
    v_mfma_f32_16x16x32_bf16 v[212:215], v[244:247], v[96:99], v[212:215]
    v_permlane32_swap_b32 v25, v27
    v_mfma_f32_16x16x32_bf16 v[220:223], v[244:247], v[100:103], v[220:223]
    s_waitcnt lgkmcnt(3)
    ds_read_b128 v[236:239], v3 offset:3072
    v_mfma_f32_16x16x32_bf16 v[112:115], v[248:251], v[104:107], v[112:115]
    buffer_load_dwordx4 a[148:151], v1, s[8:11], s58 offen offset:1024 sc1
    v_mfma_f32_16x16x32_bf16 v[120:123], v[248:251], v[108:111], v[120:123]
    s_add_u32 s57, s99, 196608
    ds_read_b128 v[240:243], v3 offset:4096
    s_add_u32 m0, s97, 98304
    v_mfma_f32_16x16x32_bf16 v[116:119], v[252:255], v[104:107], v[116:119]
    buffer_load_dwordx4 v1, s[8:11], s57 offen offset:0 sc1 lds
    v_mfma_f32_16x16x32_bf16 v[124:127], v[252:255], v[108:111], v[124:127]
    s_waitcnt lgkmcnt(3)
    ds_read_b128 v[244:247], v3 offset:5120
    v_mfma_f32_16x16x32_bf16 v[128:131], v[224:227], v[104:107], v[128:131]
    v_mfma_f32_16x16x32_bf16 v[136:139], v[224:227], v[108:111], v[136:139]
    ds_read_b128 v[248:251], v3 offset:6144
    v_mfma_f32_16x16x32_bf16 v[132:135], v[228:231], v[104:107], v[132:135]
    v_mfma_f32_16x16x32_bf16 v[140:143], v[228:231], v[108:111], v[140:143]
    s_waitcnt lgkmcnt(3)
    ds_read_b128 v[252:255], v3 offset:7168
    v_mfma_f32_16x16x32_bf16 v[144:147], v[232:235], v[104:107], v[144:147]
    buffer_load_dwordx4 a[152:155], v1, s[8:11], s58 offen offset:2048 sc1
    v_mfma_f32_16x16x32_bf16 v[152:155], v[232:235], v[108:111], v[152:155]
    ds_read_b128 v[224:227], v3 offset:8192
    v_mfma_f32_16x16x32_bf16 v[148:151], v[236:239], v[104:107], v[148:151]
    v_mfma_f32_16x16x32_bf16 v[156:159], v[236:239], v[108:111], v[156:159]
    s_waitcnt lgkmcnt(3)
    ds_read_b128 v[228:231], v3 offset:9216
    v_mfma_f32_16x16x32_bf16 v[160:163], v[240:243], v[104:107], v[160:163]
    buffer_load_dwordx4 v1, s[8:11], s57 offen offset:1024 sc1 lds
    v_mfma_f32_16x16x32_bf16 v[168:171], v[240:243], v[108:111], v[168:171]
    ds_read_b128 v[232:235], v3 offset:10240
    v_mfma_f32_16x16x32_bf16 v[164:167], v[244:247], v[104:107], v[164:167]
    v_mfma_f32_16x16x32_bf16 v[172:175], v[244:247], v[108:111], v[172:175]
    s_waitcnt lgkmcnt(3)
    ds_read_b128 v[236:239], v3 offset:11264
    v_mfma_f32_16x16x32_bf16 v[176:179], v[248:251], v[104:107], v[176:179]
    v_mfma_f32_16x16x32_bf16 v[184:187], v[248:251], v[108:111], v[184:187]
    ds_read_b128 v[240:243], v3 offset:12288
    v_mfma_f32_16x16x32_bf16 v[180:183], v[252:255], v[104:107], v[180:183]
    buffer_load_dwordx4 a[156:159], v1, s[8:11], s58 offen offset:3072 sc1
    v_mfma_f32_16x16x32_bf16 v[188:191], v[252:255], v[108:111], v[188:191]
    s_waitcnt lgkmcnt(3)
    ds_read_b128 v[244:247], v3 offset:13312
    v_mfma_f32_16x16x32_bf16 v[192:195], v[224:227], v[104:107], v[192:195]
    buffer_load_dwordx4 v1, s[8:11], s57 offen offset:2048 sc1 lds
    v_mfma_f32_16x16x32_bf16 v[200:203], v[224:227], v[108:111], v[200:203]
    ds_read_b128 v[248:251], v3 offset:14336
    v_mfma_f32_16x16x32_bf16 v[196:199], v[228:231], v[104:107], v[196:199]
    v_mfma_f32_16x16x32_bf16 v[204:207], v[228:231], v[108:111], v[204:207]
    s_waitcnt lgkmcnt(3)
    ds_read_b128 v[252:255], v3 offset:15360
    v_mfma_f32_16x16x32_bf16 v[208:211], v[232:235], v[104:107], v[208:211]
    s_waitcnt vmcnt(19)
    s_barrier
    v_mfma_f32_16x16x32_bf16 v[216:219], v[232:235], v[108:111], v[216:219]
    ds_read_b128 v[224:227], v3 offset:16384
    v_mfma_f32_16x16x32_bf16 v[212:215], v[236:239], v[104:107], v[212:215]
    buffer_load_dwordx4 v1, s[8:11], s57 offen offset:3072 sc1 lds
    v_mfma_f32_16x16x32_bf16 v[220:223], v[236:239], v[108:111], v[220:223]
    s_waitcnt lgkmcnt(3)
    ds_read_b128 v[228:231], v3 offset:17408
    v_mfma_f32_16x16x32_bf16 v[112:115], v[240:243], v[32:35], v[112:115]
    s_add_u32 s15, s13, L_dn0-L_pc+0
    s_min_u32 s15, s15, L_code_end-L_pc-4
    v_mov_b32 v19, s15
    v_mfma_f32_16x16x32_bf16 v[120:123], v[240:243], v[36:39], v[120:123]
    ds_read_b128 v[232:235], v3 offset:18432
    v_mfma_f32_16x16x32_bf16 v[116:119], v[244:247], v[32:35], v[116:119]
    global_load_dword a255, v19, s[4:5]
    v_mfma_f32_16x16x32_bf16 v[124:127], v[244:247], v[36:39], v[124:127]
    s_waitcnt lgkmcnt(3)
    ds_read_b128 v[236:239], v3 offset:19456
    s_add_u32 s58, s38, 40960
    v_mfma_f32_16x16x32_bf16 v[112:115], v[248:251], v[40:43], v[112:115]
    buffer_load_dwordx4 a[160:163], v1, s[8:11], s58 offen offset:0 sc1
    v_mfma_f32_16x16x32_bf16 v[120:123], v[248:251], v[44:47], v[120:123]
    ds_read_b128 v[240:243], v3 offset:20480
    v_mfma_f32_16x16x32_bf16 v[116:119], v[252:255], v[40:43], v[116:119]
    v_mfma_f32_16x16x32_bf16 v[124:127], v[252:255], v[44:47], v[124:127]
    s_waitcnt lgkmcnt(3)
    ds_read_b128 v[244:247], v3 offset:21504
    v_mfma_f32_16x16x32_bf16 v[112:115], v[224:227], v[48:51], v[112:115]
    buffer_load_dwordx4 a[164:167], v1, s[8:11], s58 offen offset:1024 sc1
    v_mfma_f32_16x16x32_bf16 v[120:123], v[224:227], v[52:55], v[120:123]
    ds_read_b128 v[248:251], v3 offset:22528
    v_mfma_f32_16x16x32_bf16 v[116:119], v[228:231], v[48:51], v[116:119]
    s_add_u32 s57, s99, 212992
    s_add_u32 m0, s97, 114688
    v_mfma_f32_16x16x32_bf16 v[124:127], v[228:231], v[52:55], v[124:127]
    s_waitcnt lgkmcnt(3)
    ds_read_b128 v[252:255], v3 offset:23552
    v_mfma_f32_16x16x32_bf16 v[112:115], v[232:235], v[56:59], v[112:115]
    buffer_load_dwordx4 v1, s[8:11], s57 offen offset:0 sc1 lds
    v_mfma_f32_16x16x32_bf16 v[120:123], v[232:235], v[60:63], v[120:123]
    ds_read2st64_b32 v[224:225], v23 offset0:96 offset1:97
    ds_read2st64_b32 v[226:227], v23 offset0:98 offset1:99
    v_mfma_f32_16x16x32_bf16 v[116:119], v[236:239], v[56:59], v[116:119]
    v_mfma_f32_16x16x32_bf16 v[124:127], v[236:239], v[60:63], v[124:127]
    s_waitcnt lgkmcnt(4)
    ds_read_b128 v[228:231], v3 offset:25600
    v_mfma_f32_16x16x32_bf16 v[112:115], v[240:243], v[64:67], v[112:115]
    buffer_load_dwordx4 v1, s[8:11], s57 offen offset:1024 sc1 lds
    v_mfma_f32_16x16x32_bf16 v[120:123], v[240:243], v[68:71], v[120:123]
    ds_read_b128 v[232:235], v3 offset:26624
    v_mfma_f32_16x16x32_bf16 v[116:119], v[244:247], v[64:67], v[116:119]
    v_mfma_f32_16x16x32_bf16 v[124:127], v[244:247], v[68:71], v[124:127]
    s_waitcnt vmcnt(21) lgkmcnt(4)
    ds_read_b128 v[236:239], v3 offset:27648
    v_mfma_f32_16x16x32_bf16 v[112:115], v[248:251], v[72:75], v[112:115]
    v_mfma_f32_16x16x32_bf16 v[120:123], v[248:251], v[76:79], v[120:123]
    ds_read_b128 v[240:243], v3 offset:28672
    v_mfma_f32_16x16x32_bf16 v[116:119], v[252:255], v[72:75], v[116:119]
    buffer_load_dwordx4 a[168:171], v1, s[8:11], s58 offen offset:2048 sc1
    v_mfma_f32_16x16x32_bf16 v[124:127], v[252:255], v[76:79], v[124:127]
    s_waitcnt lgkmcnt(3)
    ds_read_b128 v[244:247], v3 offset:29696
    v_mfma_f32_16x16x16_bf16 v[112:115], v[224:225], v[24:25], v[112:115]
    v_mfma_f32_16x16x16_bf16 v[120:123], v[224:225], v[26:27], v[120:123]
    buffer_load_dwordx4 v1, s[8:11], s57 offen offset:2048 sc1 lds
    v_mfma_f32_16x16x16_bf16 v[116:119], v[226:227], v[24:25], v[116:119]
    v_mfma_f32_16x16x16_bf16 v[124:127], v[226:227], v[26:27], v[124:127]
    ds_read_b128 v[248:251], v3 offset:30720
    v_mfma_f32_16x16x32_bf16 v[128:131], v[228:231], v[32:35], v[128:131]
    v_mfma_f32_16x16x32_bf16 v[136:139], v[228:231], v[36:39], v[136:139]
    s_waitcnt lgkmcnt(3)
    ds_read_b128 v[252:255], v3 offset:31744
    v_max_f32 v112, 0, v112
    v_mfma_f32_16x16x32_bf16 v[132:135], v[232:235], v[32:35], v[132:135]
    s_waitcnt vmcnt(21)
    s_barrier
    v_mfma_f32_16x16x32_bf16 v[140:143], v[232:235], v[36:39], v[140:143]
    ds_read_b128 v[224:227], v1 offset:0
    v_max_f32 v113, 0, v113
    v_mfma_f32_16x16x32_bf16 v[128:131], v[236:239], v[40:43], v[128:131]
    buffer_load_dwordx4 a[172:175], v1, s[8:11], s58 offen offset:3072 sc1
    v_mfma_f32_16x16x32_bf16 v[136:139], v[236:239], v[44:47], v[136:139]
    s_waitcnt lgkmcnt(3)
    ds_read_b128 v[228:231], v1 offset:1024
    v_max_f32 v114, 0, v114
    v_mfma_f32_16x16x32_bf16 v[132:135], v[240:243], v[40:43], v[132:135]
    buffer_load_dwordx4 v1, s[8:11], s57 offen offset:3072 sc1 lds
    v_mfma_f32_16x16x32_bf16 v[140:143], v[240:243], v[44:47], v[140:143]
    ds_read_b128 v[232:235], v1 offset:2048
    v_max_f32 v115, 0, v115
    v_mfma_f32_16x16x32_bf16 v[128:131], v[244:247], v[48:51], v[128:131]
    v_mul_f32 v112, v112, v116
    v_mul_f32 v113, v113, v117
    v_mfma_f32_16x16x32_bf16 v[136:139], v[244:247], v[52:55], v[136:139]
    s_waitcnt lgkmcnt(3)
    ds_read_b128 v[236:239], v1 offset:3072
    v_mul_f32 v114, v114, v118
    v_mfma_f32_16x16x32_bf16 v[132:135], v[248:251], v[48:51], v[132:135]
    v_mul_f32 v115, v115, v119
    v_cvt_pk_bf16_f32 v116, v112, v113
    v_mfma_f32_16x16x32_bf16 v[140:143], v[248:251], v[52:55], v[140:143]
    s_add_u32 s58, s38, 45056
    ds_read_b128 v[240:243], v1 offset:4096
    v_cvt_pk_bf16_f32 v117, v114, v115
    v_mfma_f32_16x16x32_bf16 v[128:131], v[252:255], v[56:59], v[128:131]
    buffer_load_dwordx4 a[176:179], v1, s[8:11], s58 offen offset:0 sc1
    v_mfma_f32_16x16x32_bf16 v[136:139], v[252:255], v[60:63], v[136:139]
    s_waitcnt lgkmcnt(3)
    ds_read2st64_b32 v[244:245], v21 offset0:20 offset1:21
    ds_read2st64_b32 v[246:247], v21 offset0:22 offset1:23
    v_mfma_f32_16x16x32_bf16 v[132:135], v[224:227], v[56:59], v[132:135]
    v_max_f32 v120, 0, v120
    v_max_f32 v121, 0, v121
    v_mfma_f32_16x16x32_bf16 v[140:143], v[224:227], v[60:63], v[140:143]
    ds_read_b128 v[248:251], v1 offset:6144
    v_max_f32 v122, 0, v122
    v_mfma_f32_16x16x32_bf16 v[128:131], v[228:231], v[64:67], v[128:131]
    buffer_load_dwordx4 a[180:183], v1, s[8:11], s58 offen offset:1024 sc1
    v_mfma_f32_16x16x32_bf16 v[136:139], v[228:231], v[68:71], v[136:139]
    s_waitcnt lgkmcnt(4)
    ds_read_b128 v[252:255], v1 offset:7168
    v_max_f32 v123, 0, v123
    v_mfma_f32_16x16x32_bf16 v[132:135], v[232:235], v[64:67], v[132:135]
    v_mul_f32 v120, v120, v124
    v_mul_f32 v121, v121, v125
    v_mfma_f32_16x16x32_bf16 v[140:143], v[232:235], v[68:71], v[140:143]
    ds_read_b128 v[224:227], v1 offset:8192
    v_mul_f32 v122, v122, v126
    v_mfma_f32_16x16x32_bf16 v[128:131], v[236:239], v[72:75], v[128:131]
    buffer_load_dwordx4 a[184:187], v1, s[8:11], s58 offen offset:2048 sc1
    v_mfma_f32_16x16x32_bf16 v[136:139], v[236:239], v[76:79], v[136:139]
    s_waitcnt lgkmcnt(3)
    ds_read_b128 v[228:231], v1 offset:9216
    v_mul_f32 v123, v123, v127
    v_mfma_f32_16x16x32_bf16 v[132:135], v[240:243], v[72:75], v[132:135]
    buffer_load_dwordx4 a[188:191], v1, s[8:11], s58 offen offset:3072 sc1
    v_mfma_f32_16x16x32_bf16 v[140:143], v[240:243], v[76:79], v[140:143]
    ds_read_b128 v[232:235], v1 offset:10240
    v_cvt_pk_bf16_f32 v118, v120, v121
    v_mfma_f32_16x16x16_bf16 v[128:131], v[244:245], v[24:25], v[128:131]
    v_cvt_pk_bf16_f32 v119, v122, v123
    s_add_u32 s59, s33, 262144
    v_mfma_f32_16x16x16_bf16 v[136:139], v[244:245], v[26:27], v[136:139]
    s_add_u32 s58, s38, 4096
    v_permlane16_swap_b32 v116, v118
    v_mfma_f32_16x16x16_bf16 v[132:135], v[246:247], v[24:25], v[132:135]
    buffer_load_dwordx4 a[16:19], v1, s[8:11], s58 offen offset:0 sc1
    v_mfma_f32_16x16x16_bf16 v[140:143], v[246:247], v[26:27], v[140:143]
    s_waitcnt lgkmcnt(3)
    ds_read_b128 v[236:239], v1 offset:11264
    v_mfma_f32_16x16x32_bf16 v[144:147], v[248:251], v[32:35], v[144:147]
    v_permlane16_swap_b32 v117, v119
    v_mfma_f32_16x16x32_bf16 v[152:155], v[248:251], v[36:39], v[152:155]
    ds_read_b128 v[240:243], v1 offset:12288
    v_mfma_f32_16x16x32_bf16 v[148:151], v[252:255], v[32:35], v[148:151]
    buffer_load_dwordx4 a[20:23], v1, s[8:11], s58 offen offset:1024 sc1
    v_mfma_f32_16x16x32_bf16 v[156:159], v[252:255], v[36:39], v[156:159]
    s_waitcnt lgkmcnt(3)
    ds_read_b128 v[244:247], v1 offset:13312
    buffer_store_dwordx4 v[116:119], v1, s[8:11], s59 offen sc1
    v_mfma_f32_16x16x32_bf16 v[144:147], v[224:227], v[40:43], v[144:147]
    s_add_u32 s57, s36, 229376
    s_add_u32 m0, s96, 131072
    v_max_f32 v128, 0, v128
    v_mfma_f32_16x16x32_bf16 v[152:155], v[224:227], v[44:47], v[152:155]
    ds_read_b128 v[248:251], v1 offset:14336
    v_max_f32 v129, 0, v129
    v_mfma_f32_16x16x32_bf16 v[148:151], v[228:231], v[40:43], v[148:151]
    buffer_load_dwordx4 v1, s[8:11], s57 offen offset:0 sc1 lds
    v_mfma_f32_16x16x32_bf16 v[156:159], v[228:231], v[44:47], v[156:159]
    s_waitcnt lgkmcnt(3)
    ds_read_b128 v[252:255], v1 offset:15360
    v_max_f32 v130, 0, v130
    v_mfma_f32_16x16x32_bf16 v[144:147], v[232:235], v[48:51], v[144:147]
    s_waitcnt vmcnt(24)
    s_barrier
    v_mfma_f32_16x16x32_bf16 v[152:155], v[232:235], v[52:55], v[152:155]
    ds_read_b128 v[224:227], v1 offset:16384
    v_max_f32 v131, 0, v131
    v_mfma_f32_16x16x32_bf16 v[148:151], v[236:239], v[48:51], v[148:151]
    buffer_load_dwordx4 a[24:27], v1, s[8:11], s58 offen offset:2048 sc1
    v_mfma_f32_16x16x32_bf16 v[156:159], v[236:239], v[52:55], v[156:159]
    s_waitcnt lgkmcnt(3)
    ds_read_b128 v[228:231], v1 offset:17408
    v_mul_f32 v128, v128, v132
    v_mfma_f32_16x16x32_bf16 v[144:147], v[240:243], v[56:59], v[144:147]
    buffer_load_dwordx4 v1, s[8:11], s57 offen offset:1024 sc1 lds
    v_mfma_f32_16x16x32_bf16 v[152:155], v[240:243], v[60:63], v[152:155]
    ds_read2st64_b32 v[232:233], v21 offset0:72 offset1:73
    ds_read2st64_b32 v[234:235], v21 offset0:74 offset1:75
    v_mfma_f32_16x16x32_bf16 v[148:151], v[244:247], v[56:59], v[148:151]
    v_mul_f32 v129, v129, v133
    v_mul_f32 v130, v130, v134
    v_mfma_f32_16x16x32_bf16 v[156:159], v[244:247], v[60:63], v[156:159]
    s_waitcnt lgkmcnt(4)
    ds_read_b128 v[236:239], v1 offset:19456
    v_mul_f32 v131, v131, v135
    v_mfma_f32_16x16x32_bf16 v[144:147], v[248:251], v[64:67], v[144:147]
    v_cvt_pk_bf16_f32 v132, v128, v129
    v_cvt_pk_bf16_f32 v133, v130, v131
    v_mfma_f32_16x16x32_bf16 v[152:155], v[248:251], v[68:71], v[152:155]
    ds_read_b128 v[240:243], v1 offset:20480
    v_max_f32 v136, 0, v136
    v_mfma_f32_16x16x32_bf16 v[148:151], v[252:255], v[64:67], v[148:151]
    buffer_load_dwordx4 a[28:31], v1, s[8:11], s58 offen offset:3072 sc1
    v_mfma_f32_16x16x32_bf16 v[156:159], v[252:255], v[68:71], v[156:159]
    s_waitcnt lgkmcnt(4)
    ds_read_b128 v[244:247], v1 offset:21504
    v_max_f32 v137, 0, v137
    v_mfma_f32_16x16x32_bf16 v[144:147], v[224:227], v[72:75], v[144:147]
    s_add_u32 s58, s38, 20480
    buffer_load_dwordx4 a[80:83], v1, s[8:11], s58 offen offset:0 sc1
    v_mfma_f32_16x16x32_bf16 v[152:155], v[224:227], v[76:79], v[152:155]
    ds_read_b128 v[248:251], v1 offset:22528
    v_max_f32 v138, 0, v138
    v_max_f32 v139, 0, v139
    v_mfma_f32_16x16x32_bf16 v[148:151], v[228:231], v[72:75], v[148:151]
    v_mul_f32 v136, v136, v140
    v_mul_f32 v137, v137, v141
    v_mfma_f32_16x16x32_bf16 v[156:159], v[228:231], v[76:79], v[156:159]
    s_waitcnt lgkmcnt(3)
    ds_read_b128 v[252:255], v1 offset:23552
    v_mul_f32 v138, v138, v142
    v_mfma_f32_16x16x16_bf16 v[144:147], v[232:233], v[24:25], v[144:147]
    buffer_load_dwordx4 a[84:87], v1, s[8:11], s58 offen offset:1024 sc1
    v_mfma_f32_16x16x16_bf16 v[152:155], v[232:233], v[26:27], v[152:155]
    v_mul_f32 v139, v139, v143
    v_cvt_pk_bf16_f32 v134, v136, v137
    v_mfma_f32_16x16x16_bf16 v[148:151], v[234:235], v[24:25], v[148:151]
    v_cvt_pk_bf16_f32 v135, v138, v139
    s_add_u32 s59, s59, s65
    v_mfma_f32_16x16x16_bf16 v[156:159], v[234:235], v[26:27], v[156:159]
    ds_read_b128 v[224:227], v1 offset:24576
    v_mfma_f32_16x16x32_bf16 v[160:163], v[236:239], v[32:35], v[160:163]
    buffer_load_dwordx4 a[88:91], v1, s[8:11], s58 offen offset:2048 sc1
    v_mfma_f32_16x16x32_bf16 v[168:171], v[236:239], v[36:39], v[168:171]
    s_waitcnt lgkmcnt(3)
    ds_read_b128 v[228:231], v1 offset:25600
    v_permlane16_swap_b32 v132, v134
    v_mfma_f32_16x16x32_bf16 v[164:167], v[240:243], v[32:35], v[164:167]
    v_permlane16_swap_b32 v133, v135
    v_mfma_f32_16x16x32_bf16 v[172:175], v[240:243], v[36:39], v[172:175]
    ds_read_b128 v[232:235], v1 offset:26624
    buffer_store_dwordx4 v[132:135], v1, s[8:11], s59 offen sc1
    v_mfma_f32_16x16x32_bf16 v[160:163], v[244:247], v[40:43], v[160:163]
    buffer_load_dwordx4 a[92:95], v1, s[8:11], s58 offen offset:3072 sc1
    v_mfma_f32_16x16x32_bf16 v[168:171], v[244:247], v[44:47], v[168:171]
    s_waitcnt lgkmcnt(3)
    ds_read_b128 v[236:239], v1 offset:27648
    v_max_f32 v144, 0, v144
    v_mfma_f32_16x16x32_bf16 v[164:167], v[248:251], v[40:43], v[164:167]
    s_add_u32 s58, s38, 32768
    v_max_f32 v145, 0, v145
    v_max_f32 v146, 0, v146
    v_mfma_f32_16x16x32_bf16 v[172:175], v[248:251], v[44:47], v[172:175]
    ds_read_b128 v[240:243], v1 offset:28672
    v_max_f32 v147, 0, v147
    v_mfma_f32_16x16x32_bf16 v[160:163], v[252:255], v[48:51], v[160:163]
    buffer_load_dwordx4 a[128:131], v1, s[8:11], s58 offen offset:0 sc1
    v_mfma_f32_16x16x32_bf16 v[168:171], v[252:255], v[52:55], v[168:171]
    s_waitcnt lgkmcnt(3)
    ds_read_b128 v[244:247], v1 offset:29696
    v_mul_f32 v144, v144, v148
    v_mfma_f32_16x16x32_bf16 v[164:167], v[224:227], v[48:51], v[164:167]
    buffer_load_dwordx4 a[132:135], v1, s[8:11], s58 offen offset:1024 sc1
    v_mfma_f32_16x16x32_bf16 v[172:175], v[224:227], v[52:55], v[172:175]
    ds_read_b128 v[248:251], v1 offset:30720
    v_mul_f32 v145, v145, v149
    v_mfma_f32_16x16x32_bf16 v[160:163], v[228:231], v[56:59], v[160:163]
    v_mul_f32 v146, v146, v150
    v_mul_f32 v147, v147, v151
    v_mfma_f32_16x16x32_bf16 v[168:171], v[228:231], v[60:63], v[168:171]
    s_waitcnt lgkmcnt(3)
    ds_read2st64_b32 v[252:253], v21 offset0:124 offset1:125
    ds_read2st64_b32 v[254:255], v21 offset0:126 offset1:127
    v_mfma_f32_16x16x32_bf16 v[164:167], v[232:235], v[56:59], v[164:167]
    s_waitcnt vmcnt(27)
    s_barrier
    v_mfma_f32_16x16x32_bf16 v[172:175], v[232:235], v[60:63], v[172:175]
    ds_read_b128 v[224:227], v2 offset:32768
    v_cvt_pk_bf16_f32 v148, v144, v145
    v_mfma_f32_16x16x32_bf16 v[160:163], v[236:239], v[64:67], v[160:163]
    buffer_load_dwordx4 a[136:139], v1, s[8:11], s58 offen offset:2048 sc1
    v_mfma_f32_16x16x32_bf16 v[168:171], v[236:239], v[68:71], v[168:171]
    s_waitcnt lgkmcnt(4)
    ds_read_b128 v[228:231], v2 offset:33792
    v_cvt_pk_bf16_f32 v149, v146, v147
    v_mfma_f32_16x16x32_bf16 v[164:167], v[240:243], v[64:67], v[164:167]
    buffer_load_dwordx4 a[140:143], v1, s[8:11], s58 offen offset:3072 sc1
    v_mfma_f32_16x16x32_bf16 v[172:175], v[240:243], v[68:71], v[172:175]
    ds_read_b128 v[232:235], v2 offset:34816
    v_max_f32 v152, 0, v152
    v_mfma_f32_16x16x32_bf16 v[160:163], v[244:247], v[72:75], v[160:163]
    s_add_u32 s58, s38, 49152
    v_max_f32 v153, 0, v153
    v_max_f32 v154, 0, v154
    v_mfma_f32_16x16x32_bf16 v[168:171], v[244:247], v[76:79], v[168:171]
    s_waitcnt lgkmcnt(3)
    ds_read_b128 v[236:239], v2 offset:35840
    v_max_f32 v155, 0, v155
    v_mfma_f32_16x16x32_bf16 v[164:167], v[248:251], v[72:75], v[164:167]
    buffer_load_dwordx4 a[192:195], v1, s[8:11], s58 offen offset:0 sc1
    v_mul_f32 v152, v152, v156
    v_mfma_f32_16x16x32_bf16 v[172:175], v[248:251], v[76:79], v[172:175]
    ds_read_b128 v[240:243], v2 offset:36864
    v_mul_f32 v153, v153, v157
    v_mfma_f32_16x16x16_bf16 v[160:163], v[252:253], v[24:25], v[160:163]
    v_mul_f32 v154, v154, v158
    v_mul_f32 v155, v155, v159
    v_mfma_f32_16x16x16_bf16 v[168:171], v[252:253], v[26:27], v[168:171]
    buffer_load_dwordx4 a[196:199], v1, s[8:11], s58 offen offset:1024 sc1
    v_mfma_f32_16x16x16_bf16 v[164:167], v[254:255], v[24:25], v[164:167]
    v_cvt_pk_bf16_f32 v150, v152, v153
    v_cvt_pk_bf16_f32 v151, v154, v155
    v_mfma_f32_16x16x16_bf16 v[172:175], v[254:255], v[26:27], v[172:175]
    s_waitcnt lgkmcnt(3)
    ds_read_b128 v[244:247], v2 offset:37888
    s_add_u32 s59, s59, s65
    v_mfma_f32_16x16x32_bf16 v[176:179], v[224:227], v[32:35], v[176:179]
    buffer_load_dwordx4 a[200:203], v1, s[8:11], s58 offen offset:2048 sc1
    v_mfma_f32_16x16x32_bf16 v[184:187], v[224:227], v[36:39], v[184:187]
    ds_read_b128 v[248:251], v2 offset:38912
    v_permlane16_swap_b32 v148, v150
    v_mfma_f32_16x16x32_bf16 v[180:183], v[228:231], v[32:35], v[180:183]
    v_permlane16_swap_b32 v149, v151
    v_mfma_f32_16x16x32_bf16 v[188:191], v[228:231], v[36:39], v[188:191]
    s_waitcnt lgkmcnt(3)
    ds_read_b128 v[252:255], v2 offset:39936
    buffer_store_dwordx4 v[148:151], v1, s[8:11], s59 offen sc1
    v_mfma_f32_16x16x32_bf16 v[176:179], v[232:235], v[40:43], v[176:179]
    buffer_load_dwordx4 a[204:207], v1, s[8:11], s58 offen offset:3072 sc1
    v_mfma_f32_16x16x32_bf16 v[184:187], v[232:235], v[44:47], v[184:187]
    ds_read_b128 v[224:227], v2 offset:40960
    v_max_f32 v160, 0, v160
    v_mfma_f32_16x16x32_bf16 v[180:183], v[236:239], v[40:43], v[180:183]
    s_add_u32 s58, s38, 0
    v_max_f32 v161, 0, v161
    v_max_f32 v162, 0, v162
    v_mfma_f32_16x16x32_bf16 v[188:191], v[236:239], v[44:47], v[188:191]
    s_waitcnt lgkmcnt(3)
    ds_read_b128 v[228:231], v2 offset:41984
    v_max_f32 v163, 0, v163
    v_mfma_f32_16x16x32_bf16 v[176:179], v[240:243], v[48:51], v[176:179]
    buffer_load_dwordx4 a[0:3], v1, s[8:11], s58 offen offset:0 sc1
    v_mfma_f32_16x16x32_bf16 v[184:187], v[240:243], v[52:55], v[184:187]
    ds_read_b128 v[232:235], v2 offset:43008
    v_mul_f32 v160, v160, v164
    v_mfma_f32_16x16x32_bf16 v[180:183], v[244:247], v[48:51], v[180:183]
    v_mul_f32 v161, v161, v165
    v_mul_f32 v162, v162, v166
    v_mfma_f32_16x16x32_bf16 v[188:191], v[244:247], v[52:55], v[188:191]
    s_waitcnt lgkmcnt(3)
    ds_read_b128 v[236:239], v2 offset:44032
    v_mul_f32 v163, v163, v167
    v_mfma_f32_16x16x32_bf16 v[176:179], v[248:251], v[56:59], v[176:179]
    buffer_load_dwordx4 a[4:7], v1, s[8:11], s58 offen offset:1024 sc1
    v_mfma_f32_16x16x32_bf16 v[184:187], v[248:251], v[60:63], v[184:187]
    ds_read2st64_b32 v[240:241], v22 offset0:176 offset1:177
    ds_read2st64_b32 v[242:243], v22 offset0:178 offset1:179
    v_mfma_f32_16x16x32_bf16 v[180:183], v[252:255], v[56:59], v[180:183]
    v_cvt_pk_bf16_f32 v164, v160, v161
    v_cvt_pk_bf16_f32 v165, v162, v163
    v_mfma_f32_16x16x32_bf16 v[188:191], v[252:255], v[60:63], v[188:191]
    s_waitcnt lgkmcnt(4)
    ds_read_b128 v[244:247], v2 offset:46080
    v_max_f32 v168, 0, v168
    v_mfma_f32_16x16x32_bf16 v[176:179], v[224:227], v[64:67], v[176:179]
    buffer_load_dwordx4 a[8:11], v1, s[8:11], s58 offen offset:2048 sc1
    v_mfma_f32_16x16x32_bf16 v[184:187], v[224:227], v[68:71], v[184:187]
    ds_read_b128 v[248:251], v2 offset:47104
    v_max_f32 v169, 0, v169
    v_mfma_f32_16x16x32_bf16 v[180:183], v[228:231], v[64:67], v[180:183]
    buffer_load_dwordx4 a[12:15], v1, s[8:11], s58 offen offset:3072 sc1
    v_mfma_f32_16x16x32_bf16 v[188:191], v[228:231], v[68:71], v[188:191]
    s_waitcnt lgkmcnt(4)
    ds_read_b128 v[252:255], v2 offset:48128
    v_max_f32 v170, 0, v170
    v_mfma_f32_16x16x32_bf16 v[176:179], v[232:235], v[72:75], v[176:179]
    s_waitcnt vmcnt(29)
    s_barrier
    v_mfma_f32_16x16x32_bf16 v[184:187], v[232:235], v[76:79], v[184:187]
    s_add_u32 s58, s38, 24576
    ds_read_b128 v[224:227], v2 offset:49152
    v_max_f32 v171, 0, v171
    v_mfma_f32_16x16x32_bf16 v[180:183], v[236:239], v[72:75], v[180:183]
    buffer_load_dwordx4 a[96:99], v1, s[8:11], s58 offen offset:0 sc1
    v_mul_f32 v168, v168, v172
    v_mfma_f32_16x16x32_bf16 v[188:191], v[236:239], v[76:79], v[188:191]
    s_waitcnt lgkmcnt(3)
    ds_read_b128 v[228:231], v2 offset:50176
    v_mul_f32 v169, v169, v173
    v_mfma_f32_16x16x16_bf16 v[176:179], v[240:241], v[24:25], v[176:179]
    v_mul_f32 v170, v170, v174
    v_mul_f32 v171, v171, v175
    v_mfma_f32_16x16x16_bf16 v[184:187], v[240:241], v[26:27], v[184:187]
    buffer_load_dwordx4 a[100:103], v1, s[8:11], s58 offen offset:1024 sc1
    v_mfma_f32_16x16x16_bf16 v[180:183], v[242:243], v[24:25], v[180:183]
    s_add_u32 s12, s26, 3
    v_mov_b32 v20, s12
    s_waitcnt vmcnt(7)
    v_cvt_pk_bf16_f32 v166, v168, v169
    v_mfma_f32_16x16x16_bf16 v[188:191], v[242:243], v[26:27], v[188:191]
    ds_read_b128 v[232:235], v2 offset:51200
    v_cvt_pk_bf16_f32 v167, v170, v171
    v_mfma_f32_16x16x32_bf16 v[192:195], v[244:247], v[32:35], v[192:195]
    s_add_u32 s59, s59, s65
    s_cmp_lg_u32 s27, 0
    s_cbranch_scc1 L_slow_31
    buffer_store_dword v20, v5, s[8:11], s45 offen
L_sig_32:
    v_mfma_f32_16x16x32_bf16 v[200:203], v[244:247], v[36:39], v[200:203]
    s_waitcnt lgkmcnt(3)
    ds_read_b128 v[236:239], v2 offset:52224
    v_permlane16_swap_b32 v164, v166
    v_mfma_f32_16x16x32_bf16 v[196:199], v[248:251], v[32:35], v[196:199]
    buffer_load_dwordx4 a[104:107], v1, s[8:11], s58 offen offset:2048 sc1
    v_permlane16_swap_b32 v165, v167
    v_mfma_f32_16x16x32_bf16 v[204:207], v[248:251], v[36:39], v[204:207]
    ds_read_b128 v[240:243], v2 offset:53248
    buffer_store_dwordx4 v[164:167], v1, s[8:11], s59 offen sc1
    v_mfma_f32_16x16x32_bf16 v[192:195], v[252:255], v[40:43], v[192:195]
    v_max_f32 v176, 0, v176
    v_max_f32 v177, 0, v177
    v_mfma_f32_16x16x32_bf16 v[200:203], v[252:255], v[44:47], v[200:203]
    s_waitcnt lgkmcnt(3)
    ds_read_b128 v[244:247], v2 offset:54272
    v_max_f32 v178, 0, v178
    v_mfma_f32_16x16x32_bf16 v[196:199], v[224:227], v[40:43], v[196:199]
    buffer_load_dwordx4 a[108:111], v1, s[8:11], s58 offen offset:3072 sc1
    v_mfma_f32_16x16x32_bf16 v[204:207], v[224:227], v[44:47], v[204:207]
    s_add_u32 s58, s38, 28672
    ds_read_b128 v[248:251], v2 offset:55296
    v_max_f32 v179, 0, v179
    v_mfma_f32_16x16x32_bf16 v[192:195], v[228:231], v[48:51], v[192:195]
    buffer_load_dwordx4 a[112:115], v1, s[8:11], s58 offen offset:0 sc1
    v_mfma_f32_16x16x32_bf16 v[200:203], v[228:231], v[52:55], v[200:203]
    s_waitcnt lgkmcnt(3)
    ds_read_b128 v[252:255], v2 offset:56320
    v_mul_f32 v176, v176, v180
    v_mfma_f32_16x16x32_bf16 v[196:199], v[232:235], v[48:51], v[196:199]
    v_mul_f32 v177, v177, v181
    v_mul_f32 v178, v178, v182
    v_mfma_f32_16x16x32_bf16 v[204:207], v[232:235], v[52:55], v[204:207]
    ds_read_b128 v[224:227], v2 offset:57344
    v_mul_f32 v179, v179, v183
    v_mfma_f32_16x16x32_bf16 v[192:195], v[236:239], v[56:59], v[192:195]
    buffer_load_dwordx4 a[116:119], v1, s[8:11], s58 offen offset:1024 sc1
    v_mfma_f32_16x16x32_bf16 v[200:203], v[236:239], v[60:63], v[200:203]
    s_waitcnt lgkmcnt(3)
    ds_read2st64_b32 v[228:229], v22 offset0:228 offset1:229
    ds_read2st64_b32 v[230:231], v22 offset0:230 offset1:231
    v_mfma_f32_16x16x32_bf16 v[196:199], v[240:243], v[56:59], v[196:199]
    v_cvt_pk_bf16_f32 v180, v176, v177
    v_cvt_pk_bf16_f32 v181, v178, v179
    v_mfma_f32_16x16x32_bf16 v[204:207], v[240:243], v[60:63], v[204:207]
    ds_read_b128 v[232:235], v2 offset:59392
    v_max_f32 v184, 0, v184
    v_mfma_f32_16x16x32_bf16 v[192:195], v[244:247], v[64:67], v[192:195]
    buffer_load_dwordx4 a[120:123], v1, s[8:11], s58 offen offset:2048 sc1
    v_mfma_f32_16x16x32_bf16 v[200:203], v[244:247], v[68:71], v[200:203]
    s_waitcnt lgkmcnt(4)
    ds_read_b128 v[236:239], v2 offset:60416
    v_max_f32 v185, 0, v185
    v_mfma_f32_16x16x32_bf16 v[196:199], v[248:251], v[64:67], v[196:199]
    v_max_f32 v186, 0, v186
    v_max_f32 v187, 0, v187
    v_mfma_f32_16x16x32_bf16 v[204:207], v[248:251], v[68:71], v[204:207]
    ds_read_b128 v[240:243], v2 offset:61440
    v_mul_f32 v184, v184, v188
    v_mfma_f32_16x16x32_bf16 v[192:195], v[252:255], v[72:75], v[192:195]
    buffer_load_dwordx4 a[124:127], v1, s[8:11], s58 offen offset:3072 sc1
    v_mfma_f32_16x16x32_bf16 v[200:203], v[252:255], v[76:79], v[200:203]
    s_waitcnt lgkmcnt(3)
    ds_read_b128 v[244:247], v2 offset:62464
    v_mul_f32 v185, v185, v189
    v_mfma_f32_16x16x32_bf16 v[196:199], v[224:227], v[72:75], v[196:199]
    s_add_u32 s58, s38, 53248
    v_mul_f32 v186, v186, v190
    v_mul_f32 v187, v187, v191
    v_mfma_f32_16x16x32_bf16 v[204:207], v[224:227], v[76:79], v[204:207]
    ds_read_b128 v[248:251], v2 offset:63488
    v_cvt_pk_bf16_f32 v182, v184, v185
    v_mfma_f32_16x16x16_bf16 v[192:195], v[228:229], v[24:25], v[192:195]
    buffer_load_dword v19, v6, s[8:11], s44 offen nt
    v_mfma_f32_16x16x16_bf16 v[200:203], v[228:229], v[26:27], v[200:203]
    buffer_load_dwordx4 a[208:211], v1, s[8:11], s58 offen offset:0 sc1
    v_mfma_f32_16x16x16_bf16 v[196:199], v[230:231], v[24:25], v[196:199]
    v_cvt_pk_bf16_f32 v183, v186, v187
    s_add_u32 s59, s59, s65
    v_mfma_f32_16x16x16_bf16 v[204:207], v[230:231], v[26:27], v[204:207]
    s_waitcnt lgkmcnt(3)
    ds_read_b128 v[252:255], v2 offset:64512
    v_mfma_f32_16x16x32_bf16 v[208:211], v[232:235], v[32:35], v[208:211]
    s_barrier
    v_mfma_f32_16x16x32_bf16 v[216:219], v[232:235], v[36:39], v[216:219]
    ds_read_b128 v[224:227], v3 offset:0
    ds_write_b32 v16, v17
    v_permlane16_swap_b32 v180, v182
    v_mfma_f32_16x16x32_bf16 v[212:215], v[236:239], v[32:35], v[212:215]
    buffer_load_dwordx4 a[212:215], v1, s[8:11], s58 offen offset:1024 sc1
    v_permlane16_swap_b32 v181, v183
    v_mfma_f32_16x16x32_bf16 v[220:223], v[236:239], v[36:39], v[220:223]
    s_waitcnt lgkmcnt(4)
    ds_read_b128 v[228:231], v3 offset:1024
    buffer_store_dwordx4 v[180:183], v1, s[8:11], s59 offen sc1
    v_mfma_f32_16x16x32_bf16 v[208:211], v[240:243], v[40:43], v[208:211]
    buffer_load_dwordx4 a[216:219], v1, s[8:11], s58 offen offset:2048 sc1
    v_mfma_f32_16x16x32_bf16 v[216:219], v[240:243], v[44:47], v[216:219]
    ds_read_b128 v[232:235], v3 offset:2048
    v_max_f32 v192, 0, v192
    v_mfma_f32_16x16x32_bf16 v[212:215], v[244:247], v[40:43], v[212:215]
    buffer_load_dwordx4 a[220:223], v1, s[8:11], s58 offen offset:3072 sc1
    v_mfma_f32_16x16x32_bf16 v[220:223], v[244:247], v[44:47], v[220:223]
    s_waitcnt lgkmcnt(4)
    ds_read_b128 v[236:239], v3 offset:3072
    s_add_u32 s3, s26, 3
    v_mfma_f32_16x16x32_bf16 v[208:211], v[248:251], v[48:51], v[208:211]
    s_waitcnt vmcnt(5)
    v_subrev_u32 v19, s3, v19
    v_cmp_lt_u32 vcc, 15, v19
    v_mfma_f32_16x16x32_bf16 v[216:219], v[248:251], v[52:55], v[216:219]
    ds_read_b128 v[240:243], v3 offset:4096
    v_max_f32 v193, 0, v193
    v_mfma_f32_16x16x32_bf16 v[212:215], v[252:255], v[48:51], v[212:215]
    s_and_b64 vcc, vcc, s[42:43]
    s_or_b64 vcc, vcc, s[0:1]
    s_cbranch_scc1 L_cspin_29
L_cback_30:
    v_mfma_f32_16x16x32_bf16 v[220:223], v[252:255], v[52:55], v[220:223]
    s_waitcnt lgkmcnt(3)
    ds_read_b128 v[244:247], v3 offset:5120
    s_add_u32 s56, s68, 266240
    v_max_f32 v194, 0, v194
    v_mfma_f32_16x16x32_bf16 v[208:211], v[224:227], v[56:59], v[208:211]
    buffer_load_dwordx4 v[80:83], v4, s[8:11], s56 offen offset:0 sc1
    v_max_f32 v195, 0, v195
    v_mfma_f32_16x16x32_bf16 v[216:219], v[224:227], v[60:63], v[216:219]
    ds_read2st64_b32 v[248:249], v23 offset0:24 offset1:25
    ds_read2st64_b32 v[250:251], v23 offset0:26 offset1:27
    v_mul_f32 v192, v192, v196
    v_mfma_f32_16x16x32_bf16 v[212:215], v[228:231], v[56:59], v[212:215]
    buffer_load_dwordx4 v[84:87], v4, s[8:11], s56 offen offset:2048 sc1
    v_mul_f32 v193, v193, v197
    v_mfma_f32_16x16x32_bf16 v[220:223], v[228:231], v[60:63], v[220:223]
    s_waitcnt lgkmcnt(4)
    s_add_u32 s56, s68, 270336
    v_mul_f32 v194, v194, v198
    v_mfma_f32_16x16x32_bf16 v[208:211], v[232:235], v[64:67], v[208:211]
    buffer_load_dwordx4 v[88:91], v4, s[8:11], s56 offen offset:0 sc1
    v_mul_f32 v195, v195, v199
    v_mfma_f32_16x16x32_bf16 v[216:219], v[232:235], v[68:71], v[216:219]
    v_cvt_pk_bf16_f32 v196, v192, v193
    v_cvt_pk_bf16_f32 v197, v194, v195
    v_mfma_f32_16x16x32_bf16 v[212:215], v[236:239], v[64:67], v[212:215]
    v_max_f32 v200, 0, v200
    v_max_f32 v201, 0, v201
    v_mfma_f32_16x16x32_bf16 v[220:223], v[236:239], v[68:71], v[220:223]
    s_waitcnt lgkmcnt(2)
    s_or_b32 s60, s2, s20
    v_max_f32 v202, 0, v202
    v_mfma_f32_16x16x32_bf16 v[208:211], v[240:243], v[72:75], v[208:211]
    s_add_u32 s56, s68, 280576
    s_cmp_eq_u32 s60, 0
    s_cselect_b32 s60, 0, 0x40000000
    v_mfma_f32_16x16x32_bf16 v[216:219], v[240:243], v[76:79], v[216:219]
    v_mov_b32 v18, s26
    v_max_f32 v203, 0, v203
    v_mfma_f32_16x16x32_bf16 v[212:215], v[244:247], v[72:75], v[212:215]
    buffer_load_dwordx4 v[92:95], v4, s[8:11], s56 offen offset:0 sc1
    v_mul_f32 v200, v200, v204
    v_mfma_f32_16x16x32_bf16 v[220:223], v[244:247], v[76:79], v[220:223]
    s_waitcnt lgkmcnt(0)
    buffer_store_dword v18, v5, s[8:11], s60 offen
    v_mul_f32 v201, v201, v205
    v_mfma_f32_16x16x16_bf16 v[208:211], v[248:249], v[24:25], v[208:211]
    v_mul_f32 v202, v202, v206
    v_mul_f32 v203, v203, v207
    v_mfma_f32_16x16x16_bf16 v[216:219], v[248:249], v[26:27], v[216:219]
    v_cvt_pk_bf16_f32 v198, v200, v201
    v_cvt_pk_bf16_f32 v199, v202, v203
    v_mfma_f32_16x16x16_bf16 v[212:215], v[250:251], v[24:25], v[212:215]
    s_add_u32 s12, s26, 4
    v_mov_b32 v20, s12
    s_waitcnt vmcnt(7)
    v_mfma_f32_16x16x16_bf16 v[220:223], v[250:251], v[26:27], v[220:223]
    s_add_u32 s59, s59, s65
    v_permlane16_swap_b32 v196, v198
    s_cmp_lg_u32 s27, 0
    s_cbranch_scc1 L_slow_33
    buffer_store_dword v20, v5, s[8:11], s45 offen
L_sig_34:
    v_permlane16_swap_b32 v197, v199
    buffer_store_dwordx4 v[196:199], v1, s[8:11], s59 offen sc1
    v_max_f32 v208, 0, v208
    v_max_f32 v209, 0, v209
    v_max_f32 v210, 0, v210
    v_max_f32 v211, 0, v211
    v_pk_mul_f32 v[208:209], v[208:209], v[212:213]
    v_pk_mul_f32 v[210:211], v[210:211], v[214:215]
    v_cvt_pk_bf16_f32 v212, v208, v209
    v_cvt_pk_bf16_f32 v213, v210, v211
    v_max_f32 v216, 0, v216
    v_max_f32 v217, 0, v217
    v_max_f32 v218, 0, v218
    v_max_f32 v219, 0, v219
    v_pk_mul_f32 v[216:217], v[216:217], v[220:221]
    v_pk_mul_f32 v[218:219], v[218:219], v[222:223]
    v_cvt_pk_bf16_f32 v214, v216, v217
    v_cvt_pk_bf16_f32 v215, v218, v219
    s_add_u32 s59, s59, s65
    v_permlane16_swap_b32 v212, v214
    v_permlane16_swap_b32 v213, v215
    buffer_store_dwordx4 v[212:215], v1, s[8:11], s59 offen sc1
L_dn0:
    buffer_load_dwordx4 v[96:99], v4, s[8:11], s56 offen offset:2048 sc1
    s_add_u32 s56, s68, 284672
    buffer_load_dwordx4 v[100:103], v4, s[8:11], s56 offen offset:0 sc1
    s_add_u32 s56, s69, 266240
    buffer_load_dwordx4 v[104:107], v4, s[8:11], s56 offen offset:0 sc1
    buffer_load_dwordx4 v[108:111], v4, s[8:11], s56 offen offset:2048 sc1
    s_barrier
    s_waitcnt vmcnt(11)
    v_mfma_f32_16x16x32_bf16 v[32:35], a[32:35], v[80:83], 0
    s_add_u32 s56, s69, 270336
    buffer_load_dwordx4 v[112:115], v4, s[8:11], s56 offen offset:0 sc1
    v_mfma_f32_16x16x32_bf16 v[36:39], a[36:39], v[80:83], 0
    v_mfma_f32_16x16x32_bf16 v[40:43], a[40:43], v[80:83], 0
    v_mfma_f32_16x16x32_bf16 v[44:47], a[44:47], v[80:83], 0
    s_waitcnt vmcnt(11)
    v_mfma_f32_16x16x32_bf16 v[32:35], a[48:51], v[84:87], v[32:35]
    s_add_u32 s56, s69, 280576
    buffer_load_dwordx4 v[116:119], v4, s[8:11], s56 offen offset:0 sc1
    v_mfma_f32_16x16x32_bf16 v[36:39], a[52:55], v[84:87], v[36:39]
    v_mfma_f32_16x16x32_bf16 v[40:43], a[56:59], v[84:87], v[40:43]
    v_mfma_f32_16x16x32_bf16 v[44:47], a[60:63], v[84:87], v[44:47]
    s_waitcnt vmcnt(11)
    v_mfma_f32_16x16x32_bf16 v[32:35], a[64:67], v[88:91], v[32:35]
    buffer_load_dwordx4 v[120:123], v4, s[8:11], s56 offen offset:2048 sc1
    v_mfma_f32_16x16x32_bf16 v[36:39], a[68:71], v[88:91], v[36:39]
    v_mfma_f32_16x16x32_bf16 v[40:43], a[72:75], v[88:91], v[40:43]
    v_mfma_f32_16x16x32_bf16 v[44:47], a[76:79], v[88:91], v[44:47]
    s_waitcnt vmcnt(11)
    v_mfma_f32_16x16x32_bf16 v[32:35], a[144:147], v[92:95], v[32:35]
    buffer_load_dword v22, v6, s[8:11], s44 offen nt
    v_mfma_f32_16x16x32_bf16 v[36:39], a[148:151], v[92:95], v[36:39]
    s_add_u32 s56, s69, 284672
    buffer_load_dwordx4 v[124:127], v4, s[8:11], s56 offen offset:0 sc1
    v_mfma_f32_16x16x32_bf16 v[40:43], a[152:155], v[92:95], v[40:43]
    v_mfma_f32_16x16x32_bf16 v[44:47], a[156:159], v[92:95], v[44:47]
    s_waitcnt vmcnt(8)
    v_mfma_f32_16x16x32_bf16 v[32:35], a[160:163], v[96:99], v[32:35]
    s_add_u32 s12, s26, 5
    v_mov_b32 v23, s12
    s_add_u32 s56, s70, 266240
    v_mfma_f32_16x16x32_bf16 v[36:39], a[164:167], v[96:99], v[36:39]
    buffer_load_dwordx4 v[128:131], v4, s[8:11], s56 offen offset:0 sc1
    v_mfma_f32_16x16x32_bf16 v[40:43], a[168:171], v[96:99], v[40:43]
    s_cmp_lg_u32 s27, 0
    s_cbranch_scc1 L_slow_39
    buffer_store_dword v23, v5, s[8:11], s45 offen
L_sig_40:
    v_mfma_f32_16x16x32_bf16 v[44:47], a[172:175], v[96:99], v[44:47]
    s_waitcnt vmcnt(9)
    v_mfma_f32_16x16x32_bf16 v[32:35], a[176:179], v[100:103], v[32:35]
    buffer_load_dwordx4 v[132:135], v4, s[8:11], s56 offen offset:2048 sc1
    v_mfma_f32_16x16x32_bf16 v[36:39], a[180:183], v[100:103], v[36:39]
    v_mfma_f32_16x16x32_bf16 v[40:43], a[184:187], v[100:103], v[40:43]
    v_mfma_f32_16x16x32_bf16 v[44:47], a[188:191], v[100:103], v[44:47]
    s_waitcnt vmcnt(9)
    v_mfma_f32_16x16x32_bf16 v[48:51], a[32:35], v[104:107], 0
    s_add_u32 s56, s70, 270336
    buffer_load_dwordx4 v[136:139], v4, s[8:11], s56 offen offset:0 sc1
    v_mfma_f32_16x16x32_bf16 v[52:55], a[36:39], v[104:107], 0
    v_mfma_f32_16x16x32_bf16 v[56:59], a[40:43], v[104:107], 0
    v_mfma_f32_16x16x32_bf16 v[60:63], a[44:47], v[104:107], 0
    s_waitcnt vmcnt(9)
    v_mfma_f32_16x16x32_bf16 v[48:51], a[48:51], v[108:111], v[48:51]
    s_add_u32 s56, s70, 280576
    buffer_load_dwordx4 v[140:143], v4, s[8:11], s56 offen offset:0 sc1
    v_mfma_f32_16x16x32_bf16 v[52:55], a[52:55], v[108:111], v[52:55]
    v_mfma_f32_16x16x32_bf16 v[56:59], a[56:59], v[108:111], v[56:59]
    v_add_u32 v16, s72, v2
    v_mfma_f32_16x16x32_bf16 v[60:63], a[60:63], v[108:111], v[60:63]
    s_waitcnt vmcnt(9)
    v_mfma_f32_16x16x32_bf16 v[48:51], a[64:67], v[112:115], v[48:51]
    buffer_load_dwordx4 v[80:83], v4, s[8:11], s56 offen offset:2048 sc1
    v_mfma_f32_16x16x32_bf16 v[52:55], a[68:71], v[112:115], v[52:55]
    v_add_u32 v17, s73, v2
    v_mfma_f32_16x16x32_bf16 v[56:59], a[72:75], v[112:115], v[56:59]
    v_add_u32 v18, s74, v2
    v_mfma_f32_16x16x32_bf16 v[60:63], a[76:79], v[112:115], v[60:63]
    s_waitcnt vmcnt(9)
    v_mfma_f32_16x16x32_bf16 v[48:51], a[144:147], v[116:119], v[48:51]
    s_add_u32 s56, s70, 284672
    buffer_load_dwordx4 v[84:87], v4, s[8:11], s56 offen offset:0 sc1
    v_mfma_f32_16x16x32_bf16 v[52:55], a[148:151], v[116:119], v[52:55]
    v_add_u32 v19, s32, v2
    v_mfma_f32_16x16x32_bf16 v[56:59], a[152:155], v[116:119], v[56:59]
    v_mfma_f32_16x16x32_bf16 v[60:63], a[156:159], v[116:119], v[60:63]
    s_waitcnt vmcnt(9)
    s_lshl_b32 s60, s22, 2
    s_add_u32 s60, s60, s20
    v_mfma_f32_16x16x32_bf16 v[48:51], a[160:163], v[120:123], v[48:51]
    s_add_u32 s3, s26, 4
    s_waitcnt vmcnt(8)
    v_subrev_u32 v22, s3, v22
    v_mfma_f32_16x16x32_bf16 v[52:55], a[164:167], v[120:123], v[52:55]
    s_lshl_b32 s60, s60, 6
    s_add_u32 s60, s60, 110592
    v_and_or_b32 v20, v6, 63, s60
    v_mfma_f32_16x16x32_bf16 v[56:59], a[168:171], v[120:123], v[56:59]
    v_cmp_lt_u32 vcc, 15, v22
    ds_read_b32 v20, v20
    v_mfma_f32_16x16x32_bf16 v[60:63], a[172:175], v[120:123], v[60:63]
    s_waitcnt vmcnt(7)
    v_lshlrev_b32 v208, 16, v8
    v_mfma_f32_16x16x32_bf16 v[48:51], a[176:179], v[124:127], v[48:51]
    s_and_b64 vcc, vcc, s[42:43]
    s_or_b64 vcc, vcc, s[0:1]
    s_cbranch_scc1 L_cspin_35
L_cback_36:
    v_mfma_f32_16x16x32_bf16 v[52:55], a[180:183], v[124:127], v[52:55]
    s_add_u32 s56, s68, 264192
    buffer_load_dwordx4 v[88:91], v4, s[8:11], s56 offen offset:0 sc1
    v_mfma_f32_16x16x32_bf16 v[56:59], a[184:187], v[124:127], v[56:59]
    s_add_u32 s56, s68, 272384
    v_and_b32 v209, 0xffff0000, v8
    v_mfma_f32_16x16x32_bf16 v[60:63], a[188:191], v[124:127], v[60:63]
    s_waitcnt vmcnt(7)
    buffer_load_dwordx4 v[92:95], v4, s[8:11], s56 offen offset:0 sc1
    v_mfma_f32_16x16x32_bf16 v[64:67], a[32:35], v[128:131], 0
    s_add_u32 s56, s68, 278528
    v_lshlrev_b32 v210, 16, v9
    v_mfma_f32_16x16x32_bf16 v[68:71], a[36:39], v[128:131], 0
    buffer_load_dwordx4 v[96:99], v4, s[8:11], s56 offen offset:0 sc1
    v_mfma_f32_16x16x32_bf16 v[72:75], a[40:43], v[128:131], 0
    v_and_b32 v211, 0xffff0000, v9
    v_mfma_f32_16x16x32_bf16 v[76:79], a[44:47], v[128:131], 0
    s_waitcnt vmcnt(7)
    v_lshlrev_b32 v212, 16, v10
    v_mfma_f32_16x16x32_bf16 v[64:67], a[48:51], v[132:135], v[64:67]
    s_add_u32 s56, s68, 286720
    buffer_load_dwordx4 v[100:103], v4, s[8:11], s56 offen offset:0 sc1
    v_mfma_f32_16x16x32_bf16 v[68:71], a[52:55], v[132:135], v[68:71]
    v_mfma_f32_16x16x32_bf16 v[72:75], a[56:59], v[132:135], v[72:75]
    v_and_b32 v213, 0xffff0000, v10
    v_mfma_f32_16x16x32_bf16 v[76:79], a[60:63], v[132:135], v[76:79]
    s_waitcnt vmcnt(7)
    v_mfma_f32_16x16x32_bf16 v[64:67], a[64:67], v[136:139], v[64:67]
    s_add_u32 s56, s69, 264192
    buffer_load_dwordx4 v[104:107], v4, s[8:11], s56 offen offset:0 sc1
    v_mfma_f32_16x16x32_bf16 v[68:71], a[68:71], v[136:139], v[68:71]
    v_lshlrev_b32 v214, 16, v11
    v_mfma_f32_16x16x32_bf16 v[72:75], a[72:75], v[136:139], v[72:75]
    v_mfma_f32_16x16x32_bf16 v[76:79], a[76:79], v[136:139], v[76:79]
    s_waitcnt vmcnt(7)
    v_and_b32 v215, 0xffff0000, v11
    v_mfma_f32_16x16x32_bf16 v[64:67], a[144:147], v[140:143], v[64:67]
    buffer_load_dword v22, v6, s[8:11], s44 offen nt
    v_mfma_f32_16x16x32_bf16 v[68:71], a[148:151], v[140:143], v[68:71]
    s_add_u32 s56, s69, 272384
    v_lshlrev_b32 v216, 16, v12
    v_mfma_f32_16x16x32_bf16 v[72:75], a[152:155], v[140:143], v[72:75]
    buffer_load_dwordx4 v[108:111], v4, s[8:11], s56 offen offset:0 sc1
    v_mfma_f32_16x16x32_bf16 v[76:79], a[156:159], v[140:143], v[76:79]
    s_waitcnt vmcnt(8)
    v_mfma_f32_16x16x32_bf16 v[64:67], a[160:163], v[80:83], v[64:67]
    s_add_u32 s56, s69, 278528
    v_and_b32 v217, 0xffff0000, v12
    v_mfma_f32_16x16x32_bf16 v[68:71], a[164:167], v[80:83], v[68:71]
    buffer_load_dwordx4 v[112:115], v4, s[8:11], s56 offen offset:0 sc1
    v_mfma_f32_16x16x32_bf16 v[72:75], a[168:171], v[80:83], v[72:75]
    v_lshlrev_b32 v218, 16, v13
    v_mfma_f32_16x16x32_bf16 v[76:79], a[172:175], v[80:83], v[76:79]
    s_waitcnt vmcnt(8)
    v_mfma_f32_16x16x32_bf16 v[64:67], a[176:179], v[84:87], v[64:67]
    s_add_u32 s56, s69, 286720
    buffer_load_dwordx4 v[116:119], v4, s[8:11], s56 offen offset:0 sc1
    v_mfma_f32_16x16x32_bf16 v[68:71], a[180:183], v[84:87], v[68:71]
    v_and_b32 v219, 0xffff0000, v13
    v_mfma_f32_16x16x32_bf16 v[72:75], a[184:187], v[84:87], v[72:75]
    v_mfma_f32_16x16x32_bf16 v[76:79], a[188:191], v[84:87], v[76:79]
    s_waitcnt vmcnt(8)
    v_lshlrev_b32 v220, 16, v14
    v_mfma_f32_16x16x32_bf16 v[32:35], a[16:19], v[88:91], v[32:35]
    s_add_u32 s56, s70, 264192
    buffer_load_dwordx4 v[120:123], v4, s[8:11], s56 offen offset:0 sc1
    v_mfma_f32_16x16x32_bf16 v[36:39], a[20:23], v[88:91], v[36:39]
    v_and_b32 v221, 0xffff0000, v14
    v_mfma_f32_16x16x32_bf16 v[40:43], a[24:27], v[88:91], v[40:43]
    v_mfma_f32_16x16x32_bf16 v[44:47], a[28:31], v[88:91], v[44:47]
    s_waitcnt vmcnt(8)
    v_mfma_f32_16x16x32_bf16 v[32:35], a[80:83], v[92:95], v[32:35]
    s_add_u32 s56, s70, 272384
    buffer_load_dwordx4 v[124:127], v4, s[8:11], s56 offen offset:0 sc1
    v_mfma_f32_16x16x32_bf16 v[36:39], a[84:87], v[92:95], v[36:39]
    v_lshlrev_b32 v222, 16, v15
    v_mfma_f32_16x16x32_bf16 v[40:43], a[88:91], v[92:95], v[40:43]
    v_and_b32 v223, 0xffff0000, v15
    v_mfma_f32_16x16x32_bf16 v[44:47], a[92:95], v[92:95], v[44:47]
    s_waitcnt vmcnt(8)
    v_mfma_f32_16x16x32_bf16 v[32:35], a[128:131], v[96:99], v[32:35]
    s_add_u32 s56, s70, 278528
    buffer_load_dwordx4 v[128:131], v4, s[8:11], s56 offen offset:0 sc1
    v_mfma_f32_16x16x32_bf16 v[36:39], a[132:135], v[96:99], v[36:39]
    v_mfma_f32_16x16x32_bf16 v[40:43], a[136:139], v[96:99], v[40:43]
    v_mfma_f32_16x16x32_bf16 v[44:47], a[140:143], v[96:99], v[44:47]
    s_waitcnt vmcnt(8)
    v_mfma_f32_16x16x32_bf16 v[32:35], a[192:195], v[100:103], v[32:35]
    s_add_u32 s56, s70, 286720
    buffer_load_dwordx4 v[132:135], v4, s[8:11], s56 offen offset:0 sc1
    v_mfma_f32_16x16x32_bf16 v[36:39], a[196:199], v[100:103], v[36:39]
    v_mfma_f32_16x16x32_bf16 v[40:43], a[200:203], v[100:103], v[40:43]
    v_mfma_f32_16x16x32_bf16 v[44:47], a[204:207], v[100:103], v[44:47]
    s_waitcnt vmcnt(8)
    v_mfma_f32_16x16x32_bf16 v[48:51], a[16:19], v[104:107], v[48:51]
    s_add_u32 s3, s26, 5
    s_waitcnt vmcnt(7)
    v_subrev_u32 v22, s3, v22
    v_mfma_f32_16x16x32_bf16 v[52:55], a[20:23], v[104:107], v[52:55]
    v_cmp_lt_u32 vcc, 15, v22
    v_mfma_f32_16x16x32_bf16 v[56:59], a[24:27], v[104:107], v[56:59]
    s_and_b64 vcc, vcc, s[42:43]
    s_or_b64 vcc, vcc, s[0:1]
    s_cbranch_scc1 L_cspin_37
L_cback_38:
    v_mfma_f32_16x16x32_bf16 v[60:63], a[28:31], v[104:107], v[60:63]
    s_waitcnt vmcnt(6)
    s_add_u32 s56, s68, 262144
    v_mfma_f32_16x16x32_bf16 v[48:51], a[80:83], v[108:111], v[48:51]
    buffer_load_dwordx4 v[136:139], v4, s[8:11], s56 offen offset:0 sc1
    v_mfma_f32_16x16x32_bf16 v[52:55], a[84:87], v[108:111], v[52:55]
    s_add_u32 s56, s68, 274432
    buffer_load_dwordx4 v[140:143], v4, s[8:11], s56 offen offset:0 sc1
    v_mfma_f32_16x16x32_bf16 v[56:59], a[88:91], v[108:111], v[56:59]
    v_mfma_f32_16x16x32_bf16 v[60:63], a[92:95], v[108:111], v[60:63]
    s_waitcnt vmcnt(7)
    v_mfma_f32_16x16x32_bf16 v[48:51], a[128:131], v[112:115], v[48:51]
    buffer_load_dwordx4 v[80:83], v4, s[8:11], s56 offen offset:2048 sc1
    v_mfma_f32_16x16x32_bf16 v[52:55], a[132:135], v[112:115], v[52:55]
    v_mfma_f32_16x16x32_bf16 v[56:59], a[136:139], v[112:115], v[56:59]
    v_mfma_f32_16x16x32_bf16 v[60:63], a[140:143], v[112:115], v[60:63]
    s_waitcnt vmcnt(7)
    v_mfma_f32_16x16x32_bf16 v[48:51], a[192:195], v[116:119], v[48:51]
    s_add_u32 s56, s68, 288768
    buffer_load_dwordx4 v[84:87], v4, s[8:11], s56 offen offset:0 sc1
    v_mfma_f32_16x16x32_bf16 v[52:55], a[196:199], v[116:119], v[52:55]
    v_mfma_f32_16x16x32_bf16 v[56:59], a[200:203], v[116:119], v[56:59]
    v_mfma_f32_16x16x32_bf16 v[60:63], a[204:207], v[116:119], v[60:63]
    s_waitcnt vmcnt(7)
    v_mfma_f32_16x16x32_bf16 v[64:67], a[16:19], v[120:123], v[64:67]
    s_add_u32 s56, s69, 262144
    buffer_load_dwordx4 v[88:91], v4, s[8:11], s56 offen offset:0 sc1
    v_mfma_f32_16x16x32_bf16 v[68:71], a[20:23], v[120:123], v[68:71]
    v_mfma_f32_16x16x32_bf16 v[72:75], a[24:27], v[120:123], v[72:75]
    v_mfma_f32_16x16x32_bf16 v[76:79], a[28:31], v[120:123], v[76:79]
    s_waitcnt vmcnt(7)
    v_mfma_f32_16x16x32_bf16 v[64:67], a[80:83], v[124:127], v[64:67]
    s_add_u32 s56, s69, 274432
    buffer_load_dwordx4 v[92:95], v4, s[8:11], s56 offen offset:0 sc1
    v_mfma_f32_16x16x32_bf16 v[68:71], a[84:87], v[124:127], v[68:71]
    v_mfma_f32_16x16x32_bf16 v[72:75], a[88:91], v[124:127], v[72:75]
    v_mfma_f32_16x16x32_bf16 v[76:79], a[92:95], v[124:127], v[76:79]
    s_waitcnt vmcnt(7)
    v_mfma_f32_16x16x32_bf16 v[64:67], a[128:131], v[128:131], v[64:67]
    buffer_load_dwordx4 v[96:99], v4, s[8:11], s56 offen offset:2048 sc1
    v_mfma_f32_16x16x32_bf16 v[68:71], a[132:135], v[128:131], v[68:71]
    v_mfma_f32_16x16x32_bf16 v[72:75], a[136:139], v[128:131], v[72:75]
    v_mfma_f32_16x16x32_bf16 v[76:79], a[140:143], v[128:131], v[76:79]
    s_waitcnt vmcnt(7)
    v_mfma_f32_16x16x32_bf16 v[64:67], a[192:195], v[132:135], v[64:67]
    s_add_u32 s56, s69, 288768
    buffer_load_dwordx4 v[100:103], v4, s[8:11], s56 offen offset:0 sc1
    v_mfma_f32_16x16x32_bf16 v[68:71], a[196:199], v[132:135], v[68:71]
    v_mfma_f32_16x16x32_bf16 v[72:75], a[200:203], v[132:135], v[72:75]
    v_mfma_f32_16x16x32_bf16 v[76:79], a[204:207], v[132:135], v[76:79]
    s_waitcnt vmcnt(7)
    v_mfma_f32_16x16x32_bf16 v[32:35], a[0:3], v[136:139], v[32:35]
    s_add_u32 s56, s70, 262144
    buffer_load_dwordx4 v[104:107], v4, s[8:11], s56 offen offset:0 sc1
    v_mfma_f32_16x16x32_bf16 v[36:39], a[4:7], v[136:139], v[36:39]
    v_mfma_f32_16x16x32_bf16 v[40:43], a[8:11], v[136:139], v[40:43]
    v_mfma_f32_16x16x32_bf16 v[44:47], a[12:15], v[136:139], v[44:47]
    s_waitcnt vmcnt(7)
    v_mfma_f32_16x16x32_bf16 v[32:35], a[96:99], v[140:143], v[32:35]
    s_add_u32 s56, s70, 274432
    buffer_load_dwordx4 v[108:111], v4, s[8:11], s56 offen offset:0 sc1
    v_mfma_f32_16x16x32_bf16 v[36:39], a[100:103], v[140:143], v[36:39]
    v_mfma_f32_16x16x32_bf16 v[40:43], a[104:107], v[140:143], v[40:43]
    v_mfma_f32_16x16x32_bf16 v[44:47], a[108:111], v[140:143], v[44:47]
    s_waitcnt vmcnt(7)
    v_mfma_f32_16x16x32_bf16 v[32:35], a[112:115], v[80:83], v[32:35]
    buffer_load_dwordx4 v[112:115], v4, s[8:11], s56 offen offset:2048 sc1
    v_mfma_f32_16x16x32_bf16 v[36:39], a[116:119], v[80:83], v[36:39]
    v_mfma_f32_16x16x32_bf16 v[40:43], a[120:123], v[80:83], v[40:43]
    v_mfma_f32_16x16x32_bf16 v[44:47], a[124:127], v[80:83], v[44:47]
    s_waitcnt vmcnt(7)
    v_mfma_f32_16x16x32_bf16 v[32:35], a[208:211], v[84:87], v[32:35]
    s_add_u32 s56, s70, 288768
    buffer_load_dwordx4 v[116:119], v4, s[8:11], s56 offen offset:0 sc1
    v_mfma_f32_16x16x32_bf16 v[36:39], a[212:215], v[84:87], v[36:39]
    v_mfma_f32_16x16x32_bf16 v[40:43], a[216:219], v[84:87], v[40:43]
    v_mfma_f32_16x16x32_bf16 v[44:47], a[220:223], v[84:87], v[44:47]
    s_waitcnt vmcnt(7)
    v_mfma_f32_16x16x32_bf16 v[48:51], a[0:3], v[88:91], v[48:51]
    s_add_u32 s56, s71, 262144
    buffer_load_dwordx4 v[120:123], v4, s[8:11], s56 offen offset:0 sc1
    v_mfma_f32_16x16x32_bf16 v[52:55], a[4:7], v[88:91], v[52:55]
    ds_write_b128 v16, v[32:35] offset:49152
    v_mfma_f32_16x16x32_bf16 v[56:59], a[8:11], v[88:91], v[56:59]
    v_mfma_f32_16x16x32_bf16 v[60:63], a[12:15], v[88:91], v[60:63]
    s_waitcnt vmcnt(7)
    v_mfma_f32_16x16x32_bf16 v[48:51], a[96:99], v[92:95], v[48:51]
    buffer_load_dwordx4 v[124:127], v4, s[8:11], s56 offen offset:2048 sc1
    v_mfma_f32_16x16x32_bf16 v[52:55], a[100:103], v[92:95], v[52:55]
    ds_write_b128 v16, v[36:39] offset:50176
    v_mfma_f32_16x16x32_bf16 v[56:59], a[104:107], v[92:95], v[56:59]
    v_mfma_f32_16x16x32_bf16 v[60:63], a[108:111], v[92:95], v[60:63]
    s_waitcnt vmcnt(7)
    v_mfma_f32_16x16x32_bf16 v[48:51], a[112:115], v[96:99], v[48:51]
    s_add_u32 s56, s71, 266240
    buffer_load_dwordx4 v[128:131], v4, s[8:11], s56 offen offset:0 sc1
    v_mfma_f32_16x16x32_bf16 v[52:55], a[116:119], v[96:99], v[52:55]
    ds_write_b128 v16, v[40:43] offset:51200
    v_mfma_f32_16x16x32_bf16 v[56:59], a[120:123], v[96:99], v[56:59]
    v_mfma_f32_16x16x32_bf16 v[60:63], a[124:127], v[96:99], v[60:63]
    s_waitcnt vmcnt(7)
    v_mfma_f32_16x16x32_bf16 v[48:51], a[208:211], v[100:103], v[48:51]
    buffer_load_dwordx4 v[132:135], v4, s[8:11], s56 offen offset:2048 sc1
    v_mfma_f32_16x16x32_bf16 v[52:55], a[212:215], v[100:103], v[52:55]
    ds_write_b128 v16, v[44:47] offset:52224
    v_mfma_f32_16x16x32_bf16 v[56:59], a[216:219], v[100:103], v[56:59]
    s_add_u32 s15, s13, L_qkv1-L_pc+0
    s_min_u32 s15, s15, L_code_end-L_pc-4
    v_mov_b32 v24, s15
    v_mfma_f32_16x16x32_bf16 v[60:63], a[220:223], v[100:103], v[60:63]
    s_waitcnt vmcnt(7)
    global_load_dword a255, v24, s[4:5]
    v_mfma_f32_16x16x32_bf16 v[64:67], a[0:3], v[104:107], v[64:67]
    s_add_u32 s56, s71, 270336
    buffer_load_dwordx4 v[136:139], v4, s[8:11], s56 offen offset:0 sc1
    v_mfma_f32_16x16x32_bf16 v[68:71], a[4:7], v[104:107], v[68:71]
    ds_write_b128 v17, v[48:51] offset:49152
    v_mfma_f32_16x16x32_bf16 v[72:75], a[8:11], v[104:107], v[72:75]
    v_mfma_f32_16x16x32_bf16 v[76:79], a[12:15], v[104:107], v[76:79]
    s_waitcnt vmcnt(8)
    v_mfma_f32_16x16x32_bf16 v[64:67], a[96:99], v[108:111], v[64:67]
    buffer_load_dwordx4 v[140:143], v4, s[8:11], s56 offen offset:2048 sc1
    v_mfma_f32_16x16x32_bf16 v[68:71], a[100:103], v[108:111], v[68:71]
    ds_write_b128 v17, v[52:55] offset:50176
    v_mfma_f32_16x16x32_bf16 v[72:75], a[104:107], v[108:111], v[72:75]
    v_mfma_f32_16x16x32_bf16 v[76:79], a[108:111], v[108:111], v[76:79]
    s_waitcnt vmcnt(8)
    v_mfma_f32_16x16x32_bf16 v[64:67], a[112:115], v[112:115], v[64:67]
    s_add_u32 s56, s71, 274432
    buffer_load_dwordx4 v[80:83], v4, s[8:11], s56 offen offset:0 sc1
    v_mfma_f32_16x16x32_bf16 v[68:71], a[116:119], v[112:115], v[68:71]
    ds_write_b128 v17, v[56:59] offset:51200
    v_mfma_f32_16x16x32_bf16 v[72:75], a[120:123], v[112:115], v[72:75]
    v_mfma_f32_16x16x32_bf16 v[76:79], a[124:127], v[112:115], v[76:79]
    s_waitcnt vmcnt(8)
    v_mfma_f32_16x16x32_bf16 v[64:67], a[208:211], v[116:119], v[64:67]
    buffer_load_dwordx4 v[84:87], v4, s[8:11], s56 offen offset:2048 sc1
    v_mfma_f32_16x16x32_bf16 v[68:71], a[212:215], v[116:119], v[68:71]
    ds_write_b128 v17, v[60:63] offset:52224
    v_mfma_f32_16x16x32_bf16 v[72:75], a[216:219], v[116:119], v[72:75]
    v_mfma_f32_16x16x32_bf16 v[76:79], a[220:223], v[116:119], v[76:79]
    s_waitcnt vmcnt(8)
    v_mfma_f32_16x16x32_bf16 v[144:147], a[0:3], v[120:123], 0
    s_add_u32 s56, s71, 278528
    buffer_load_dwordx4 v[88:91], v4, s[8:11], s56 offen offset:0 sc1
    v_mfma_f32_16x16x32_bf16 v[148:151], a[4:7], v[120:123], 0
    ds_write_b128 v18, v[64:67] offset:49152
    v_mfma_f32_16x16x32_bf16 v[152:155], a[8:11], v[120:123], 0
    v_mfma_f32_16x16x32_bf16 v[156:159], a[12:15], v[120:123], 0
    s_waitcnt vmcnt(8)
    v_mfma_f32_16x16x32_bf16 v[144:147], a[16:19], v[124:127], v[144:147]
    buffer_load_dwordx4 v[92:95], v4, s[8:11], s56 offen offset:2048 sc1
    v_mfma_f32_16x16x32_bf16 v[148:151], a[20:23], v[124:127], v[148:151]
    ds_write_b128 v18, v[68:71] offset:50176
    v_mfma_f32_16x16x32_bf16 v[152:155], a[24:27], v[124:127], v[152:155]
    v_mfma_f32_16x16x32_bf16 v[156:159], a[28:31], v[124:127], v[156:159]
    s_waitcnt vmcnt(8)
    v_mfma_f32_16x16x32_bf16 v[144:147], a[32:35], v[128:131], v[144:147]
    s_add_u32 s56, s71, 282624
    buffer_load_dwordx4 v[96:99], v4, s[8:11], s56 offen offset:0 sc1
    v_mfma_f32_16x16x32_bf16 v[148:151], a[36:39], v[128:131], v[148:151]
    ds_write_b128 v18, v[72:75] offset:51200
    v_mfma_f32_16x16x32_bf16 v[152:155], a[40:43], v[128:131], v[152:155]
    v_mfma_f32_16x16x32_bf16 v[156:159], a[44:47], v[128:131], v[156:159]
    s_waitcnt vmcnt(8)
    v_mfma_f32_16x16x32_bf16 v[144:147], a[48:51], v[132:135], v[144:147]
    buffer_load_dwordx4 v[100:103], v4, s[8:11], s56 offen offset:2048 sc1
    v_mfma_f32_16x16x32_bf16 v[148:151], a[52:55], v[132:135], v[148:151]
    ds_write_b128 v18, v[76:79] offset:52224
    v_mfma_f32_16x16x32_bf16 v[152:155], a[56:59], v[132:135], v[152:155]
    v_mfma_f32_16x16x32_bf16 v[156:159], a[60:63], v[132:135], v[156:159]
    s_waitcnt vmcnt(7)
    v_mfma_f32_16x16x32_bf16 v[144:147], a[64:67], v[136:139], v[144:147]
    s_add_u32 s56, s71, 286720
    buffer_load_dwordx4 v[104:107], v4, s[8:11], s56 offen offset:0 sc1
    v_mfma_f32_16x16x32_bf16 v[148:151], a[68:71], v[136:139], v[148:151]
    v_mfma_f32_16x16x32_bf16 v[152:155], a[72:75], v[136:139], v[152:155]
    v_mfma_f32_16x16x32_bf16 v[156:159], a[76:79], v[136:139], v[156:159]
    s_waitcnt vmcnt(7)
    s_waitcnt lgkmcnt(0)
    v_mfma_f32_16x16x32_bf16 v[144:147], a[80:83], v[140:143], v[144:147]
    s_barrier
    v_mfma_f32_16x16x32_bf16 v[148:151], a[84:87], v[140:143], v[148:151]
    ds_read_b128 v[160:163], v19 offset:49152
    ds_read_b128 v[164:167], v19 offset:50176
    v_mfma_f32_16x16x32_bf16 v[152:155], a[88:91], v[140:143], v[152:155]
    buffer_load_dwordx4 v[108:111], v4, s[8:11], s56 offen offset:2048 sc1
    v_mfma_f32_16x16x32_bf16 v[156:159], a[92:95], v[140:143], v[156:159]
    s_waitcnt vmcnt(7)
    ds_read_b128 v[168:171], v19 offset:51200
    ds_read_b128 v[172:175], v19 offset:52224
    v_mfma_f32_16x16x32_bf16 v[144:147], a[96:99], v[80:83], v[144:147]
    ds_read_b128 v[176:179], v19 offset:53248
    ds_read_b128 v[180:183], v19 offset:54272
    v_mfma_f32_16x16x32_bf16 v[148:151], a[100:103], v[80:83], v[148:151]
    s_add_u32 s57, s98, 0
    s_add_u32 m0, s97, 0
    ds_read_b128 v[184:187], v19 offset:55296
    v_mfma_f32_16x16x32_bf16 v[152:155], a[104:107], v[80:83], v[152:155]
    buffer_load_dwordx4 v1, s[8:11], s57 offen offset:0 sc1 lds
    v_mfma_f32_16x16x32_bf16 v[156:159], a[108:111], v[80:83], v[156:159]
    s_waitcnt vmcnt(7)
    ds_read_b128 v[188:191], v19 offset:56320
    ds_read_b128 v[192:195], v19 offset:57344
    v_mfma_f32_16x16x32_bf16 v[144:147], a[112:115], v[84:87], v[144:147]
    ds_read_b128 v[196:199], v19 offset:58368
    ds_read_b128 v[200:203], v19 offset:59392
    v_mfma_f32_16x16x32_bf16 v[148:151], a[116:119], v[84:87], v[148:151]
    ds_read_b128 v[204:207], v19 offset:60416
    s_waitcnt lgkmcnt(4)
    v_mfma_f32_16x16x32_bf16 v[152:155], a[120:123], v[84:87], v[152:155]
    buffer_load_dwordx4 v1, s[8:11], s57 offen offset:1024 sc1 lds
    v_mfma_f32_16x16x32_bf16 v[156:159], a[124:127], v[84:87], v[156:159]
    s_waitcnt vmcnt(7)
    v_add_f32 v160, v160, v176
    v_add_f32 v161, v161, v177
    v_mfma_f32_16x16x32_bf16 v[144:147], a[128:131], v[88:91], v[144:147]
    v_add_f32 v162, v162, v178
    v_add_f32 v163, v163, v179
    v_mfma_f32_16x16x32_bf16 v[148:151], a[132:135], v[88:91], v[148:151]
    v_add_f32 v164, v164, v180
    v_add_f32 v165, v165, v181
    v_mfma_f32_16x16x32_bf16 v[152:155], a[136:139], v[88:91], v[152:155]
    buffer_load_dwordx4 v1, s[8:11], s57 offen offset:2048 sc1 lds
    v_mfma_f32_16x16x32_bf16 v[156:159], a[140:143], v[88:91], v[156:159]
    s_waitcnt vmcnt(7)
    v_add_f32 v166, v166, v182
    v_add_f32 v167, v167, v183
    v_mfma_f32_16x16x32_bf16 v[144:147], a[144:147], v[92:95], v[144:147]
    v_add_f32 v168, v168, v184
    v_add_f32 v169, v169, v185
    v_mfma_f32_16x16x32_bf16 v[148:151], a[148:151], v[92:95], v[148:151]
    v_add_f32 v170, v170, v186
    v_add_f32 v171, v171, v187
    v_mfma_f32_16x16x32_bf16 v[152:155], a[152:155], v[92:95], v[152:155]
    v_add_f32 v172, v172, v188
    v_add_f32 v173, v173, v189
    v_mfma_f32_16x16x32_bf16 v[156:159], a[156:159], v[92:95], v[156:159]
    s_waitcnt vmcnt(6)
    buffer_load_dwordx4 v1, s[8:11], s57 offen offset:3072 sc1 lds
    v_mfma_f32_16x16x32_bf16 v[144:147], a[160:163], v[96:99], v[144:147]
    v_add_f32 v174, v174, v190
    v_add_f32 v175, v175, v191
    v_mfma_f32_16x16x32_bf16 v[148:151], a[164:167], v[96:99], v[148:151]
    s_waitcnt lgkmcnt(0)
    v_add_f32 v160, v160, v192
    v_add_f32 v161, v161, v193
    v_mfma_f32_16x16x32_bf16 v[152:155], a[168:171], v[96:99], v[152:155]
    s_add_u32 s57, s98, 16384
    s_add_u32 m0, s97, 16384
    v_add_f32 v162, v162, v194
    v_mfma_f32_16x16x32_bf16 v[156:159], a[172:175], v[96:99], v[156:159]
    s_waitcnt vmcnt(6)
    buffer_load_dwordx4 v1, s[8:11], s57 offen offset:0 sc1 lds
    v_mfma_f32_16x16x32_bf16 v[144:147], a[176:179], v[100:103], v[144:147]
    v_add_f32 v163, v163, v195
    v_add_f32 v164, v164, v196
    v_mfma_f32_16x16x32_bf16 v[148:151], a[180:183], v[100:103], v[148:151]
    v_add_f32 v165, v165, v197
    v_add_f32 v166, v166, v198
    v_mfma_f32_16x16x32_bf16 v[152:155], a[184:187], v[100:103], v[152:155]
    v_add_f32 v167, v167, v199
    v_add_f32 v168, v168, v200
    v_mfma_f32_16x16x32_bf16 v[156:159], a[188:191], v[100:103], v[156:159]
    s_waitcnt vmcnt(6)
    v_add_f32 v169, v169, v201
    v_add_f32 v170, v170, v202
    v_mfma_f32_16x16x32_bf16 v[144:147], a[192:195], v[104:107], v[144:147]
    buffer_load_dwordx4 v1, s[8:11], s57 offen offset:1024 sc1 lds
    v_mfma_f32_16x16x32_bf16 v[148:151], a[196:199], v[104:107], v[148:151]
    v_add_f32 v171, v171, v203
    v_add_f32 v172, v172, v204
    v_mfma_f32_16x16x32_bf16 v[152:155], a[200:203], v[104:107], v[152:155]
    v_add_f32 v173, v173, v205
    v_add_f32 v174, v174, v206
    v_mfma_f32_16x16x32_bf16 v[156:159], a[204:207], v[104:107], v[156:159]
    s_waitcnt vmcnt(6)
    v_add_f32 v175, v175, v207
    v_fma_f32 v208, v160, v20, v208
    v_mfma_f32_16x16x32_bf16 v[144:147], a[208:211], v[108:111], v[144:147]
    buffer_load_dwordx4 v1, s[8:11], s57 offen offset:2048 sc1 lds
    v_mfma_f32_16x16x32_bf16 v[148:151], a[212:215], v[108:111], v[148:151]
    v_fma_f32 v209, v161, v20, v209
    v_fma_f32 v210, v162, v20, v210
    v_mfma_f32_16x16x32_bf16 v[152:155], a[216:219], v[108:111], v[152:155]
    v_fma_f32 v211, v163, v20, v211
    v_fma_f32 v212, v164, v20, v212
    v_mfma_f32_16x16x32_bf16 v[156:159], a[220:223], v[108:111], v[156:159]
    v_fma_f32 v213, v165, v20, v213
    v_fma_f32 v214, v166, v20, v214
    v_fma_f32 v215, v167, v20, v215
    v_fma_f32 v216, v168, v20, v216
    v_fma_f32 v217, v169, v20, v217
    v_fma_f32 v218, v170, v20, v218
    v_fma_f32 v219, v171, v20, v219
    v_fma_f32 v220, v172, v20, v220
    v_fma_f32 v221, v173, v20, v221
    v_fma_f32 v222, v174, v20, v222
    v_fma_f32 v223, v175, v20, v223
    v_pk_fma_f32 v[144:145], v[144:145], v[20:21], v[208:209] op_sel_hi:[1,0,1]
    v_pk_fma_f32 v[146:147], v[146:147], v[20:21], v[210:211] op_sel_hi:[1,0,1]
    v_pk_fma_f32 v[148:149], v[148:149], v[20:21], v[212:213] op_sel_hi:[1,0,1]
    v_pk_fma_f32 v[150:151], v[150:151], v[20:21], v[214:215] op_sel_hi:[1,0,1]
    v_pk_fma_f32 v[152:153], v[152:153], v[20:21], v[216:217] op_sel_hi:[1,0,1]
    v_pk_fma_f32 v[154:155], v[154:155], v[20:21], v[218:219] op_sel_hi:[1,0,1]
    v_pk_fma_f32 v[156:157], v[156:157], v[20:21], v[220:221] op_sel_hi:[1,0,1]
    v_pk_fma_f32 v[158:159], v[158:159], v[20:21], v[222:223] op_sel_hi:[1,0,1]
    v_cvt_pk_bf16_f32 v8, v144, v145
    v_cvt_pk_bf16_f32 v9, v146, v147
    v_cvt_pk_bf16_f32 v10, v148, v149
    v_cvt_pk_bf16_f32 v11, v150, v151
    v_cvt_pk_bf16_f32 v12, v152, v153
    v_cvt_pk_bf16_f32 v13, v154, v155
    v_cvt_pk_bf16_f32 v14, v156, v157
    v_cvt_pk_bf16_f32 v15, v158, v159
    s_add_u32 s59, s30, 0
    buffer_store_dwordx4 v[8:11], v4, s[8:11], s59 offen offset:0
    buffer_store_dwordx4 v[12:15], v4, s[8:11], s59 offen offset:2048
    v_dot2_f32_bf16 v26, v8, s50, 0
    v_dot2_f32_bf16 v27, v8, v8, 0
    v_dot2_f32_bf16 v28, v12, s50, 0
    v_dot2_f32_bf16 v29, v12, v12, 0
    v_dot2_f32_bf16 v26, v9, s50, v26
    v_dot2_f32_bf16 v27, v9, v9, v27
    v_dot2_f32_bf16 v28, v13, s50, v28
    v_dot2_f32_bf16 v29, v13, v13, v29
    v_dot2_f32_bf16 v26, v10, s50, v26
    v_dot2_f32_bf16 v27, v10, v10, v27
    v_dot2_f32_bf16 v28, v14, s50, v28
    v_dot2_f32_bf16 v29, v14, v14, v29
    v_dot2_f32_bf16 v26, v11, s50, v26
    v_dot2_f32_bf16 v27, v11, v11, v27
    v_dot2_f32_bf16 v28, v15, s50, v28
    v_dot2_f32_bf16 v29, v15, v15, v29
    v_accvgpr_read_b32 v25, a225
    s_add_u32 s59, s49, 720896
    v_add_f32 v26, v26, v28
    v_add_f32 v27, v27, v29
    s_nop 1
    v_permlane32_swap_b32 v26, v27
    v_add_f32 v26, v26, v27
    v_mov_b32 v27, v26
    s_nop 1
    v_permlane16_swap_b32 v26, v27
    v_add_f32 v26, v26, v27
    buffer_store_dword v26, v25, s[8:11], s59 offen
    buffer_load_dwordx4 v1, s[8:11], s57 offen offset:3072 sc1 lds
    s_add_u32 s57, s35, 98304
    s_add_u32 m0, s39, 98304
    s_nop 0
    buffer_load_dwordx4 v1, s[8:11], s57 offen offset:0 sc1 lds
    s_add_u32 s12, s26, 6
    v_mov_b32 v30, s12
    s_cmp_lg_u32 s51, 0x40000000
    s_cbranch_scc1 L_halo_43
    s_waitcnt vmcnt(2)
L_hback_44:
    s_cmp_lg_u32 s27, 0
    s_cbranch_scc1 L_slow_41
    buffer_store_dword v30, v5, s[8:11], s45 offen
L_sig_42:
    s_cmp_lg_u32 s51, 0x40000000
    s_cbranch_scc1 L_halo_45
L_hback_46:
    s_branch L_page_47
    .p2align 12
L_page_47:
L_qkv1:
    v_accvgpr_read_b32 v16, a229
    s_add_u32 s62, s39, 2048
    v_add_u32 v17, s62, v1
    v_add_u32 v18, 0xc000, v17
    v_and_b32 v28, 0x380, v1
    s_mov_b32 s63, 0x40000
    s_cmp_lg_u32 s27, 0
    s_cbranch_scc1 L_far_48
L_poll_50:
    buffer_load_dword v22, v6, s[8:11], s44 offen nt
    s_sub_u32 s63, s63, 1
    s_cbranch_scc1 L_main_done
    s_waitcnt vmcnt(0)
    v_subrev_u32 v22, s12, v22
    v_cmp_lt_u32 vcc, 15, v22
    s_nop 0
    s_and_b64 vcc, vcc, s[40:41]
    s_cbranch_scc1 L_poll_50
L_ok_49:
    s_add_u32 s56, s29, 0
    buffer_load_dwordx4 v[32:35], v4, s[8:11], s56 offen offset:0 sc1
    buffer_load_dwordx4 v[36:39], v4, s[8:11], s56 offen offset:256 sc1
    buffer_load_dwordx4 v[40:43], v4, s[8:11], s56 offen offset:2048 sc1
    buffer_load_dwordx4 v[44:47], v4, s[8:11], s56 offen offset:2304 sc1
    s_add_u32 s56, s29, 4096
    buffer_load_dwordx4 v[48:51], v4, s[8:11], s56 offen offset:0 sc1
    buffer_load_dwordx4 v[52:55], v4, s[8:11], s56 offen offset:256 sc1
    buffer_load_dwordx4 v[56:59], v4, s[8:11], s56 offen offset:2048 sc1
    buffer_load_dwordx4 v[60:63], v4, s[8:11], s56 offen offset:2304 sc1
    s_barrier
    ds_read_b128 v[224:227], v1 offset:0
    ds_read_b128 v[228:231], v1 offset:1024
    ds_read_b128 v[232:235], v1 offset:2048
    ds_read_b128 v[236:239], v1 offset:3072
    ds_read_b128 v[240:243], v1 offset:4096
    ds_read_b128 v[244:247], v1 offset:5120
    s_waitcnt vmcnt(7) lgkmcnt(3)
    v_mfma_f32_16x16x32_bf16 v[160:163], v[224:227], v[32:35], 0
    s_waitcnt vmcnt(6)
    s_add_u32 s56, s29, 8192
    v_mfma_f32_16x16x32_bf16 v[164:167], v[224:227], v[36:39], 0
    ds_read_b128 v[224:227], v1 offset:6144
    v_mfma_f32_16x16x32_bf16 v[168:171], v[228:231], v[32:35], 0
    buffer_load_dwordx4 v[64:67], v4, s[8:11], s56 offen offset:0 sc1
    v_mfma_f32_16x16x32_bf16 v[172:175], v[228:231], v[36:39], 0
    ds_read_b128 v[228:231], v1 offset:7168
    v_mfma_f32_16x16x32_bf16 v[176:179], v[232:235], v[32:35], 0
    buffer_load_dwordx4 v[68:71], v4, s[8:11], s56 offen offset:256 sc1
    v_mfma_f32_16x16x32_bf16 v[180:183], v[232:235], v[36:39], 0
    s_waitcnt lgkmcnt(2)
    ds_read_b128 v[232:235], v1 offset:8192
    v_mfma_f32_16x16x32_bf16 v[184:187], v[236:239], v[32:35], 0
    v_mfma_f32_16x16x32_bf16 v[188:191], v[236:239], v[36:39], 0
    ds_read_b128 v[236:239], v1 offset:9216
    v_mfma_f32_16x16x32_bf16 v[192:195], v[32:35], v[240:243], 0
    buffer_load_dwordx4 v[72:75], v4, s[8:11], s56 offen offset:2048 sc1
    v_mfma_f32_16x16x32_bf16 v[196:199], v[36:39], v[240:243], 0
    ds_read_b128 v[240:243], v1 offset:10240
    v_mfma_f32_16x16x32_bf16 v[200:203], v[32:35], v[244:247], 0
    v_mfma_f32_16x16x32_bf16 v[204:207], v[36:39], v[244:247], 0
    s_waitcnt vmcnt(7) lgkmcnt(2)
    ds_read_b128 v[244:247], v1 offset:11264
    v_mfma_f32_16x16x32_bf16 v[160:163], v[224:227], v[40:43], v[160:163]
    v_mfma_f32_16x16x32_bf16 v[164:167], v[224:227], v[44:47], v[164:167]
    ds_read_b128 v[224:227], v1 offset:12288
    v_mfma_f32_16x16x32_bf16 v[168:171], v[228:231], v[40:43], v[168:171]
    buffer_load_dwordx4 v[76:79], v4, s[8:11], s56 offen offset:2304 sc1
    v_mfma_f32_16x16x32_bf16 v[172:175], v[228:231], v[44:47], v[172:175]
    ds_read_b128 v[228:231], v1 offset:13312
    v_mfma_f32_16x16x32_bf16 v[176:179], v[232:235], v[40:43], v[176:179]
    s_add_u32 s56, s29, 12288
    v_mfma_f32_16x16x32_bf16 v[180:183], v[232:235], v[44:47], v[180:183]
    s_waitcnt lgkmcnt(2)
    ds_read_b128 v[232:235], v1 offset:14336
    v_mfma_f32_16x16x32_bf16 v[184:187], v[236:239], v[40:43], v[184:187]
    buffer_load_dwordx4 v[80:83], v4, s[8:11], s56 offen offset:0 sc1
    v_mfma_f32_16x16x32_bf16 v[188:191], v[236:239], v[44:47], v[188:191]
    ds_read_b128 v[236:239], v1 offset:15360
    v_mfma_f32_16x16x32_bf16 v[192:195], v[40:43], v[240:243], v[192:195]
    v_mfma_f32_16x16x32_bf16 v[196:199], v[44:47], v[240:243], v[196:199]
    ds_read_b128 v[240:243], v1 offset:16384
    v_mfma_f32_16x16x32_bf16 v[200:203], v[40:43], v[244:247], v[200:203]
    buffer_load_dwordx4 v[84:87], v4, s[8:11], s56 offen offset:256 sc1
    v_mfma_f32_16x16x32_bf16 v[204:207], v[44:47], v[244:247], v[204:207]
    s_waitcnt vmcnt(8) lgkmcnt(2)
    ds_read_b128 v[244:247], v1 offset:17408
    v_mfma_f32_16x16x32_bf16 v[160:163], v[224:227], v[48:51], v[160:163]
    v_mfma_f32_16x16x32_bf16 v[164:167], v[224:227], v[52:55], v[164:167]
    ds_read_b128 v[224:227], v1 offset:18432
    v_mfma_f32_16x16x32_bf16 v[168:171], v[228:231], v[48:51], v[168:171]
    buffer_load_dwordx4 v[88:91], v4, s[8:11], s56 offen offset:2048 sc1
    v_mfma_f32_16x16x32_bf16 v[172:175], v[228:231], v[52:55], v[172:175]
    ds_read_b128 v[228:231], v1 offset:19456
    v_mfma_f32_16x16x32_bf16 v[176:179], v[232:235], v[48:51], v[176:179]
    v_mfma_f32_16x16x32_bf16 v[180:183], v[232:235], v[52:55], v[180:183]
    s_waitcnt lgkmcnt(2)
    ds_read_b128 v[232:235], v1 offset:20480
    v_mfma_f32_16x16x32_bf16 v[184:187], v[236:239], v[48:51], v[184:187]
    buffer_load_dwordx4 v[92:95], v4, s[8:11], s56 offen offset:2304 sc1
    v_mfma_f32_16x16x32_bf16 v[188:191], v[236:239], v[52:55], v[188:191]
    ds_read_b128 v[236:239], v1 offset:21504
    v_mfma_f32_16x16x32_bf16 v[192:195], v[48:51], v[240:243], v[192:195]
    v_mfma_f32_16x16x32_bf16 v[196:199], v[52:55], v[240:243], v[196:199]
    ds_read_b128 v[240:243], v1 offset:22528
    v_mfma_f32_16x16x32_bf16 v[200:203], v[48:51], v[244:247], v[200:203]
    s_add_u32 s56, s29, 16384
    v_mfma_f32_16x16x32_bf16 v[204:207], v[52:55], v[244:247], v[204:207]
    s_waitcnt vmcnt(8) lgkmcnt(2)
    ds_read_b128 v[244:247], v1 offset:23552
    v_mfma_f32_16x16x32_bf16 v[160:163], v[224:227], v[56:59], v[160:163]
    buffer_load_dwordx4 v[96:99], v4, s[8:11], s56 offen offset:0 sc1
    v_mfma_f32_16x16x32_bf16 v[164:167], v[224:227], v[60:63], v[164:167]
    ds_read_b128 v[224:227], v1 offset:24576
    v_mfma_f32_16x16x32_bf16 v[168:171], v[228:231], v[56:59], v[168:171]
    v_mfma_f32_16x16x32_bf16 v[172:175], v[228:231], v[60:63], v[172:175]
    ds_read_b128 v[228:231], v1 offset:25600
    v_mfma_f32_16x16x32_bf16 v[176:179], v[232:235], v[56:59], v[176:179]
    buffer_load_dwordx4 v[100:103], v4, s[8:11], s56 offen offset:256 sc1
    v_mfma_f32_16x16x32_bf16 v[180:183], v[232:235], v[60:63], v[180:183]
    s_waitcnt lgkmcnt(2)
    ds_read_b128 v[232:235], v1 offset:26624
    v_mfma_f32_16x16x32_bf16 v[184:187], v[236:239], v[56:59], v[184:187]
    v_mfma_f32_16x16x32_bf16 v[188:191], v[236:239], v[60:63], v[188:191]
    ds_read_b128 v[236:239], v1 offset:27648
    v_mfma_f32_16x16x32_bf16 v[192:195], v[56:59], v[240:243], v[192:195]
    buffer_load_dwordx4 v[104:107], v4, s[8:11], s56 offen offset:2048 sc1
    v_mfma_f32_16x16x32_bf16 v[196:199], v[60:63], v[240:243], v[196:199]
    ds_read_b128 v[240:243], v1 offset:28672
    v_mfma_f32_16x16x32_bf16 v[200:203], v[56:59], v[244:247], v[200:203]
    v_mfma_f32_16x16x32_bf16 v[204:207], v[60:63], v[244:247], v[204:207]
    s_waitcnt vmcnt(9) lgkmcnt(2)
    ds_read_b128 v[244:247], v1 offset:29696
    v_mfma_f32_16x16x32_bf16 v[160:163], v[224:227], v[64:67], v[160:163]
    v_add_u32 v61, 98304, v6
    s_lshr_b32 s62, s39, 1
    v_mfma_f32_16x16x32_bf16 v[164:167], v[224:227], v[68:71], v[164:167]
    ds_read_b128 v[224:227], v1 offset:30720
    v_add_u32 v62, s62, v61
    v_mfma_f32_16x16x32_bf16 v[168:171], v[228:231], v[64:67], v[168:171]
    buffer_load_dwordx4 v[108:111], v4, s[8:11], s56 offen offset:2304 sc1
    v_mfma_f32_16x16x32_bf16 v[172:175], v[228:231], v[68:71], v[172:175]
    ds_read_b128 v[228:231], v1 offset:31744
    v_accvgpr_read_b32 v40, a240
    v_mfma_f32_16x16x32_bf16 v[176:179], v[232:235], v[64:67], v[176:179]
    s_add_u32 s61, s47, 16384
    buffer_load_dword v19, v28, s[8:11], s61 offen sc1
    v_mfma_f32_16x16x32_bf16 v[180:183], v[232:235], v[68:71], v[180:183]
    s_waitcnt lgkmcnt(2)
    ds_read_b128 v[232:235], v1 offset:32768
    v_accvgpr_read_b32 v41, a241
    v_mfma_f32_16x16x32_bf16 v[184:187], v[236:239], v[64:67], v[184:187]
    v_accvgpr_read_b32 v42, a242
    v_mfma_f32_16x16x32_bf16 v[188:191], v[236:239], v[68:71], v[188:191]
    ds_read_b128 v[236:239], v1 offset:33792
    v_mfma_f32_16x16x32_bf16 v[192:195], v[64:67], v[240:243], v[192:195]
    v_accvgpr_read_b32 v43, a243
    v_mfma_f32_16x16x32_bf16 v[196:199], v[68:71], v[240:243], v[196:199]
    s_add_u32 s60, s34, 720896
    ds_read_b128 v[240:243], v1 offset:34816
    v_mfma_f32_16x16x32_bf16 v[200:203], v[64:67], v[244:247], v[200:203]
    buffer_load_dwordx4 v[212:215], v1, s[8:11], s60 offen sc1
    v_mfma_f32_16x16x32_bf16 v[204:207], v[68:71], v[244:247], v[204:207]
    s_waitcnt vmcnt(10) lgkmcnt(2)
    ds_read_b128 v[244:247], v1 offset:35840
    v_accvgpr_read_b32 v44, a244
    v_mfma_f32_16x16x32_bf16 v[160:163], v[224:227], v[72:75], v[160:163]
    v_accvgpr_read_b32 v45, a245
    v_mfma_f32_16x16x32_bf16 v[164:167], v[224:227], v[76:79], v[164:167]
    ds_read_b128 v[224:227], v1 offset:36864
    v_mfma_f32_16x16x32_bf16 v[168:171], v[228:231], v[72:75], v[168:171]
    buffer_load_dwordx4 v[216:219], v1, s[8:11], s60 offen offset:1024 sc1
    v_mfma_f32_16x16x32_bf16 v[172:175], v[228:231], v[76:79], v[172:175]
    ds_read_b128 v[228:231], v1 offset:37888
    ds_read_b128 v[64:67], v17 offset:0
    v_mfma_f32_16x16x32_bf16 v[176:179], v[232:235], v[72:75], v[176:179]
    s_add_u32 s56, s29, 20480
    v_accvgpr_read_b32 v46, a246
    v_accvgpr_read_b32 v47, a247
    v_mfma_f32_16x16x32_bf16 v[180:183], v[232:235], v[76:79], v[180:183]
    s_waitcnt lgkmcnt(3)
    ds_read_b128 v[232:235], v1 offset:38912
    v_mfma_f32_16x16x32_bf16 v[184:187], v[236:239], v[72:75], v[184:187]
    buffer_load_dwordx4 v[112:115], v4, s[8:11], s56 offen offset:0 sc1
    v_mfma_f32_16x16x32_bf16 v[188:191], v[236:239], v[76:79], v[188:191]
    ds_read_b128 v[236:239], v1 offset:39936
    v_accvgpr_read_b32 v48, a248
    v_mfma_f32_16x16x32_bf16 v[192:195], v[72:75], v[240:243], v[192:195]
    v_accvgpr_read_b32 v49, a249
    v_mfma_f32_16x16x32_bf16 v[196:199], v[76:79], v[240:243], v[196:199]
    ds_read_b128 v[240:243], v1 offset:40960
    ds_read_b128 v[68:71], v17 offset:6144
    v_mfma_f32_16x16x32_bf16 v[200:203], v[72:75], v[244:247], v[200:203]
    buffer_load_dwordx4 v[116:119], v4, s[8:11], s56 offen offset:256 sc1
    v_mfma_f32_16x16x32_bf16 v[204:207], v[76:79], v[244:247], v[204:207]
    s_waitcnt vmcnt(11) lgkmcnt(3)
    ds_read_b128 v[244:247], v1 offset:41984
    v_accvgpr_read_b32 v50, a250
    v_mfma_f32_16x16x32_bf16 v[160:163], v[224:227], v[80:83], v[160:163]
    v_accvgpr_read_b32 v51, a251
    v_mfma_f32_16x16x32_bf16 v[164:167], v[224:227], v[84:87], v[164:167]
    ds_read_b128 v[224:227], v1 offset:43008
    v_mfma_f32_16x16x32_bf16 v[168:171], v[228:231], v[80:83], v[168:171]
    buffer_load_dwordx4 v[120:123], v4, s[8:11], s56 offen offset:2048 sc1
    v_mfma_f32_16x16x32_bf16 v[172:175], v[228:231], v[84:87], v[172:175]
    ds_read_b128 v[228:231], v1 offset:44032
    ds_read_b128 v[72:75], v17 offset:12288
    v_mfma_f32_16x16x32_bf16 v[176:179], v[232:235], v[80:83], v[176:179]
    v_accvgpr_read_b32 v52, a252
    v_accvgpr_read_b32 v53, a253
    v_mfma_f32_16x16x32_bf16 v[180:183], v[232:235], v[84:87], v[180:183]
    s_waitcnt lgkmcnt(3)
    ds_read_b128 v[232:235], v1 offset:45056
    v_mfma_f32_16x16x32_bf16 v[184:187], v[236:239], v[80:83], v[184:187]
    v_mov_b32 v54, s50
    v_mfma_f32_16x16x32_bf16 v[188:191], v[236:239], v[84:87], v[188:191]
    ds_read_b128 v[236:239], v1 offset:46080
    v_mfma_f32_16x16x32_bf16 v[192:195], v[80:83], v[240:243], v[192:195]
    buffer_load_dwordx4 v[124:127], v4, s[8:11], s56 offen offset:2304 sc1
    v_mfma_f32_16x16x32_bf16 v[196:199], v[84:87], v[240:243], v[196:199]
    ds_read_b128 v[240:243], v1 offset:47104
    ds_read_b128 v[76:79], v17 offset:18432
    v_mfma_f32_16x16x32_bf16 v[200:203], v[80:83], v[244:247], v[200:203]
    v_mov_b32 v55, s50
    v_accvgpr_read_b32 v56, a230
    v_mfma_f32_16x16x32_bf16 v[204:207], v[84:87], v[244:247], v[204:207]
    s_waitcnt vmcnt(11) lgkmcnt(3)
    ds_read_b128 v[244:247], v1 offset:48128
    s_waitcnt vmcnt(6)
    v_mfma_f32_16x16x32_bf16 v[160:163], v[224:227], v[88:91], v[160:163]
    v_cmp_ne_u32 vcc, s26, v19
    v_accvgpr_read_b32 v59, a231
    v_mfma_f32_16x16x32_bf16 v[164:167], v[224:227], v[92:95], v[164:167]
    ds_read_b128 v[224:227], v1 offset:49152
    s_and_b64 vcc, vcc, s[54:55]
    s_cbranch_scc1 L_lspin_51
L_lback_52:
    v_mfma_f32_16x16x32_bf16 v[168:171], v[228:231], v[88:91], v[168:171]
    s_add_u32 s62, s96, 114688
    s_add_u32 s57, s53, 745472
    s_add_u32 m0, s96, 102400
    v_mfma_f32_16x16x32_bf16 v[172:175], v[228:231], v[92:95], v[172:175]
    ds_read_b128 v[228:231], v1 offset:50176
    ds_read_b128 v[80:83], v17 offset:24576
    v_mfma_f32_16x16x32_bf16 v[176:179], v[232:235], v[88:91], v[176:179]
    v_add_u32 v57, v56, v59
    buffer_load_dwordx4 v1, s[8:11], s57 offen offset:0 sc1 lds
    v_mfma_f32_16x16x32_bf16 v[180:183], v[232:235], v[92:95], v[180:183]
    s_waitcnt lgkmcnt(3)
    ds_read_b128 v[232:235], v1 offset:51200
    v_mfma_f32_16x16x32_bf16 v[184:187], v[236:239], v[88:91], v[184:187]
    v_lshl_add_u32 v60, v0, 3, s62
    buffer_load_dwordx4 v1, s[8:11], s57 offen offset:1024 sc1 lds
    v_mfma_f32_16x16x32_bf16 v[188:191], v[236:239], v[92:95], v[188:191]
    ds_read_b128 v[236:239], v1 offset:52224
    v_mfma_f32_16x16x32_bf16 v[192:195], v[88:91], v[240:243], v[192:195]
    s_add_u32 s61, s46, 753728
    v_add_u32 v58, v57, v59
    v_and_b32 v19, 7, v0
    v_mfma_f32_16x16x32_bf16 v[196:199], v[92:95], v[240:243], v[196:199]
    ds_read_b128 v[240:243], v1 offset:53248
    ds_read_b128 v[84:87], v17 offset:30720
    v_mfma_f32_16x16x32_bf16 v[200:203], v[88:91], v[244:247], v[200:203]
    v_add_u32 v59, v58, v59
    v_lshl_add_u32 v19, v19, 3, v28
    v_mfma_f32_16x16x32_bf16 v[204:207], v[92:95], v[244:247], v[204:207]
    s_waitcnt lgkmcnt(3)
    ds_read_b128 v[244:247], v1 offset:54272
    buffer_load_dwordx2 v[220:221], v19, s[8:11], s61 offen sc1
    v_mfma_f32_16x16x32_bf16 v[160:163], v[224:227], v[96:99], v[160:163]
    s_add_u32 s56, s29, 24576
    buffer_load_dwordx4 v[128:131], v4, s[8:11], s56 offen offset:0 sc1
    v_mfma_f32_16x16x32_bf16 v[164:167], v[224:227], v[100:103], v[164:167]
    ds_read_b128 v[224:227], v1 offset:55296
    v_mfma_f32_16x16x32_bf16 v[168:171], v[228:231], v[96:99], v[168:171]
    v_mfma_f32_16x16x32_bf16 v[172:175], v[228:231], v[100:103], v[172:175]
    ds_read_b128 v[228:231], v1 offset:56320
    ds_read_b128 v[88:91], v17 offset:36864
    v_mfma_f32_16x16x32_bf16 v[176:179], v[232:235], v[96:99], v[176:179]
    v_mfma_f32_16x16x32_bf16 v[180:183], v[232:235], v[100:103], v[180:183]
    s_waitcnt lgkmcnt(3)
    ds_read_b128 v[232:235], v1 offset:57344
    v_mfma_f32_16x16x32_bf16 v[184:187], v[236:239], v[96:99], v[184:187]
    buffer_load_dwordx4 v[132:135], v4, s[8:11], s56 offen offset:256 sc1
    v_mfma_f32_16x16x32_bf16 v[188:191], v[236:239], v[100:103], v[188:191]
    ds_read_b128 v[236:239], v1 offset:58368
    v_mfma_f32_16x16x32_bf16 v[192:195], v[96:99], v[240:243], v[192:195]
    v_mfma_f32_16x16x32_bf16 v[196:199], v[100:103], v[240:243], v[196:199]
    ds_read_b128 v[240:243], v1 offset:59392
    ds_read_b128 v[92:95], v17 offset:43008
    v_mfma_f32_16x16x32_bf16 v[200:203], v[96:99], v[244:247], v[200:203]
    buffer_load_dwordx4 v[136:139], v4, s[8:11], s56 offen offset:2048 sc1
    v_mfma_f32_16x16x32_bf16 v[204:207], v[100:103], v[244:247], v[204:207]
    s_waitcnt lgkmcnt(3)
    ds_read_b128 v[244:247], v1 offset:60416
    v_mfma_f32_16x16x32_bf16 v[160:163], v[224:227], v[104:107], v[160:163]
    v_mfma_f32_16x16x32_bf16 v[164:167], v[224:227], v[108:111], v[164:167]
    ds_read_b128 v[224:227], v1 offset:61440
    v_mfma_f32_16x16x32_bf16 v[168:171], v[228:231], v[104:107], v[168:171]
    buffer_load_dwordx4 v[140:143], v4, s[8:11], s56 offen offset:2304 sc1
    v_mfma_f32_16x16x32_bf16 v[172:175], v[228:231], v[108:111], v[172:175]
    ds_read_b128 v[228:231], v1 offset:62464
    ds_read_b128 v[96:99], v18 offset:0
    v_mfma_f32_16x16x32_bf16 v[176:179], v[232:235], v[104:107], v[176:179]
    v_mfma_f32_16x16x32_bf16 v[180:183], v[232:235], v[108:111], v[180:183]
    s_waitcnt lgkmcnt(3)
    ds_read_b128 v[232:235], v1 offset:63488
    s_add_u32 s56, s29, 28672
    v_mfma_f32_16x16x32_bf16 v[184:187], v[236:239], v[104:107], v[184:187]
    buffer_load_dwordx4 v[144:147], v4, s[8:11], s56 offen offset:0 sc1
    v_mfma_f32_16x16x32_bf16 v[188:191], v[236:239], v[108:111], v[188:191]
    ds_read_b128 v[236:239], v1 offset:64512
    v_mfma_f32_16x16x32_bf16 v[192:195], v[104:107], v[240:243], v[192:195]
    v_mfma_f32_16x16x32_bf16 v[196:199], v[108:111], v[240:243], v[196:199]
    ds_read_b128 v[240:243], v2 offset:0
    ds_read_b128 v[100:103], v18 offset:6144
    v_mfma_f32_16x16x32_bf16 v[200:203], v[104:107], v[244:247], v[200:203]
    buffer_load_dwordx4 v[148:151], v4, s[8:11], s56 offen offset:256 sc1
    v_mfma_f32_16x16x32_bf16 v[204:207], v[108:111], v[244:247], v[204:207]
    s_waitcnt vmcnt(11) lgkmcnt(3)
    ds_read_b128 v[244:247], v2 offset:1024
    v_mfma_f32_16x16x32_bf16 v[160:163], v[224:227], v[112:115], v[160:163]
    v_mfma_f32_16x16x32_bf16 v[164:167], v[224:227], v[116:119], v[164:167]
    ds_read_b128 v[224:227], v2 offset:2048
    v_mfma_f32_16x16x32_bf16 v[168:171], v[228:231], v[112:115], v[168:171]
    v_mfma_f32_16x16x32_bf16 v[172:175], v[228:231], v[116:119], v[172:175]
    ds_read_b128 v[228:231], v2 offset:3072
    ds_read_b128 v[104:107], v18 offset:12288
    v_mfma_f32_16x16x32_bf16 v[176:179], v[232:235], v[112:115], v[176:179]
    s_waitcnt vmcnt(7)
    s_barrier
    v_mfma_f32_16x16x32_bf16 v[180:183], v[232:235], v[116:119], v[180:183]
    s_waitcnt lgkmcnt(3)
    ds_read_b128 v[232:235], v2 offset:4096
    buffer_load_dwordx4 v[152:155], v4, s[8:11], s56 offen offset:2048 sc1
    v_mfma_f32_16x16x32_bf16 v[184:187], v[236:239], v[112:115], v[184:187]
    ds_read_b128 v[252:255], v16 offset:0
    v_mfma_f32_16x16x32_bf16 v[188:191], v[236:239], v[116:119], v[188:191]
    ds_read_b128 v[236:239], v2 offset:5120
    v_mfma_f32_16x16x32_bf16 v[192:195], v[112:115], v[240:243], v[192:195]
    ds_read_b128 v[36:39], v16 offset:512
    v_mfma_f32_16x16x32_bf16 v[196:199], v[116:119], v[240:243], v[196:199]
    ds_read_b128 v[240:243], v2 offset:6144
    ds_read_b128 v[108:111], v18 offset:18432
    v_mfma_f32_16x16x32_bf16 v[200:203], v[112:115], v[244:247], v[200:203]
    buffer_load_dwordx4 v[156:159], v4, s[8:11], s56 offen offset:2304 sc1
    v_mfma_f32_16x16x32_bf16 v[204:207], v[116:119], v[244:247], v[204:207]
    s_waitcnt lgkmcnt(5)
    ds_read_b128 v[244:247], v2 offset:7168
    s_add_u32 s57, s37, 0
    v_mfma_f32_16x16x32_bf16 v[160:163], v[224:227], v[120:123], v[160:163]
    s_waitcnt vmcnt(8)
    s_add_u32 m0, s97, 131072
    v_mfma_f32_16x16x32_bf16 v[164:167], v[224:227], v[124:127], v[164:167]
    ds_read_b128 v[224:227], v2 offset:8192
    v_add_f32_dpp v220, v220, v220 row_ror:8 row_mask:0xf bank_mask:0xf
    v_mfma_f32_16x16x32_bf16 v[168:171], v[228:231], v[120:123], v[168:171]
    buffer_load_dwordx4 v1, s[8:11], s57 offen offset:0 sc1 lds
    v_mfma_f32_16x16x32_bf16 v[172:175], v[228:231], v[124:127], v[172:175]
    s_waitcnt lgkmcnt(6)
    ds_read_b128 v[228:231], v2 offset:9216
    ds_read_b128 v[112:115], v18 offset:24576
    v_mfma_f32_16x16x32_bf16 v[208:211], v[252:255], v[64:67], 0
    ds_read_b128 v[252:255], v16 offset:1024
    v_add_f32_dpp v221, v221, v221 row_ror:8 row_mask:0xf bank_mask:0xf
    v_mfma_f32_16x16x32_bf16 v[176:179], v[232:235], v[120:123], v[176:179]
    buffer_load_dwordx4 v1, s[8:11], s57 offen offset:1024 sc1 lds
    v_mfma_f32_16x16x32_bf16 v[180:183], v[232:235], v[124:127], v[180:183]
    s_waitcnt lgkmcnt(7)
    ds_read_b128 v[232:235], v2 offset:10240
    v_add_f32 v212, v212, v214
    v_mfma_f32_16x16x32_bf16 v[208:211], v[36:39], v[68:71], v[208:211]
    s_waitcnt lgkmcnt(5)
    ds_read_b128 v[36:39], v16 offset:1536
    v_add_f32 v213, v213, v215
    v_mfma_f32_16x16x32_bf16 v[184:187], v[236:239], v[120:123], v[184:187]
    buffer_load_dwordx4 v1, s[8:11], s57 offen offset:2048 sc1 lds
    v_mfma_f32_16x16x32_bf16 v[188:191], v[236:239], v[124:127], v[188:191]
    ds_read_b128 v[236:239], v2 offset:11264
    v_add_f32 v216, v216, v218
    v_mfma_f32_16x16x32_bf16 v[192:195], v[120:123], v[240:243], v[192:195]
    v_add_f32 v217, v217, v219
    v_mov_b32 v222, v220
    v_mfma_f32_16x16x32_bf16 v[196:199], v[124:127], v[240:243], v[196:199]
    s_waitcnt lgkmcnt(3)
    ds_read_b128 v[240:243], v2 offset:12288
    v_mov_b32 v223, v221
    v_mfma_f32_16x16x32_bf16 v[208:211], v[252:255], v[72:75], v[208:211]
    ds_read_b128 v[252:255], v16 offset:2048
    v_mfma_f32_16x16x32_bf16 v[200:203], v[120:123], v[244:247], v[200:203]
    buffer_load_dwordx4 v1, s[8:11], s57 offen offset:3072 sc1 lds
    v_mfma_f32_16x16x32_bf16 v[204:207], v[124:127], v[244:247], v[204:207]
    s_waitcnt vmcnt(10) lgkmcnt(4)
    ds_read_b128 v[244:247], v2 offset:13312
    v_mfma_f32_16x16x32_bf16 v[160:163], v[224:227], v[128:131], v[160:163]
    s_add_u32 s15, s13, L_wo1-L_pc+0
    s_barrier
    v_mfma_f32_16x16x32_bf16 v[164:167], v[224:227], v[132:135], v[164:167]
    s_waitcnt lgkmcnt(4)
    ds_read_b128 v[224:227], v2 offset:14336
    s_min_u32 s15, s15, L_code_end-L_pc-4
    v_mfma_f32_16x16x32_bf16 v[208:211], v[36:39], v[76:79], v[208:211]
    s_add_u32 s57, s37, 16384
    ds_read_b128 v[36:39], v16 offset:2560
    v_mov_b32 v29, s15
    v_mfma_f32_16x16x32_bf16 v[168:171], v[228:231], v[128:131], v[168:171]
    s_add_u32 m0, s97, 147456
    v_permlane32_swap_b32 v212, v216
    v_mfma_f32_16x16x32_bf16 v[172:175], v[228:231], v[132:135], v[172:175]
    ds_read_b128 v[228:231], v2 offset:15360
    buffer_load_dwordx4 v1, s[8:11], s57 offen offset:0 sc1 lds
    v_mfma_f32_16x16x32_bf16 v[176:179], v[232:235], v[128:131], v[176:179]
    global_load_dword a255, v29, s[4:5]
    v_permlane32_swap_b32 v213, v217
    v_mfma_f32_16x16x32_bf16 v[180:183], v[232:235], v[132:135], v[180:183]
    s_waitcnt lgkmcnt(4)
    ds_read_b128 v[232:235], v2 offset:16384
    v_permlane32_swap_b32 v220, v222
    v_mfma_f32_16x16x32_bf16 v[208:211], v[252:255], v[80:83], v[208:211]
    s_waitcnt lgkmcnt(4)
    ds_read_b128 v[252:255], v16 offset:3072
    v_permlane32_swap_b32 v221, v223
    v_mfma_f32_16x16x32_bf16 v[184:187], v[236:239], v[128:131], v[184:187]
    buffer_load_dwordx4 v1, s[8:11], s57 offen offset:1024 sc1 lds
    v_add_f32 v212, v212, v216
    v_mfma_f32_16x16x32_bf16 v[188:191], v[236:239], v[132:135], v[188:191]
    ds_read_b128 v[236:239], v2 offset:17408
    v_add_f32 v213, v213, v217
    v_mfma_f32_16x16x32_bf16 v[192:195], v[128:131], v[240:243], v[192:195]
    v_add_f32 v220, v220, v222
    v_add_f32 v221, v221, v223
    v_mfma_f32_16x16x32_bf16 v[196:199], v[132:135], v[240:243], v[196:199]
    s_waitcnt lgkmcnt(4)
    ds_read_b128 v[240:243], v2 offset:18432
    ds_read_b128 v[116:119], v18 offset:30720
    v_mfma_f32_16x16x32_bf16 v[208:211], v[36:39], v[84:87], v[208:211]
    ds_read_b128 v[36:39], v16 offset:3584
    v_permlane16_swap_b32 v212, v220
    v_mfma_f32_16x16x32_bf16 v[200:203], v[128:131], v[244:247], v[200:203]
    buffer_load_dwordx4 v1, s[8:11], s57 offen offset:2048 sc1 lds
    v_permlane16_swap_b32 v213, v221
    v_mfma_f32_16x16x32_bf16 v[204:207], v[132:135], v[244:247], v[204:207]
    s_waitcnt vmcnt(12) lgkmcnt(5)
    ds_read_b128 v[244:247], v2 offset:19456
    v_add_f32 v212, v212, v220
    v_mfma_f32_16x16x32_bf16 v[160:163], v[224:227], v[136:139], v[160:163]
    buffer_load_dwordx4 v1, s[8:11], s57 offen offset:3072 sc1 lds
    v_add_f32 v213, v213, v221
    v_mfma_f32_16x16x32_bf16 v[164:167], v[224:227], v[140:143], v[164:167]
    s_waitcnt lgkmcnt(5)
    ds_read_b128 v[224:227], v2 offset:20480
    v_mul_f32 v212, 0x3b000000, v212
    v_mfma_f32_16x16x32_bf16 v[208:211], v[252:255], v[88:91], v[208:211]
    ds_read_b128 v[252:255], v16 offset:4096
    v_mul_f32 v214, v212, v212
    v_mfma_f32_16x16x32_bf16 v[168:171], v[228:231], v[136:139], v[168:171]
    v_mul_f32 v213, 0x3b000000, v213
    v_sub_f32 v213, v213, v214
    v_mfma_f32_16x16x32_bf16 v[172:175], v[228:231], v[140:143], v[172:175]
    s_add_u32 s57, s37, 32768
    ds_read_b128 v[228:231], v2 offset:21504
    ds_read_b128 v[120:123], v18 offset:36864
    v_mfma_f32_16x16x32_bf16 v[176:179], v[232:235], v[136:139], v[176:179]
    s_add_u32 m0, s97, 0
    v_max_f32 v213, 0, v213
    v_cvt_pk_bf16_f32 v213, v213, v213
    v_mfma_f32_16x16x32_bf16 v[180:183], v[232:235], v[140:143], v[180:183]
    s_waitcnt lgkmcnt(5)
    ds_read_b128 v[232:235], v2 offset:22528
    v_lshlrev_b32 v213, 16, v213
    v_mfma_f32_16x16x32_bf16 v[208:211], v[36:39], v[92:95], v[208:211]
    s_waitcnt lgkmcnt(5)
    ds_read_b128 v[36:39], v16 offset:4608
    buffer_load_dwordx4 v1, s[8:11], s57 offen offset:0 sc1 lds
    v_mfma_f32_16x16x32_bf16 v[184:187], v[236:239], v[136:139], v[184:187]
    v_add_f32 v213, 0x3727c5ac, v213
    v_cvt_pk_bf16_f32 v213, v213, v213
    v_mfma_f32_16x16x32_bf16 v[188:191], v[236:239], v[140:143], v[188:191]
    ds_read_b128 v[236:239], v2 offset:23552
    v_lshlrev_b32 v213, 16, v213
    v_mfma_f32_16x16x32_bf16 v[192:195], v[136:139], v[240:243], v[192:195]
    buffer_load_dwordx4 v1, s[8:11], s57 offen offset:1024 sc1 lds
    v_mfma_f32_16x16x32_bf16 v[196:199], v[140:143], v[240:243], v[196:199]
    s_waitcnt lgkmcnt(5)
    ds_read_b128 v[240:243], v2 offset:24576
    v_sqrt_f32 v213, v213
    v_mfma_f32_16x16x32_bf16 v[208:211], v[252:255], v[96:99], v[208:211]
    ds_read_b128 v[252:255], v16 offset:5120
    v_cvt_pk_bf16_f32 v213, v213, v213
    v_mfma_f32_16x16x32_bf16 v[200:203], v[136:139], v[244:247], v[200:203]
    v_lshlrev_b32 v213, 16, v213
    v_mfma_f32_16x16x32_bf16 v[204:207], v[140:143], v[244:247], v[204:207]
    s_waitcnt lgkmcnt(3)
    ds_read_b128 v[244:247], v2 offset:25600
    v_rcp_f32 v213, v213
    v_mfma_f32_16x16x32_bf16 v[208:211], v[36:39], v[100:103], v[208:211]
    s_waitcnt vmcnt(13)
    ds_read_b128 v[36:39], v16 offset:5632
    v_cvt_pk_bf16_f32 v212, -v212, -v212
    v_mfma_f32_16x16x32_bf16 v[160:163], v[224:227], v[144:147], v[160:163]
    buffer_load_dwordx4 v1, s[8:11], s57 offen offset:2048 sc1 lds
    v_add_u32 v19, s48, v6
    v_mfma_f32_16x16x32_bf16 v[164:167], v[224:227], v[148:151], v[164:167]
    ds_read_b128 v[224:227], v2 offset:26624
    v_and_or_b32 v30, v6, 63, s48
    v_mfma_f32_16x16x32_bf16 v[168:171], v[228:231], v[144:147], v[168:171]
    buffer_load_dwordx4 v1, s[8:11], s57 offen offset:3072 sc1 lds
    v_and_or_b32 v31, v0, 48, s48
    v_mfma_f32_16x16x32_bf16 v[172:175], v[228:231], v[148:151], v[172:175]
    s_waitcnt lgkmcnt(3)
    ds_read_b128 v[228:231], v2 offset:27648
    ds_write2st64_b32 v19, v213, v212 offset0:0 offset1:1
    v_mfma_f32_16x16x32_bf16 v[208:211], v[252:255], v[104:107], v[208:211]
    ds_read_b128 v[252:255], v16 offset:6144
    ds_read2_b32 v[20:21], v30 offset0:64 offset1:64
    v_mfma_f32_16x16x32_bf16 v[176:179], v[232:235], v[144:147], v[176:179]
    s_add_u32 s57, s37, 49152
    s_add_u32 m0, s97, 16384
    ds_read2_b32 v[22:23], v30 offset0:96 offset1:96
    v_mfma_f32_16x16x32_bf16 v[180:183], v[232:235], v[148:151], v[180:183]
    s_waitcnt lgkmcnt(7)
    ds_read_b128 v[232:235], v2 offset:28672
    ds_read2_b32 v[24:25], v30 offset0:80 offset1:80
    v_mfma_f32_16x16x32_bf16 v[184:187], v[236:239], v[144:147], v[184:187]
    buffer_load_dwordx4 v1, s[8:11], s57 offen offset:0 sc1 lds
    ds_read2_b32 v[26:27], v30 offset0:0 offset1:32
    v_mfma_f32_16x16x32_bf16 v[188:191], v[236:239], v[148:151], v[188:191]
    s_waitcnt lgkmcnt(9)
    ds_read_b128 v[236:239], v2 offset:29696
    ds_read_b128 v[212:215], v31 offset:0
    v_mfma_f32_16x16x32_bf16 v[208:211], v[36:39], v[108:111], v[208:211]
    ds_read_b128 v[36:39], v16 offset:6656
    ds_read_b128 v[216:219], v31 offset:128
    v_mfma_f32_16x16x32_bf16 v[192:195], v[144:147], v[240:243], v[192:195]
    ds_read_b128 v[220:223], v31 offset:64
    v_mfma_f32_16x16x32_bf16 v[196:199], v[148:151], v[240:243], v[196:199]
    ds_read_b128 v[240:243], v2 offset:30720
    s_waitcnt lgkmcnt(14)
    ds_read_b128 v[124:127], v18 offset:43008
    v_mfma_f32_16x16x32_bf16 v[200:203], v[144:147], v[244:247], v[200:203]
    buffer_load_dwordx4 v1, s[8:11], s57 offen offset:1024 sc1 lds
    v_mfma_f32_16x16x32_bf16 v[204:207], v[148:151], v[244:247], v[204:207]
    s_waitcnt lgkmcnt(12)
    ds_read_b128 v[244:247], v2 offset:31744
    v_mfma_f32_16x16x32_bf16 v[208:211], v[252:255], v[112:115], v[208:211]
    s_waitcnt vmcnt(15) lgkmcnt(10)
    ds_read_b128 v[252:255], v16 offset:7168
    v_mfma_f32_16x16x32_bf16 v[160:163], v[224:227], v[152:155], v[160:163]
    buffer_load_dwordx4 v1, s[8:11], s57 offen offset:2048 sc1 lds
    v_mfma_f32_16x16x32_bf16 v[164:167], v[224:227], v[156:159], v[164:167]
    ds_read2st64_b32 v[224:225], v61 offset0:0 offset1:1
    v_mfma_f32_16x16x32_bf16 v[168:171], v[228:231], v[152:155], v[168:171]
    v_mfma_f32_16x16x32_bf16 v[172:175], v[228:231], v[156:159], v[172:175]
    s_waitcnt lgkmcnt(7)
    ds_read2st64_b32 v[228:229], v61 offset0:2 offset1:3
    v_mfma_f32_16x16x32_bf16 v[208:211], v[36:39], v[116:119], v[208:211]
    ds_read_b128 v[36:39], v16 offset:7680
    v_mfma_f32_16x16x32_bf16 v[176:179], v[232:235], v[152:155], v[176:179]
    buffer_load_dwordx4 v1, s[8:11], s57 offen offset:3072 sc1 lds
    v_mfma_f32_16x16x32_bf16 v[180:183], v[232:235], v[156:159], v[180:183]
    s_waitcnt lgkmcnt(4)
    ds_read2st64_b32 v[232:233], v61 offset0:4 offset1:5
    v_mfma_f32_16x16x32_bf16 v[184:187], v[236:239], v[152:155], v[184:187]
    v_mfma_f32_16x16x32_bf16 v[188:191], v[236:239], v[156:159], v[188:191]
    s_waitcnt lgkmcnt(4)
    ds_read2st64_b32 v[236:237], v61 offset0:6 offset1:7
    s_add_u32 s57, s99, 0
    v_mfma_f32_16x16x32_bf16 v[208:211], v[252:255], v[120:123], v[208:211]
    s_add_u32 m0, s97, 32768
    ds_read2st64_b32 v[248:249], v62 offset0:4 offset1:5
    v_mfma_f32_16x16x32_bf16 v[192:195], v[152:155], v[240:243], v[192:195]
    buffer_load_dwordx4 v1, s[8:11], s57 offen offset:0 sc1 lds
    v_mfma_f32_16x16x32_bf16 v[196:199], v[156:159], v[240:243], v[196:199]
    ds_read2st64_b32 v[240:241], v61 offset0:8 offset1:9
    v_mfma_f32_16x16x32_bf16 v[200:203], v[152:155], v[244:247], v[200:203]
    v_mfma_f32_16x16x32_bf16 v[204:207], v[156:159], v[244:247], v[204:207]
    s_waitcnt lgkmcnt(4)
    ds_read2st64_b32 v[244:245], v61 offset0:10 offset1:11
    v_mfma_f32_16x16x32_bf16 v[208:211], v[36:39], v[124:127], v[208:211]
    s_waitcnt lgkmcnt(2)
    buffer_load_dwordx4 v1, s[8:11], s57 offen offset:1024 sc1 lds
    s_nop 3
    v_mfma_f32_16x16x16_bf16 v[208:211], v[24:25], v[248:249], v[208:211]
    v_mul_f32 v28, 0x3eb8aa3b, v26
    v_mul_f32 v29, 0x3eb8aa3b, v27
    v_mfma_f32_16x16x16_bf16 v[160:163], v[224:225], v[20:21], v[160:163]
    v_mfma_f32_16x16x16_bf16 v[164:167], v[224:225], v[22:23], v[164:167]
    v_mfma_f32_16x16x16_bf16 v[168:171], v[228:229], v[20:21], v[168:171]
    buffer_load_dwordx4 v1, s[8:11], s57 offen offset:2048 sc1 lds
    v_mfma_f32_16x16x16_bf16 v[172:175], v[228:229], v[22:23], v[172:175]
    v_mfma_f32_16x16x16_bf16 v[176:179], v[232:233], v[20:21], v[176:179]
    v_mul_f32 v208, v208, v220
    v_mul_f32 v209, v209, v221
    v_mfma_f32_16x16x16_bf16 v[180:183], v[232:233], v[22:23], v[180:183]
    s_waitcnt lgkmcnt(0)
    v_mul_f32 v210, v210, v222
    v_mul_f32 v211, v211, v223
    v_mfma_f32_16x16x16_bf16 v[184:187], v[236:237], v[20:21], v[184:187]
    buffer_load_dwordx4 v1, s[8:11], s57 offen offset:3072 sc1 lds
    v_mfma_f32_16x16x16_bf16 v[188:191], v[236:237], v[22:23], v[188:191]
    v_cvt_pk_bf16_f32 v16, v208, v209
    v_cvt_pk_bf16_f32 v17, v210, v211
    v_mfma_f32_16x16x16_bf16 v[192:195], v[20:21], v[240:241], v[192:195]
    ds_write_b16 v56, v16
    v_cvt_pk_bf16_f32 v128, v160, v161
    v_mfma_f32_16x16x16_bf16 v[196:199], v[22:23], v[240:241], v[196:199]
    v_cvt_pk_bf16_f32 v129, v162, v163
    ds_write_b16_d16_hi v57, v16
    v_mfma_f32_16x16x16_bf16 v[200:203], v[20:21], v[244:245], v[200:203]
    v_cvt_pk_bf16_f32 v130, v164, v165
    v_cvt_pk_bf16_f32 v131, v166, v167
    v_mfma_f32_16x16x16_bf16 v[204:207], v[22:23], v[244:245], v[204:207]
    ds_write_b16 v58, v17
    v_cvt_pk_bf16_f32 v132, v168, v169
    v_cvt_pk_bf16_f32 v133, v170, v171
    ds_write_b16_d16_hi v59, v17
    v_cvt_pk_bf16_f32 v134, v172, v173
    v_cvt_pk_bf16_f32 v135, v174, v175
    s_add_u32 s57, s99, 16384
    s_add_u32 m0, s97, 49152
    s_nop 0
    buffer_load_dwordx4 v1, s[8:11], s57 offen offset:0 sc1 lds
    v_pk_mul_f32 v[180:181], v[180:181], v[26:27] op_sel:[0,1] op_sel_hi:[1,1]
    v_pk_mul_f32 v[182:183], v[182:183], v[26:27] op_sel:[0,1] op_sel_hi:[1,1]
    v_cvt_pk_bf16_f32 v140, v180, v181
    v_cvt_pk_bf16_f32 v141, v182, v183
    ds_write_b64 v60, v[140:141] offset:2048
    v_pk_mul_f32 v[176:177], v[176:177], v[26:27] op_sel:[0,0] op_sel_hi:[1,0]
    v_pk_mul_f32 v[178:179], v[178:179], v[26:27] op_sel:[0,0] op_sel_hi:[1,0]
    v_pk_mul_f32 v[188:189], v[188:189], v[26:27] op_sel:[0,1] op_sel_hi:[1,1]
    v_pk_mul_f32 v[190:191], v[190:191], v[26:27] op_sel:[0,1] op_sel_hi:[1,1]
    v_cvt_pk_bf16_f32 v146, v188, v189
    v_cvt_pk_bf16_f32 v147, v190, v191
    ds_write_b64 v60, v[146:147] offset:2560
    v_pk_mul_f32 v[184:185], v[184:185], v[26:27] op_sel:[0,0] op_sel_hi:[1,0]
    v_pk_mul_f32 v[186:187], v[186:187], v[26:27] op_sel:[0,0] op_sel_hi:[1,0]
    buffer_load_dwordx4 v1, s[8:11], s57 offen offset:1024 sc1 lds
    v_pk_mul_f32 v[196:197], v[196:197], v[216:217]
    v_pk_mul_f32 v[198:199], v[198:199], v[218:219]
    v_cvt_pk_bf16_f32 v152, v196, v197
    v_cvt_pk_bf16_f32 v153, v198, v199
    ds_write_b64 v60, v[152:153] offset:3072
    v_pk_mul_f32 v[192:193], v[192:193], v[212:213]
    v_pk_mul_f32 v[194:195], v[194:195], v[214:215]
    v_pk_mul_f32 v[204:205], v[204:205], v[216:217]
    v_pk_mul_f32 v[206:207], v[206:207], v[218:219]
    v_cvt_pk_bf16_f32 v158, v204, v205
    v_cvt_pk_bf16_f32 v159, v206, v207
    ds_write_b64 v60, v[158:159] offset:3584
    v_pk_mul_f32 v[200:201], v[200:201], v[212:213]
    v_pk_mul_f32 v[202:203], v[202:203], v[214:215]
    buffer_load_dwordx4 v1, s[8:11], s57 offen offset:2048 sc1 lds
    v_mfma_f32_16x16x16_bf16 v[224:227], v[140:141], v[130:131], v[40:43]
    v_cvt_pk_bf16_f32 v138, v176, v177
    v_cvt_pk_bf16_f32 v139, v178, v179
    v_mfma_f32_16x16x16_bf16 v[232:235], v[146:147], v[134:135], v[40:43]
    v_cvt_pk_bf16_f32 v144, v184, v185
    v_cvt_pk_bf16_f32 v145, v186, v187
    v_mfma_f32_16x16x16_bf16 v[228:231], v[138:139], v[130:131], v[44:47]
    s_waitcnt vmcnt(20)
    s_waitcnt vmcnt(15)
    s_waitcnt lgkmcnt(0)
    s_barrier
    v_mfma_f32_16x16x16_bf16 v[236:239], v[144:145], v[134:135], v[44:47]
    ds_read_b64 v[136:137], v60 offset:0
    ds_read_b64 v[142:143], v60 offset:512
    v_mfma_f32_16x16x16_bf16 v[240:243], v[138:139], v[128:129], v[40:43]
    buffer_load_dwordx4 v1, s[8:11], s57 offen offset:3072 sc1 lds
    ds_read_b64 v[148:149], v60 offset:1024
    ds_read_b64 v[154:155], v60 offset:1536
    v_mfma_f32_16x16x16_bf16 v[248:251], v[144:145], v[132:133], v[40:43]
    v_cvt_pk_bf16_f32 v150, v192, v193
    v_cvt_pk_bf16_f32 v151, v194, v195
    v_cvt_pk_bf16_f32 v156, v200, v201
    v_cvt_pk_bf16_f32 v157, v202, v203
    v_max_f32 v224, v224, v228
    v_max_f32 v225, v225, v229
    v_max_f32 v226, v226, v230
    v_max_f32 v227, v227, v231
    v_max3_f32 v160, v224, v225, v226
    v_max_f32 v160, v160, v227
    s_waitcnt lgkmcnt(2)
    s_add_u32 s57, s99, 32768
    s_add_u32 m0, s97, 65536
    s_nop 0
    buffer_load_dwordx4 v1, s[8:11], s57 offen offset:0 sc1 lds
    v_mfma_f32_16x16x16_bf16 v[244:247], v[136:137], v[128:129], v[48:51]
    v_max_f32 v232, v232, v236
    v_max_f32 v233, v233, v237
    v_mfma_f32_16x16x16_bf16 v[252:255], v[142:143], v[132:133], v[48:51]
    v_max_f32 v234, v234, v238
    v_max_f32 v235, v235, v239
    v_max3_f32 v161, v232, v233, v234
    v_max_f32 v161, v161, v235
    s_add_u32 s60, s31, 262144
    v_max_f32 v240, v240, v244
    v_max_f32 v241, v241, v245
    v_permlane32_swap_b32 v160, v161
    v_max_f32 v242, v242, v246
    v_max_f32 v243, v243, v247
    buffer_load_dwordx4 v1, s[8:11], s57 offen offset:1024 sc1 lds
    v_max3_f32 v162, v240, v241, v242
    v_max_f32 v162, v162, v243
    v_max_f32 v248, v248, v252
    v_max_f32 v249, v249, v253
    v_max_f32 v250, v250, v254
    v_max_f32 v251, v251, v255
    v_max3_f32 v163, v248, v249, v250
    v_max_f32 v163, v163, v251
    v_max_f32 v160, v160, v161
    s_nop 0
    v_permlane32_swap_b32 v162, v163
    v_max_f32 v162, v162, v163
    s_nop 1
    v_permlane16_swap_b32 v160, v162
    v_max_f32 v161, v160, v162
    v_max_f32 v162, v160, v162
    buffer_load_dwordx4 v1, s[8:11], s57 offen offset:2048 sc1 lds
    s_nop 0
    v_permlane16_swap_b32 v161, v162
    v_mul_f32 v160, v161, v29
    v_mul_f32 v161, v161, v29
    v_mul_f32 v163, v162, v28
    v_mul_f32 v162, v162, v28
    v_permlane32_swap_b32 v160, v161
    v_pk_fma_f32 v[224:225], v[224:225], v[28:29], v[160:161] op_sel:[0,1,0] op_sel_hi:[1,1,0] neg_lo:[0,0,1] neg_hi:[0,0,1]
    v_pk_fma_f32 v[226:227], v[226:227], v[28:29], v[160:161] op_sel:[0,1,0] op_sel_hi:[1,1,0] neg_lo:[0,0,1] neg_hi:[0,0,1]
    v_permlane32_swap_b32 v162, v163
    v_pk_fma_f32 v[232:233], v[232:233], v[28:29], v[160:161] op_sel:[0,1,1] op_sel_hi:[1,1,1] neg_lo:[0,0,1] neg_hi:[0,0,1]
    v_pk_fma_f32 v[234:235], v[234:235], v[28:29], v[160:161] op_sel:[0,1,1] op_sel_hi:[1,1,1] neg_lo:[0,0,1] neg_hi:[0,0,1]
    v_pk_fma_f32 v[240:241], v[240:241], v[28:29], v[162:163] op_sel:[0,0,0] op_sel_hi:[1,0,0] neg_lo:[0,0,1] neg_hi:[0,0,1]
    v_pk_fma_f32 v[242:243], v[242:243], v[28:29], v[162:163] op_sel:[0,0,0] op_sel_hi:[1,0,0] neg_lo:[0,0,1] neg_hi:[0,0,1]
    v_pk_fma_f32 v[248:249], v[248:249], v[28:29], v[162:163] op_sel:[0,0,1] op_sel_hi:[1,0,1] neg_lo:[0,0,1] neg_hi:[0,0,1]
    buffer_load_dwordx4 v1, s[8:11], s57 offen offset:3072 sc1 lds
    v_pk_fma_f32 v[250:251], v[250:251], v[28:29], v[162:163] op_sel:[0,0,1] op_sel_hi:[1,0,1] neg_lo:[0,0,1] neg_hi:[0,0,1]
    v_exp_f32 v224, v224
    v_exp_f32 v225, v225
    v_exp_f32 v226, v226
    v_exp_f32 v227, v227
    v_cvt_pk_bf16_f32 v164, v224, v225
    v_cvt_pk_bf16_f32 v165, v226, v227
    v_bfi_b32 v172, v52, 0, v164
    v_and_b32 v174, v52, v164
    v_bfi_b32 v173, v53, 0, v165
    v_and_b32 v175, v53, v165
    v_mfma_f32_16x16x16_bf16 v[228:231], v[54:55], v[164:165], 0
    v_exp_f32 v232, v232
    v_exp_f32 v233, v233
    v_mfma_f32_16x16x32_bf16 v[224:227], v[150:153], v[172:175], 0
    v_exp_f32 v234, v234
    v_exp_f32 v235, v235
    v_cvt_pk_bf16_f32 v166, v232, v233
    v_cvt_pk_bf16_f32 v167, v234, v235
    v_bfi_b32 v176, v52, 0, v166
    v_and_b32 v178, v52, v166
    v_bfi_b32 v177, v53, 0, v167
    v_and_b32 v179, v53, v167
    v_mfma_f32_16x16x16_bf16 v[236:239], v[54:55], v[166:167], 0
    v_exp_f32 v240, v240
    v_exp_f32 v241, v241
    v_mfma_f32_16x16x32_bf16 v[232:235], v[156:159], v[176:179], 0
    v_exp_f32 v242, v242
    v_exp_f32 v243, v243
    s_waitcnt lgkmcnt(0)
    v_rcp_f32 v228, v228
    v_cvt_pk_bf16_f32 v168, v240, v241
    v_cvt_pk_bf16_f32 v169, v242, v243
    v_bfi_b32 v180, v52, 0, v168
    v_and_b32 v182, v52, v168
    v_bfi_b32 v181, v53, 0, v169
    v_and_b32 v183, v53, v169
    v_mfma_f32_16x16x16_bf16 v[244:247], v[54:55], v[168:169], 0
    v_exp_f32 v248, v248
    v_exp_f32 v249, v249
    v_mfma_f32_16x16x32_bf16 v[240:243], v[148:151], v[180:183], 0
    v_exp_f32 v250, v250
    v_exp_f32 v251, v251
    v_rcp_f32 v236, v236
    v_cvt_pk_bf16_f32 v170, v248, v249
    v_cvt_pk_bf16_f32 v171, v250, v251
    v_bfi_b32 v184, v52, 0, v170
    v_and_b32 v186, v52, v170
    v_bfi_b32 v185, v53, 0, v171
    v_and_b32 v187, v53, v171
    v_mfma_f32_16x16x16_bf16 v[252:255], v[54:55], v[170:171], 0
    v_rcp_f32 v244, v244
    v_mfma_f32_16x16x32_bf16 v[248:251], v[154:157], v[184:187], 0
    v_mul_f32 v224, v224, v228
    v_mul_f32 v225, v225, v228
    v_mul_f32 v226, v226, v228
    v_mul_f32 v227, v227, v228
    v_cvt_pk_bf16_f32 v192, v224, v225
    v_cvt_pk_bf16_f32 v193, v226, v227
    v_pk_mul_f32 v[232:233], v[232:233], v[236:237] op_sel_hi:[1,0]
    v_pk_mul_f32 v[234:235], v[234:235], v[236:237] op_sel_hi:[1,0]
    v_cvt_pk_bf16_f32 v194, v232, v233
    v_cvt_pk_bf16_f32 v195, v234, v235
    buffer_store_dwordx4 v[192:195], v4, s[8:11], s60 offen offset:256
    v_rcp_f32 v252, v252
    v_pk_mul_f32 v[240:241], v[240:241], v[244:245] op_sel_hi:[1,0]
    v_pk_mul_f32 v[242:243], v[242:243], v[244:245] op_sel_hi:[1,0]
    v_cvt_pk_bf16_f32 v188, v240, v241
    v_cvt_pk_bf16_f32 v189, v242, v243
    v_pk_mul_f32 v[248:249], v[248:249], v[252:253] op_sel_hi:[1,0]
    v_pk_mul_f32 v[250:251], v[250:251], v[252:253] op_sel_hi:[1,0]
    v_cvt_pk_bf16_f32 v190, v248, v249
    v_cvt_pk_bf16_f32 v191, v250, v251
    buffer_store_dwordx4 v[188:191], v4, s[8:11], s60 offen offset:0
    ds_read_b128 v[32:35], v3 offset:0
    ds_read_b128 v[36:39], v3 offset:1024
    ds_read_b128 v[40:43], v3 offset:2048
    ds_read_b128 v[44:47], v3 offset:3072
    ds_read_b128 v[48:51], v3 offset:4096
    ds_read_b128 v[52:55], v3 offset:5120
    ds_read_b128 v[56:59], v3 offset:6144
    ds_read_b128 v[60:63], v3 offset:7168
    ds_read_b128 v[64:67], v3 offset:8192
    ds_read_b128 v[68:71], v3 offset:9216
    ds_read_b128 v[72:75], v3 offset:10240
    ds_read_b128 v[76:79], v3 offset:11264
    ds_read_b128 v[80:83], v3 offset:12288
    ds_read_b128 v[84:87], v3 offset:13312
    ds_read_b128 v[88:91], v3 offset:14336
    s_waitcnt lgkmcnt(14)
    ds_read_b128 v[92:95], v3 offset:15360
    s_waitcnt lgkmcnt(14)
    ds_read_b128 v[176:179], v3 offset:16384
    s_waitcnt lgkmcnt(14)
    ds_read_b128 v[180:183], v3 offset:17408
    s_waitcnt lgkmcnt(14)
    ds_read_b128 v[184:187], v3 offset:18432
    s_waitcnt lgkmcnt(14)
    ds_read_b128 v[188:191], v3 offset:19456
    s_add_u32 s12, s26, 7
    v_mov_b32 v30, s12
    s_cmp_lg_u32 s27, 0
    s_waitcnt vmcnt(0)
    s_cbranch_scc1 L_slow_53
    buffer_store_dword v30, v5, s[8:11], s45 offen
L_sig_54:
L_wo1:
    v_lshlrev_b32 v160, 16, v8
    v_and_b32 v161, 0xffff0000, v8
    v_lshlrev_b32 v162, 16, v9
    v_and_b32 v163, 0xffff0000, v9
    v_lshlrev_b32 v164, 16, v10
    v_and_b32 v165, 0xffff0000, v10
    v_lshlrev_b32 v166, 16, v11
    v_and_b32 v167, 0xffff0000, v11
    v_lshlrev_b32 v168, 16, v12
    v_and_b32 v169, 0xffff0000, v12
    v_lshlrev_b32 v170, 16, v13
    v_and_b32 v171, 0xffff0000, v13
    v_lshlrev_b32 v172, 16, v14
    v_and_b32 v173, 0xffff0000, v14
    v_lshlrev_b32 v174, 16, v15
    v_and_b32 v175, 0xffff0000, v15
    s_mov_b32 s63, 0x40000
    s_cmp_lg_u32 s27, 0
    s_cbranch_scc1 L_far_55
L_poll_57:
    buffer_load_dword v22, v6, s[8:11], s44 offen nt
    s_sub_u32 s63, s63, 1
    s_cbranch_scc1 L_main_done
    s_waitcnt vmcnt(0)
    v_subrev_u32 v22, s12, v22
    v_cmp_lt_u32 vcc, 15, v22
    s_nop 0
    s_and_b64 vcc, vcc, s[66:67]
    s_cbranch_scc1 L_poll_57
L_ok_56:
    s_add_u32 s56, s64, 262144
    buffer_load_dwordx4 v[96:99], v4, s[8:11], s56 offen offset:0 sc1
    buffer_load_dwordx4 v[100:103], v4, s[8:11], s56 offen offset:2048 sc1
    s_add_u32 s56, s64, 266240
    buffer_load_dwordx4 v[104:107], v4, s[8:11], s56 offen offset:0 sc1
    buffer_load_dwordx4 v[108:111], v4, s[8:11], s56 offen offset:2048 sc1
    s_waitcnt lgkmcnt(14)
    ds_read_b128 v[192:195], v3 offset:20480
    s_waitcnt lgkmcnt(14)
    ds_read_b128 v[196:199], v3 offset:21504
    s_waitcnt lgkmcnt(14)
    ds_read_b128 v[200:203], v3 offset:22528
    s_add_u32 s56, s64, 270336
    buffer_load_dwordx4 v[112:115], v4, s[8:11], s56 offen offset:0 sc1
    s_waitcnt lgkmcnt(14)
    ds_read_b128 v[204:207], v3 offset:23552
    s_waitcnt lgkmcnt(14)
    ds_read_b128 v[208:211], v3 offset:24576
    s_waitcnt lgkmcnt(14)
    ds_read_b128 v[212:215], v3 offset:25600
    buffer_load_dwordx4 v[116:119], v4, s[8:11], s56 offen offset:2048 sc1
    s_waitcnt lgkmcnt(14)
    ds_read_b128 v[216:219], v3 offset:26624
    s_waitcnt lgkmcnt(14)
    ds_read_b128 v[220:223], v3 offset:27648
    s_waitcnt lgkmcnt(14)
    ds_read_b128 v[224:227], v3 offset:28672
    s_add_u32 s56, s64, 274432
    buffer_load_dwordx4 v[120:123], v4, s[8:11], s56 offen offset:0 sc1
    s_waitcnt lgkmcnt(14)
    ds_read_b128 v[228:231], v3 offset:29696
    s_waitcnt lgkmcnt(14)
    ds_read_b128 v[232:235], v3 offset:30720
    s_waitcnt lgkmcnt(14)
    ds_read_b128 v[236:239], v3 offset:31744
    buffer_load_dwordx4 v[124:127], v4, s[8:11], s56 offen offset:2048 sc1
    s_barrier
    s_waitcnt lgkmcnt(14)
    ds_read_b128 v[240:243], v1 offset:0
    s_waitcnt lgkmcnt(14)
    ds_read_b128 v[244:247], v1 offset:1024
    s_waitcnt lgkmcnt(14)
    ds_read_b128 v[248:251], v1 offset:2048
    s_waitcnt lgkmcnt(14)
    ds_read_b128 v[252:255], v1 offset:3072
    s_waitcnt vmcnt(7)
    v_mfma_f32_16x16x32_bf16 v[160:163], v[32:35], v[96:99], v[160:163]
    s_add_u32 s56, s64, 278528
    buffer_load_dwordx4 v[128:131], v4, s[8:11], s56 offen offset:0 sc1
    v_mfma_f32_16x16x32_bf16 v[164:167], v[36:39], v[96:99], v[164:167]
    s_waitcnt lgkmcnt(14)
    ds_read_b128 v[32:35], v1 offset:4096
    s_waitcnt lgkmcnt(14)
    ds_read_b128 v[36:39], v1 offset:5120
    v_mfma_f32_16x16x32_bf16 v[168:171], v[40:43], v[96:99], v[168:171]
    s_waitcnt lgkmcnt(14)
    ds_read_b128 v[40:43], v1 offset:6144
    v_mfma_f32_16x16x32_bf16 v[172:175], v[44:47], v[96:99], v[172:175]
    s_waitcnt vmcnt(7)
    s_waitcnt lgkmcnt(14)
    ds_read_b128 v[44:47], v1 offset:7168
    v_mfma_f32_16x16x32_bf16 v[160:163], v[48:51], v[100:103], v[160:163]
    buffer_load_dwordx4 v[132:135], v4, s[8:11], s56 offen offset:2048 sc1
    v_mfma_f32_16x16x32_bf16 v[164:167], v[52:55], v[100:103], v[164:167]
    s_waitcnt lgkmcnt(14)
    ds_read_b128 v[48:51], v1 offset:8192
    s_waitcnt lgkmcnt(14)
    ds_read_b128 v[52:55], v1 offset:9216
    v_mfma_f32_16x16x32_bf16 v[168:171], v[56:59], v[100:103], v[168:171]
    s_waitcnt lgkmcnt(14)
    ds_read_b128 v[56:59], v1 offset:10240
    v_mfma_f32_16x16x32_bf16 v[172:175], v[60:63], v[100:103], v[172:175]
    s_waitcnt vmcnt(7)
    s_waitcnt lgkmcnt(14)
    ds_read_b128 v[60:63], v1 offset:11264
    v_mfma_f32_16x16x32_bf16 v[160:163], v[64:67], v[104:107], v[160:163]
    s_add_u32 s56, s64, 282624
    buffer_load_dwordx4 v[136:139], v4, s[8:11], s56 offen offset:0 sc1
    v_mfma_f32_16x16x32_bf16 v[164:167], v[68:71], v[104:107], v[164:167]
    s_waitcnt lgkmcnt(14)
    ds_read_b128 v[64:67], v1 offset:12288
    s_waitcnt lgkmcnt(14)
    ds_read_b128 v[68:71], v1 offset:13312
    v_mfma_f32_16x16x32_bf16 v[168:171], v[72:75], v[104:107], v[168:171]
    s_waitcnt lgkmcnt(14)
    ds_read_b128 v[72:75], v1 offset:14336
    v_mfma_f32_16x16x32_bf16 v[172:175], v[76:79], v[104:107], v[172:175]
    s_waitcnt vmcnt(7)
    s_waitcnt lgkmcnt(14)
    ds_read_b128 v[76:79], v1 offset:15360
    v_mfma_f32_16x16x32_bf16 v[160:163], v[80:83], v[108:111], v[160:163]
    buffer_load_dwordx4 v[140:143], v4, s[8:11], s56 offen offset:2048 sc1
    v_mfma_f32_16x16x32_bf16 v[164:167], v[84:87], v[108:111], v[164:167]
    s_waitcnt lgkmcnt(14)
    ds_read_b128 v[80:83], v1 offset:16384
    s_waitcnt lgkmcnt(14)
    ds_read_b128 v[84:87], v1 offset:17408
    v_mfma_f32_16x16x32_bf16 v[168:171], v[88:91], v[108:111], v[168:171]
    s_waitcnt lgkmcnt(14)
    ds_read_b128 v[88:91], v1 offset:18432
    v_mfma_f32_16x16x32_bf16 v[172:175], v[92:95], v[108:111], v[172:175]
    s_waitcnt vmcnt(7)
    s_waitcnt lgkmcnt(14)
    ds_read_b128 v[92:95], v1 offset:19456
    v_mfma_f32_16x16x32_bf16 v[160:163], v[176:179], v[112:115], v[160:163]
    s_add_u32 s56, s64, 286720
    buffer_load_dwordx4 v[144:147], v4, s[8:11], s56 offen offset:0 sc1
    v_mfma_f32_16x16x32_bf16 v[164:167], v[180:183], v[112:115], v[164:167]
    s_waitcnt lgkmcnt(14)
    ds_read_b128 v[176:179], v1 offset:20480
    s_waitcnt lgkmcnt(14)
    ds_read_b128 v[180:183], v1 offset:21504
    v_mfma_f32_16x16x32_bf16 v[168:171], v[184:187], v[112:115], v[168:171]
    s_waitcnt lgkmcnt(14)
    ds_read_b128 v[184:187], v1 offset:22528
    v_mfma_f32_16x16x32_bf16 v[172:175], v[188:191], v[112:115], v[172:175]
    s_waitcnt vmcnt(7)
    s_waitcnt lgkmcnt(14)
    ds_read_b128 v[188:191], v1 offset:23552
    v_mfma_f32_16x16x32_bf16 v[160:163], v[192:195], v[116:119], v[160:163]
    buffer_load_dwordx4 v[148:151], v4, s[8:11], s56 offen offset:2048 sc1
    v_mfma_f32_16x16x32_bf16 v[164:167], v[196:199], v[116:119], v[164:167]
    s_waitcnt lgkmcnt(14)
    ds_read_b128 v[192:195], v1 offset:24576
    s_waitcnt lgkmcnt(14)
    ds_read_b128 v[196:199], v1 offset:25600
    v_mfma_f32_16x16x32_bf16 v[168:171], v[200:203], v[116:119], v[168:171]
    s_waitcnt lgkmcnt(14)
    ds_read_b128 v[200:203], v1 offset:26624
    v_mfma_f32_16x16x32_bf16 v[172:175], v[204:207], v[116:119], v[172:175]
    s_waitcnt vmcnt(7)
    s_waitcnt lgkmcnt(14)
    ds_read_b128 v[204:207], v1 offset:27648
    v_mfma_f32_16x16x32_bf16 v[160:163], v[208:211], v[120:123], v[160:163]
    s_add_u32 s56, s64, 290816
    buffer_load_dwordx4 v[152:155], v4, s[8:11], s56 offen offset:0 sc1
    v_mfma_f32_16x16x32_bf16 v[164:167], v[212:215], v[120:123], v[164:167]
    s_waitcnt lgkmcnt(14)
    ds_read_b128 v[208:211], v1 offset:28672
    s_waitcnt lgkmcnt(14)
    ds_read_b128 v[212:215], v1 offset:29696
    v_mfma_f32_16x16x32_bf16 v[168:171], v[216:219], v[120:123], v[168:171]
    s_waitcnt lgkmcnt(14)
    ds_read_b128 v[216:219], v1 offset:30720
    v_mfma_f32_16x16x32_bf16 v[172:175], v[220:223], v[120:123], v[172:175]
    s_waitcnt vmcnt(7)
    s_waitcnt lgkmcnt(14)
    ds_read_b128 v[220:223], v1 offset:31744
    v_mfma_f32_16x16x32_bf16 v[160:163], v[224:227], v[124:127], v[160:163]
    buffer_load_dwordx4 v[156:159], v4, s[8:11], s56 offen offset:2048 sc1
    v_mfma_f32_16x16x32_bf16 v[164:167], v[228:231], v[124:127], v[164:167]
    v_mfma_f32_16x16x32_bf16 v[168:171], v[232:235], v[124:127], v[168:171]
    v_mfma_f32_16x16x32_bf16 v[172:175], v[236:239], v[124:127], v[172:175]
    s_waitcnt vmcnt(7)
    v_mfma_f32_16x16x32_bf16 v[160:163], v[240:243], v[128:131], v[160:163]
    v_mfma_f32_16x16x32_bf16 v[164:167], v[244:247], v[128:131], v[164:167]
    s_add_u32 s57, s99, 49152
    s_add_u32 m0, s97, 81920
    v_mfma_f32_16x16x32_bf16 v[168:171], v[248:251], v[128:131], v[168:171]
    buffer_load_dwordx4 v1, s[8:11], s57 offen offset:0 sc1 lds
    v_mfma_f32_16x16x32_bf16 v[172:175], v[252:255], v[128:131], v[172:175]
    s_waitcnt vmcnt(7)
    v_mfma_f32_16x16x32_bf16 v[160:163], v[32:35], v[132:135], v[160:163]
    v_mfma_f32_16x16x32_bf16 v[164:167], v[36:39], v[132:135], v[164:167]
    v_mfma_f32_16x16x32_bf16 v[168:171], v[40:43], v[132:135], v[168:171]
    buffer_load_dwordx4 v1, s[8:11], s57 offen offset:1024 sc1 lds
    v_mfma_f32_16x16x32_bf16 v[172:175], v[44:47], v[132:135], v[172:175]
    s_waitcnt vmcnt(7)
    v_mfma_f32_16x16x32_bf16 v[160:163], v[48:51], v[136:139], v[160:163]
    v_mfma_f32_16x16x32_bf16 v[164:167], v[52:55], v[136:139], v[164:167]
    v_mfma_f32_16x16x32_bf16 v[168:171], v[56:59], v[136:139], v[168:171]
    buffer_load_dwordx4 v1, s[8:11], s57 offen offset:2048 sc1 lds
    v_mfma_f32_16x16x32_bf16 v[172:175], v[60:63], v[136:139], v[172:175]
    s_waitcnt vmcnt(7)
    v_mfma_f32_16x16x32_bf16 v[160:163], v[64:67], v[140:143], v[160:163]
    v_mfma_f32_16x16x32_bf16 v[164:167], v[68:71], v[140:143], v[164:167]
    v_mfma_f32_16x16x32_bf16 v[168:171], v[72:75], v[140:143], v[168:171]
    v_mfma_f32_16x16x32_bf16 v[172:175], v[76:79], v[140:143], v[172:175]
    s_waitcnt vmcnt(6)
    buffer_load_dwordx4 v1, s[8:11], s57 offen offset:3072 sc1 lds
    v_mfma_f32_16x16x32_bf16 v[160:163], v[80:83], v[144:147], v[160:163]
    s_waitcnt lgkmcnt(14)
    v_mfma_f32_16x16x32_bf16 v[164:167], v[84:87], v[144:147], v[164:167]
    s_waitcnt lgkmcnt(13)
    v_mfma_f32_16x16x32_bf16 v[168:171], v[88:91], v[144:147], v[168:171]
    s_waitcnt lgkmcnt(12)
    v_mfma_f32_16x16x32_bf16 v[172:175], v[92:95], v[144:147], v[172:175]
    s_waitcnt vmcnt(6) lgkmcnt(11)
    v_mfma_f32_16x16x32_bf16 v[160:163], v[176:179], v[148:151], v[160:163]
    s_waitcnt lgkmcnt(10)
    v_mfma_f32_16x16x32_bf16 v[164:167], v[180:183], v[148:151], v[164:167]
    s_waitcnt lgkmcnt(9)
    v_mfma_f32_16x16x32_bf16 v[168:171], v[184:187], v[148:151], v[168:171]
    s_waitcnt lgkmcnt(8)
    v_mfma_f32_16x16x32_bf16 v[172:175], v[188:191], v[148:151], v[172:175]
    s_waitcnt vmcnt(5) lgkmcnt(7)
    v_mfma_f32_16x16x32_bf16 v[160:163], v[192:195], v[152:155], v[160:163]
    s_waitcnt lgkmcnt(6)
    v_mfma_f32_16x16x32_bf16 v[164:167], v[196:199], v[152:155], v[164:167]
    s_waitcnt lgkmcnt(5)
    v_mfma_f32_16x16x32_bf16 v[168:171], v[200:203], v[152:155], v[168:171]
    s_waitcnt lgkmcnt(4)
    v_mfma_f32_16x16x32_bf16 v[172:175], v[204:207], v[152:155], v[172:175]
    s_waitcnt vmcnt(4) lgkmcnt(3)
    v_mfma_f32_16x16x32_bf16 v[160:163], v[208:211], v[156:159], v[160:163]
    s_waitcnt lgkmcnt(2)
    v_mfma_f32_16x16x32_bf16 v[164:167], v[212:215], v[156:159], v[164:167]
    s_waitcnt lgkmcnt(1)
    v_mfma_f32_16x16x32_bf16 v[168:171], v[216:219], v[156:159], v[168:171]
    s_waitcnt lgkmcnt(0)
    v_mfma_f32_16x16x32_bf16 v[172:175], v[220:223], v[156:159], v[172:175]
    s_nop 1
    v_cvt_pk_bf16_f32 v8, v160, v161
    v_cvt_pk_bf16_f32 v9, v162, v163
    v_cvt_pk_bf16_f32 v10, v164, v165
    v_cvt_pk_bf16_f32 v11, v166, v167
    v_cvt_pk_bf16_f32 v12, v168, v169
    v_cvt_pk_bf16_f32 v13, v170, v171
    v_cvt_pk_bf16_f32 v14, v172, v173
    v_cvt_pk_bf16_f32 v15, v174, v175
    s_add_u32 s59, s30, 0
    buffer_store_dwordx4 v[8:11], v4, s[8:11], s59 offen offset:0
    buffer_store_dwordx4 v[12:15], v4, s[8:11], s59 offen offset:2048
    v_dot2_f32_bf16 v26, v8, s50, 0
    v_dot2_f32_bf16 v27, v8, v8, 0
    v_dot2_f32_bf16 v28, v12, s50, 0
    v_dot2_f32_bf16 v29, v12, v12, 0
    v_dot2_f32_bf16 v26, v9, s50, v26
    v_dot2_f32_bf16 v27, v9, v9, v27
    v_dot2_f32_bf16 v28, v13, s50, v28
    v_dot2_f32_bf16 v29, v13, v13, v29
    v_dot2_f32_bf16 v26, v10, s50, v26
    v_dot2_f32_bf16 v27, v10, v10, v27
    v_dot2_f32_bf16 v28, v14, s50, v28
    v_dot2_f32_bf16 v29, v14, v14, v29
    v_dot2_f32_bf16 v26, v11, s50, v26
    v_dot2_f32_bf16 v27, v11, v11, v27
    v_dot2_f32_bf16 v28, v15, s50, v28
    v_dot2_f32_bf16 v29, v15, v15, v29
    v_accvgpr_read_b32 v25, a225
    s_add_u32 s59, s49, 720896
    v_add_f32 v26, v26, v28
    v_add_f32 v27, v27, v29
    s_nop 1
    v_permlane32_swap_b32 v26, v27
    v_add_f32 v26, v26, v27
    v_mov_b32 v27, v26
    s_nop 1
    v_permlane16_swap_b32 v26, v27
    v_add_f32 v26, v26, v27
    buffer_store_dword v26, v25, s[8:11], s59 offen
    s_add_u32 s12, s26, 8
    v_mov_b32 v30, s12
    s_cmp_lg_u32 s27, 0
    s_waitcnt vmcnt(0)
    s_cbranch_scc1 L_slow_58
    buffer_store_dword v30, v5, s[8:11], s45 offen
L_sig_59:
    s_branch L_page_60
    .p2align 12
L_page_60:
L_gu1:
    s_barrier
    ds_read_b128 v[224:227], v1 offset:32768
    ds_read_b128 v[228:231], v1 offset:33792
    ds_read_b128 v[232:235], v1 offset:34816
    ds_read_b128 v[236:239], v1 offset:35840
    ds_read_b128 v[240:243], v1 offset:36864
    ds_read_b128 v[244:247], v1 offset:37888
    s_mov_b32 s63, 0x40000
    s_cmp_lg_u32 s27, 0
    s_cbranch_scc1 L_far_61
L_poll_63:
    buffer_load_dword v22, v6, s[8:11], s44 offen nt
    s_sub_u32 s63, s63, 1
    s_cbranch_scc1 L_main_done
    s_waitcnt vmcnt(0)
    v_subrev_u32 v22, s12, v22
    v_cmp_lt_u32 vcc, 15, v22
    s_nop 0
    s_and_b64 vcc, vcc, s[40:41]
    s_cbranch_scc1 L_poll_63
L_ok_62:
    s_add_u32 s56, s29, 0
    buffer_load_dwordx4 v[32:35], v4, s[8:11], s56 offen offset:0 sc1
    buffer_load_dwordx4 v[36:39], v4, s[8:11], s56 offen offset:256 sc1
    buffer_load_dwordx4 v[40:43], v4, s[8:11], s56 offen offset:2048 sc1
    buffer_load_dwordx4 v[44:47], v4, s[8:11], s56 offen offset:2304 sc1
    s_add_u32 s60, s34, 720896
    s_waitcnt vmcnt(3) lgkmcnt(4)
    v_mfma_f32_16x16x32_bf16 v[112:115], v[224:227], v[32:35], 0
    s_waitcnt vmcnt(2)
    s_add_u32 s56, s29, 4096
    v_mfma_f32_16x16x32_bf16 v[120:123], v[224:227], v[36:39], 0
    ds_read_b128 v[248:251], v1 offset:38912
    v_mfma_f32_16x16x32_bf16 v[116:119], v[228:231], v[32:35], 0
    buffer_load_dwordx4 v[48:51], v4, s[8:11], s56 offen offset:0 sc1
    v_mfma_f32_16x16x32_bf16 v[124:127], v[228:231], v[36:39], 0
    s_waitcnt lgkmcnt(3)
    ds_read_b128 v[252:255], v1 offset:39936
    v_mfma_f32_16x16x32_bf16 v[128:131], v[232:235], v[32:35], 0
    buffer_load_dwordx4 v[52:55], v4, s[8:11], s56 offen offset:256 sc1
    v_mfma_f32_16x16x32_bf16 v[136:139], v[232:235], v[36:39], 0
    ds_read_b128 v[224:227], v1 offset:40960
    v_mfma_f32_16x16x32_bf16 v[132:135], v[236:239], v[32:35], 0
    buffer_load_dwordx4 v[56:59], v4, s[8:11], s56 offen offset:2048 sc1
    v_mfma_f32_16x16x32_bf16 v[140:143], v[236:239], v[36:39], 0
    s_waitcnt lgkmcnt(3)
    ds_read_b128 v[228:231], v1 offset:41984
    v_mfma_f32_16x16x32_bf16 v[144:147], v[240:243], v[32:35], 0
    buffer_load_dwordx4 v[60:63], v4, s[8:11], s56 offen offset:2304 sc1
    v_mfma_f32_16x16x32_bf16 v[152:155], v[240:243], v[36:39], 0
    s_add_u32 s56, s29, 8192
    ds_read_b128 v[232:235], v1 offset:43008
    v_mfma_f32_16x16x32_bf16 v[148:151], v[244:247], v[32:35], 0
    buffer_load_dwordx4 v[64:67], v4, s[8:11], s56 offen offset:0 sc1
    v_mfma_f32_16x16x32_bf16 v[156:159], v[244:247], v[36:39], 0
    s_waitcnt lgkmcnt(3)
    ds_read_b128 v[236:239], v1 offset:44032
    v_mfma_f32_16x16x32_bf16 v[160:163], v[248:251], v[32:35], 0
    buffer_load_dwordx4 v[68:71], v4, s[8:11], s56 offen offset:256 sc1
    v_mfma_f32_16x16x32_bf16 v[168:171], v[248:251], v[36:39], 0
    ds_read_b128 v[240:243], v1 offset:45056
    v_mfma_f32_16x16x32_bf16 v[164:167], v[252:255], v[32:35], 0
    v_mfma_f32_16x16x32_bf16 v[172:175], v[252:255], v[36:39], 0
    s_waitcnt lgkmcnt(3)
    ds_read_b128 v[244:247], v1 offset:46080
    v_mfma_f32_16x16x32_bf16 v[176:179], v[224:227], v[32:35], 0
    v_mfma_f32_16x16x32_bf16 v[184:187], v[224:227], v[36:39], 0
    ds_read_b128 v[248:251], v1 offset:47104
    v_mfma_f32_16x16x32_bf16 v[180:183], v[228:231], v[32:35], 0
    buffer_load_dwordx4 v[16:19], v1, s[8:11], s60 offen sc1
    v_mfma_f32_16x16x32_bf16 v[188:191], v[228:231], v[36:39], 0
    s_waitcnt lgkmcnt(3)
    ds_read_b128 v[252:255], v1 offset:48128
    v_mfma_f32_16x16x32_bf16 v[192:195], v[232:235], v[32:35], 0
    v_mfma_f32_16x16x32_bf16 v[200:203], v[232:235], v[36:39], 0
    ds_read_b128 v[224:227], v1 offset:49152
    v_mfma_f32_16x16x32_bf16 v[196:199], v[236:239], v[32:35], 0
    buffer_load_dwordx4 v[20:23], v1, s[8:11], s60 offen offset:1024 sc1
    v_mfma_f32_16x16x32_bf16 v[204:207], v[236:239], v[36:39], 0
    s_waitcnt lgkmcnt(3)
    ds_read_b128 v[228:231], v1 offset:50176
    v_mfma_f32_16x16x32_bf16 v[208:211], v[240:243], v[32:35], 0
    buffer_load_dwordx4 v[72:75], v4, s[8:11], s56 offen offset:2048 sc1
    v_mfma_f32_16x16x32_bf16 v[216:219], v[240:243], v[36:39], 0
    ds_read_b128 v[232:235], v1 offset:51200
    v_mfma_f32_16x16x32_bf16 v[212:215], v[244:247], v[32:35], 0
    v_mfma_f32_16x16x32_bf16 v[220:223], v[244:247], v[36:39], 0
    s_waitcnt vmcnt(9) lgkmcnt(3)
    ds_read_b128 v[236:239], v1 offset:52224
    v_mfma_f32_16x16x32_bf16 v[112:115], v[248:251], v[40:43], v[112:115]
    buffer_load_dwordx4 v[76:79], v4, s[8:11], s56 offen offset:2304 sc1
    v_mfma_f32_16x16x32_bf16 v[120:123], v[248:251], v[44:47], v[120:123]
    ds_read_b128 v[240:243], v1 offset:53248
    v_mfma_f32_16x16x32_bf16 v[116:119], v[252:255], v[40:43], v[116:119]
    v_mfma_f32_16x16x32_bf16 v[124:127], v[252:255], v[44:47], v[124:127]
    s_waitcnt lgkmcnt(3)
    ds_read_b128 v[244:247], v1 offset:54272
    v_mfma_f32_16x16x32_bf16 v[128:131], v[224:227], v[40:43], v[128:131]
    s_add_u32 s57, s99, 65536
    s_add_u32 m0, s97, 98304
    v_mfma_f32_16x16x32_bf16 v[136:139], v[224:227], v[44:47], v[136:139]
    ds_read_b128 v[248:251], v1 offset:55296
    v_mfma_f32_16x16x32_bf16 v[132:135], v[228:231], v[40:43], v[132:135]
    buffer_load_dwordx4 v1, s[8:11], s57 offen offset:0 sc1 lds
    v_mfma_f32_16x16x32_bf16 v[140:143], v[228:231], v[44:47], v[140:143]
    s_waitcnt lgkmcnt(3)
    ds_read_b128 v[252:255], v1 offset:56320
    v_mfma_f32_16x16x32_bf16 v[144:147], v[232:235], v[40:43], v[144:147]
    v_mfma_f32_16x16x32_bf16 v[152:155], v[232:235], v[44:47], v[152:155]
    ds_read_b128 v[224:227], v1 offset:57344
    v_mfma_f32_16x16x32_bf16 v[148:151], v[236:239], v[40:43], v[148:151]
    buffer_load_dwordx4 v1, s[8:11], s57 offen offset:1024 sc1 lds
    v_mfma_f32_16x16x32_bf16 v[156:159], v[236:239], v[44:47], v[156:159]
    s_waitcnt lgkmcnt(3)
    ds_read_b128 v[228:231], v1 offset:58368
    v_mfma_f32_16x16x32_bf16 v[160:163], v[240:243], v[40:43], v[160:163]
    v_mfma_f32_16x16x32_bf16 v[168:171], v[240:243], v[44:47], v[168:171]
    s_add_u32 s56, s29, 12288
    ds_read_b128 v[232:235], v1 offset:59392
    v_mfma_f32_16x16x32_bf16 v[164:167], v[244:247], v[40:43], v[164:167]
    buffer_load_dwordx4 v[80:83], v4, s[8:11], s56 offen offset:0 sc1
    v_mfma_f32_16x16x32_bf16 v[172:175], v[244:247], v[44:47], v[172:175]
    s_waitcnt lgkmcnt(3)
    ds_read_b128 v[236:239], v1 offset:60416
    v_mfma_f32_16x16x32_bf16 v[176:179], v[248:251], v[40:43], v[176:179]
    v_mfma_f32_16x16x32_bf16 v[184:187], v[248:251], v[44:47], v[184:187]
    ds_read_b128 v[240:243], v1 offset:61440
    v_mfma_f32_16x16x32_bf16 v[180:183], v[252:255], v[40:43], v[180:183]
    buffer_load_dwordx4 v1, s[8:11], s57 offen offset:2048 sc1 lds
    v_mfma_f32_16x16x32_bf16 v[188:191], v[252:255], v[44:47], v[188:191]
    s_waitcnt lgkmcnt(3)
    ds_read_b128 v[244:247], v1 offset:62464
    v_mfma_f32_16x16x32_bf16 v[192:195], v[224:227], v[40:43], v[192:195]
    v_mfma_f32_16x16x32_bf16 v[200:203], v[224:227], v[44:47], v[200:203]
    ds_read_b128 v[248:251], v1 offset:63488
    v_mfma_f32_16x16x32_bf16 v[196:199], v[228:231], v[40:43], v[196:199]
    v_mfma_f32_16x16x32_bf16 v[204:207], v[228:231], v[44:47], v[204:207]
    s_waitcnt lgkmcnt(3)
    ds_read_b128 v[252:255], v1 offset:64512
    v_mfma_f32_16x16x32_bf16 v[208:211], v[232:235], v[40:43], v[208:211]
    buffer_load_dwordx4 v[84:87], v4, s[8:11], s56 offen offset:256 sc1
    v_mfma_f32_16x16x32_bf16 v[216:219], v[232:235], v[44:47], v[216:219]
    ds_read_b128 v[224:227], v2 offset:0
    v_mfma_f32_16x16x32_bf16 v[212:215], v[236:239], v[40:43], v[212:215]
    v_mfma_f32_16x16x32_bf16 v[220:223], v[236:239], v[44:47], v[220:223]
    s_waitcnt vmcnt(13) lgkmcnt(3)
    ds_read_b128 v[228:231], v2 offset:1024
    v_mfma_f32_16x16x32_bf16 v[112:115], v[240:243], v[48:51], v[112:115]
    buffer_load_dwordx4 v1, s[8:11], s57 offen offset:3072 sc1 lds
    v_mfma_f32_16x16x32_bf16 v[120:123], v[240:243], v[52:55], v[120:123]
    ds_read_b128 v[232:235], v2 offset:2048
    v_mfma_f32_16x16x32_bf16 v[116:119], v[244:247], v[48:51], v[116:119]
    v_mfma_f32_16x16x32_bf16 v[124:127], v[244:247], v[52:55], v[124:127]
    s_waitcnt lgkmcnt(3)
    ds_read_b128 v[236:239], v2 offset:3072
    v_mfma_f32_16x16x32_bf16 v[128:131], v[248:251], v[48:51], v[128:131]
    s_add_u32 s15, s13, L_gu1-L_pc+0
    s_min_u32 s15, s15, L_code_end-L_pc-4
    v_mov_b32 v28, s15
    v_mfma_f32_16x16x32_bf16 v[136:139], v[248:251], v[52:55], v[136:139]
    ds_read_b128 v[240:243], v2 offset:4096
    v_mfma_f32_16x16x32_bf16 v[132:135], v[252:255], v[48:51], v[132:135]
    buffer_load_dwordx4 v[88:91], v4, s[8:11], s56 offen offset:2048 sc1
    v_mfma_f32_16x16x32_bf16 v[140:143], v[252:255], v[52:55], v[140:143]
    s_waitcnt lgkmcnt(3)
    ds_read_b128 v[244:247], v2 offset:5120
    s_waitcnt vmcnt(9)
    v_mfma_f32_16x16x32_bf16 v[144:147], v[224:227], v[48:51], v[144:147]
    s_add_u32 s57, s99, 81920
    global_load_dword a255, v28, s[4:5]
    v_mfma_f32_16x16x32_bf16 v[152:155], v[224:227], v[52:55], v[152:155]
    s_add_u32 m0, s97, 114688
    ds_read_b128 v[248:251], v2 offset:6144
    v_mfma_f32_16x16x32_bf16 v[148:151], v[228:231], v[48:51], v[148:151]
    buffer_load_dwordx4 v1, s[8:11], s57 offen offset:0 sc1 lds
    v_mfma_f32_16x16x32_bf16 v[156:159], v[228:231], v[52:55], v[156:159]
    s_waitcnt lgkmcnt(3)
    ds_read_b128 v[252:255], v2 offset:7168
    v_add_f32 v16, v16, v18
    v_mfma_f32_16x16x32_bf16 v[160:163], v[232:235], v[48:51], v[160:163]
    v_mfma_f32_16x16x32_bf16 v[168:171], v[232:235], v[52:55], v[168:171]
    ds_read_b128 v[224:227], v2 offset:8192
    v_mfma_f32_16x16x32_bf16 v[164:167], v[236:239], v[48:51], v[164:167]
    buffer_load_dwordx4 v1, s[8:11], s57 offen offset:1024 sc1 lds
    v_mfma_f32_16x16x32_bf16 v[172:175], v[236:239], v[52:55], v[172:175]
    s_waitcnt lgkmcnt(3)
    ds_read_b128 v[228:231], v2 offset:9216
    v_add_f32 v17, v17, v19
    v_mfma_f32_16x16x32_bf16 v[176:179], v[240:243], v[48:51], v[176:179]
    v_mfma_f32_16x16x32_bf16 v[184:187], v[240:243], v[52:55], v[184:187]
    ds_read_b128 v[232:235], v2 offset:10240
    v_mfma_f32_16x16x32_bf16 v[180:183], v[244:247], v[48:51], v[180:183]
    buffer_load_dwordx4 v[92:95], v4, s[8:11], s56 offen offset:2304 sc1
    v_mfma_f32_16x16x32_bf16 v[188:191], v[244:247], v[52:55], v[188:191]
    s_waitcnt lgkmcnt(3)
    ds_read_b128 v[236:239], v2 offset:11264
    v_mfma_f32_16x16x32_bf16 v[192:195], v[248:251], v[48:51], v[192:195]
    v_add_f32 v20, v20, v22
    v_mfma_f32_16x16x32_bf16 v[200:203], v[248:251], v[52:55], v[200:203]
    ds_read_b128 v[240:243], v2 offset:12288
    v_mfma_f32_16x16x32_bf16 v[196:199], v[252:255], v[48:51], v[196:199]
    buffer_load_dwordx4 v1, s[8:11], s57 offen offset:2048 sc1 lds
    v_mfma_f32_16x16x32_bf16 v[204:207], v[252:255], v[52:55], v[204:207]
    s_waitcnt lgkmcnt(3)
    ds_read_b128 v[244:247], v2 offset:13312
    v_mfma_f32_16x16x32_bf16 v[208:211], v[224:227], v[48:51], v[208:211]
    v_add_f32 v21, v21, v23
    v_mfma_f32_16x16x32_bf16 v[216:219], v[224:227], v[52:55], v[216:219]
    ds_read_b128 v[248:251], v2 offset:14336
    v_mfma_f32_16x16x32_bf16 v[212:215], v[228:231], v[48:51], v[212:215]
    s_add_u32 s56, s29, 16384
    v_mfma_f32_16x16x32_bf16 v[220:223], v[228:231], v[52:55], v[220:223]
    s_waitcnt lgkmcnt(3)
    ds_read_b128 v[252:255], v2 offset:15360
    v_mfma_f32_16x16x32_bf16 v[112:115], v[232:235], v[56:59], v[112:115]
    buffer_load_dwordx4 v[96:99], v4, s[8:11], s56 offen offset:0 sc1
    v_mfma_f32_16x16x32_bf16 v[120:123], v[232:235], v[60:63], v[120:123]
    ds_read_b128 v[224:227], v2 offset:16384
    v_mfma_f32_16x16x32_bf16 v[116:119], v[236:239], v[56:59], v[116:119]
    v_permlane32_swap_b32 v16, v20
    v_mfma_f32_16x16x32_bf16 v[124:127], v[236:239], v[60:63], v[124:127]
    s_waitcnt lgkmcnt(3)
    ds_read_b128 v[228:231], v2 offset:17408
    v_mfma_f32_16x16x32_bf16 v[128:131], v[240:243], v[56:59], v[128:131]
    buffer_load_dwordx4 v1, s[8:11], s57 offen offset:3072 sc1 lds
    v_mfma_f32_16x16x32_bf16 v[136:139], v[240:243], v[60:63], v[136:139]
    ds_read_b128 v[232:235], v2 offset:18432
    v_mfma_f32_16x16x32_bf16 v[132:135], v[244:247], v[56:59], v[132:135]
    v_permlane32_swap_b32 v17, v21
    v_mfma_f32_16x16x32_bf16 v[140:143], v[244:247], v[60:63], v[140:143]
    s_waitcnt lgkmcnt(3)
    ds_read_b128 v[236:239], v2 offset:19456
    v_mfma_f32_16x16x32_bf16 v[144:147], v[248:251], v[56:59], v[144:147]
    buffer_load_dwordx4 v[100:103], v4, s[8:11], s56 offen offset:256 sc1
    v_mfma_f32_16x16x32_bf16 v[152:155], v[248:251], v[60:63], v[152:155]
    ds_read_b128 v[240:243], v2 offset:20480
    v_mfma_f32_16x16x32_bf16 v[148:151], v[252:255], v[56:59], v[148:151]
    v_add_f32 v16, v16, v20
    v_mfma_f32_16x16x32_bf16 v[156:159], v[252:255], v[60:63], v[156:159]
    s_waitcnt lgkmcnt(3)
    ds_read_b128 v[244:247], v2 offset:21504
    v_mfma_f32_16x16x32_bf16 v[160:163], v[224:227], v[56:59], v[160:163]
    s_add_u32 s57, s99, 98304
    s_add_u32 m0, s97, 131072
    v_mfma_f32_16x16x32_bf16 v[168:171], v[224:227], v[60:63], v[168:171]
    ds_read_b128 v[248:251], v2 offset:22528
    v_mfma_f32_16x16x32_bf16 v[164:167], v[228:231], v[56:59], v[164:167]
    buffer_load_dwordx4 v1, s[8:11], s57 offen offset:0 sc1 lds
    v_mfma_f32_16x16x32_bf16 v[172:175], v[228:231], v[60:63], v[172:175]
    s_waitcnt lgkmcnt(3)
    ds_read_b128 v[252:255], v2 offset:23552
    v_add_f32 v17, v17, v21
    v_mfma_f32_16x16x32_bf16 v[176:179], v[232:235], v[56:59], v[176:179]
    v_mfma_f32_16x16x32_bf16 v[184:187], v[232:235], v[60:63], v[184:187]
    ds_read_b128 v[224:227], v2 offset:24576
    v_mfma_f32_16x16x32_bf16 v[180:183], v[236:239], v[56:59], v[180:183]
    buffer_load_dwordx4 v1, s[8:11], s57 offen offset:1024 sc1 lds
    v_mfma_f32_16x16x32_bf16 v[188:191], v[236:239], v[60:63], v[188:191]
    s_waitcnt lgkmcnt(3)
    ds_read_b128 v[228:231], v2 offset:25600
    v_mov_b32 v18, v16
    v_mfma_f32_16x16x32_bf16 v[192:195], v[240:243], v[56:59], v[192:195]
    v_mfma_f32_16x16x32_bf16 v[200:203], v[240:243], v[60:63], v[200:203]
    ds_read_b128 v[232:235], v2 offset:26624
    v_mfma_f32_16x16x32_bf16 v[196:199], v[244:247], v[56:59], v[196:199]
    buffer_load_dwordx4 v[104:107], v4, s[8:11], s56 offen offset:2048 sc1
    v_mfma_f32_16x16x32_bf16 v[204:207], v[244:247], v[60:63], v[204:207]
    s_waitcnt lgkmcnt(3)
    ds_read_b128 v[236:239], v2 offset:27648
    v_mov_b32 v19, v17
    v_mfma_f32_16x16x32_bf16 v[208:211], v[248:251], v[56:59], v[208:211]
    v_mfma_f32_16x16x32_bf16 v[216:219], v[248:251], v[60:63], v[216:219]
    ds_read_b128 v[240:243], v2 offset:28672
    v_mfma_f32_16x16x32_bf16 v[212:215], v[252:255], v[56:59], v[212:215]
    v_mfma_f32_16x16x32_bf16 v[220:223], v[252:255], v[60:63], v[220:223]
    s_waitcnt lgkmcnt(3)
    ds_read_b128 v[244:247], v2 offset:29696
    v_mfma_f32_16x16x32_bf16 v[112:115], v[224:227], v[64:67], v[112:115]
    buffer_load_dwordx4 v1, s[8:11], s57 offen offset:2048 sc1 lds
    v_mfma_f32_16x16x32_bf16 v[120:123], v[224:227], v[68:71], v[120:123]
    ds_read_b128 v[248:251], v2 offset:30720
    v_add_u32 v21, 0, v6
    v_mfma_f32_16x16x32_bf16 v[116:119], v[228:231], v[64:67], v[116:119]
    v_mfma_f32_16x16x32_bf16 v[124:127], v[228:231], v[68:71], v[124:127]
    s_waitcnt lgkmcnt(3)
    ds_read_b128 v[252:255], v2 offset:31744
    v_mfma_f32_16x16x32_bf16 v[128:131], v[232:235], v[64:67], v[128:131]
    s_waitcnt vmcnt(13)
    s_barrier
    v_mfma_f32_16x16x32_bf16 v[136:139], v[232:235], v[68:71], v[136:139]
    ds_read_b128 v[224:227], v2 offset:32768
    v_add_u32 v22, 65536, v6
    v_mfma_f32_16x16x32_bf16 v[132:135], v[236:239], v[64:67], v[132:135]
    buffer_load_dwordx4 v[108:111], v4, s[8:11], s56 offen offset:2304 sc1
    v_mfma_f32_16x16x32_bf16 v[140:143], v[236:239], v[68:71], v[140:143]
    s_waitcnt lgkmcnt(3)
    ds_read_b128 v[228:231], v2 offset:33792
    v_mfma_f32_16x16x32_bf16 v[144:147], v[240:243], v[64:67], v[144:147]
    v_add_u32 v23, 131072, v6
    v_mfma_f32_16x16x32_bf16 v[152:155], v[240:243], v[68:71], v[152:155]
    ds_read_b128 v[232:235], v2 offset:34816
    v_mfma_f32_16x16x32_bf16 v[148:151], v[244:247], v[64:67], v[148:151]
    buffer_load_dwordx4 v1, s[8:11], s57 offen offset:3072 sc1 lds
    v_mfma_f32_16x16x32_bf16 v[156:159], v[244:247], v[68:71], v[156:159]
    s_waitcnt lgkmcnt(3)
    ds_read_b128 v[236:239], v2 offset:35840
    s_add_u32 s57, s99, 114688
    v_mfma_f32_16x16x32_bf16 v[160:163], v[248:251], v[64:67], v[160:163]
    s_add_u32 m0, s97, 147456
    v_mfma_f32_16x16x32_bf16 v[168:171], v[248:251], v[68:71], v[168:171]
    ds_read_b128 v[240:243], v2 offset:36864
    v_mfma_f32_16x16x32_bf16 v[164:167], v[252:255], v[64:67], v[164:167]
    v_permlane16_swap_b32 v16, v18
    v_mfma_f32_16x16x32_bf16 v[172:175], v[252:255], v[68:71], v[172:175]
    s_waitcnt lgkmcnt(3)
    ds_read_b128 v[244:247], v2 offset:37888
    v_mfma_f32_16x16x32_bf16 v[176:179], v[224:227], v[64:67], v[176:179]
    buffer_load_dwordx4 v1, s[8:11], s57 offen offset:0 sc1 lds
    v_mfma_f32_16x16x32_bf16 v[184:187], v[224:227], v[68:71], v[184:187]
    s_add_u32 s56, s29, 20480
    ds_read_b128 v[248:251], v2 offset:38912
    v_mfma_f32_16x16x32_bf16 v[180:183], v[228:231], v[64:67], v[180:183]
    v_permlane16_swap_b32 v17, v19
    v_mfma_f32_16x16x32_bf16 v[188:191], v[228:231], v[68:71], v[188:191]
    s_waitcnt lgkmcnt(3)
    ds_read_b128 v[252:255], v2 offset:39936
    v_mfma_f32_16x16x32_bf16 v[192:195], v[232:235], v[64:67], v[192:195]
    buffer_load_dwordx4 v[32:35], v4, s[8:11], s56 offen offset:0 sc1
    v_mfma_f32_16x16x32_bf16 v[200:203], v[232:235], v[68:71], v[200:203]
    ds_read_b128 v[224:227], v2 offset:40960
    v_mfma_f32_16x16x32_bf16 v[196:199], v[236:239], v[64:67], v[196:199]
    v_add_f32 v16, v16, v18
    v_mfma_f32_16x16x32_bf16 v[204:207], v[236:239], v[68:71], v[204:207]
    s_waitcnt lgkmcnt(3)
    ds_read_b128 v[228:231], v2 offset:41984
    v_mfma_f32_16x16x32_bf16 v[208:211], v[240:243], v[64:67], v[208:211]
    buffer_load_dwordx4 v1, s[8:11], s57 offen offset:1024 sc1 lds
    v_mfma_f32_16x16x32_bf16 v[216:219], v[240:243], v[68:71], v[216:219]
    ds_read_b128 v[232:235], v2 offset:43008
    v_mfma_f32_16x16x32_bf16 v[212:215], v[244:247], v[64:67], v[212:215]
    v_add_f32 v17, v17, v19
    v_mfma_f32_16x16x32_bf16 v[220:223], v[244:247], v[68:71], v[220:223]
    s_waitcnt lgkmcnt(3)
    ds_read_b128 v[236:239], v2 offset:44032
    v_mfma_f32_16x16x32_bf16 v[112:115], v[248:251], v[72:75], v[112:115]
    buffer_load_dwordx4 v[36:39], v4, s[8:11], s56 offen offset:256 sc1
    v_mfma_f32_16x16x32_bf16 v[120:123], v[248:251], v[76:79], v[120:123]
    ds_read_b128 v[240:243], v2 offset:45056
    v_mfma_f32_16x16x32_bf16 v[116:119], v[252:255], v[72:75], v[116:119]
    v_mfma_f32_16x16x32_bf16 v[124:127], v[252:255], v[76:79], v[124:127]
    s_waitcnt lgkmcnt(3)
    ds_read_b128 v[244:247], v2 offset:46080
    v_mul_f32 v16, 0x3b000000, v16
    v_mfma_f32_16x16x32_bf16 v[128:131], v[224:227], v[72:75], v[128:131]
    buffer_load_dwordx4 v1, s[8:11], s57 offen offset:2048 sc1 lds
    v_mfma_f32_16x16x32_bf16 v[136:139], v[224:227], v[76:79], v[136:139]
    ds_read_b128 v[248:251], v2 offset:47104
    v_mfma_f32_16x16x32_bf16 v[132:135], v[228:231], v[72:75], v[132:135]
    v_mfma_f32_16x16x32_bf16 v[140:143], v[228:231], v[76:79], v[140:143]
    s_waitcnt lgkmcnt(3)
    ds_read_b128 v[252:255], v2 offset:48128
    v_mul_f32 v18, v16, v16
    v_mfma_f32_16x16x32_bf16 v[144:147], v[232:235], v[72:75], v[144:147]
    s_waitcnt vmcnt(12)
    s_barrier
    v_mfma_f32_16x16x32_bf16 v[152:155], v[232:235], v[76:79], v[152:155]
    ds_read_b128 v[224:227], v2 offset:49152
    v_mfma_f32_16x16x32_bf16 v[148:151], v[236:239], v[72:75], v[148:151]
    buffer_load_dwordx4 v[40:43], v4, s[8:11], s56 offen offset:2048 sc1
    v_mfma_f32_16x16x32_bf16 v[156:159], v[236:239], v[76:79], v[156:159]
    s_waitcnt lgkmcnt(3)
    ds_read_b128 v[228:231], v2 offset:50176
    v_mfma_f32_16x16x32_bf16 v[160:163], v[240:243], v[72:75], v[160:163]
    v_mul_f32 v17, 0x3b000000, v17
    v_mfma_f32_16x16x32_bf16 v[168:171], v[240:243], v[76:79], v[168:171]
    ds_read_b128 v[232:235], v2 offset:51200
    v_mfma_f32_16x16x32_bf16 v[164:167], v[244:247], v[72:75], v[164:167]
    buffer_load_dwordx4 v1, s[8:11], s57 offen offset:3072 sc1 lds
    v_mfma_f32_16x16x32_bf16 v[172:175], v[244:247], v[76:79], v[172:175]
    s_waitcnt lgkmcnt(3)
    ds_read_b128 v[236:239], v2 offset:52224
    v_mfma_f32_16x16x32_bf16 v[176:179], v[248:251], v[72:75], v[176:179]
    s_add_u32 s57, s99, 131072
    v_sub_f32 v17, v17, v18
    s_add_u32 m0, s97, 0
    v_mfma_f32_16x16x32_bf16 v[184:187], v[248:251], v[76:79], v[184:187]
    ds_read_b128 v[240:243], v2 offset:53248
    v_mfma_f32_16x16x32_bf16 v[180:183], v[252:255], v[72:75], v[180:183]
    buffer_load_dwordx4 v1, s[8:11], s57 offen offset:0 sc1 lds
    v_mfma_f32_16x16x32_bf16 v[188:191], v[252:255], v[76:79], v[188:191]
    s_waitcnt lgkmcnt(3)
    ds_read_b128 v[244:247], v2 offset:54272
    v_mfma_f32_16x16x32_bf16 v[192:195], v[224:227], v[72:75], v[192:195]
    v_mfma_f32_16x16x32_bf16 v[200:203], v[224:227], v[76:79], v[200:203]
    ds_read_b128 v[248:251], v2 offset:55296
    v_max_f32 v17, 0, v17
    v_mfma_f32_16x16x32_bf16 v[196:199], v[228:231], v[72:75], v[196:199]
    buffer_load_dwordx4 v[44:47], v4, s[8:11], s56 offen offset:2304 sc1
    v_mfma_f32_16x16x32_bf16 v[204:207], v[228:231], v[76:79], v[204:207]
    s_waitcnt lgkmcnt(3)
    ds_read_b128 v[252:255], v2 offset:56320
    v_mfma_f32_16x16x32_bf16 v[208:211], v[232:235], v[72:75], v[208:211]
    v_mfma_f32_16x16x32_bf16 v[216:219], v[232:235], v[76:79], v[216:219]
    ds_read_b128 v[224:227], v2 offset:57344
    v_cvt_pk_bf16_f32 v17, v17, v17
    v_mfma_f32_16x16x32_bf16 v[212:215], v[236:239], v[72:75], v[212:215]
    buffer_load_dwordx4 v1, s[8:11], s57 offen offset:1024 sc1 lds
    v_mfma_f32_16x16x32_bf16 v[220:223], v[236:239], v[76:79], v[220:223]
    s_waitcnt lgkmcnt(3)
    ds_read_b128 v[228:231], v2 offset:58368
    v_mfma_f32_16x16x32_bf16 v[112:115], v[240:243], v[80:83], v[112:115]
    v_mfma_f32_16x16x32_bf16 v[120:123], v[240:243], v[84:87], v[120:123]
    s_add_u32 s56, s29, 24576
    ds_read_b128 v[232:235], v2 offset:59392
    v_lshlrev_b32 v17, 16, v17
    v_mfma_f32_16x16x32_bf16 v[116:119], v[244:247], v[80:83], v[116:119]
    buffer_load_dwordx4 v[48:51], v4, s[8:11], s56 offen offset:0 sc1
    v_mfma_f32_16x16x32_bf16 v[124:127], v[244:247], v[84:87], v[124:127]
    s_waitcnt lgkmcnt(3)
    ds_read_b128 v[236:239], v2 offset:60416
    v_mfma_f32_16x16x32_bf16 v[128:131], v[248:251], v[80:83], v[128:131]
    v_mfma_f32_16x16x32_bf16 v[136:139], v[248:251], v[84:87], v[136:139]
    ds_read_b128 v[240:243], v2 offset:61440
    v_mfma_f32_16x16x32_bf16 v[132:135], v[252:255], v[80:83], v[132:135]
    v_add_f32 v17, 0x3727c5ac, v17
    v_mfma_f32_16x16x32_bf16 v[140:143], v[252:255], v[84:87], v[140:143]
    s_waitcnt lgkmcnt(3)
    ds_read_b128 v[244:247], v2 offset:62464
    v_mfma_f32_16x16x32_bf16 v[144:147], v[224:227], v[80:83], v[144:147]
    buffer_load_dwordx4 v1, s[8:11], s57 offen offset:2048 sc1 lds
    v_mfma_f32_16x16x32_bf16 v[152:155], v[224:227], v[84:87], v[152:155]
    ds_read_b128 v[248:251], v2 offset:63488
    v_mfma_f32_16x16x32_bf16 v[148:151], v[228:231], v[80:83], v[148:151]
    v_cvt_pk_bf16_f32 v17, v17, v17
    v_mfma_f32_16x16x32_bf16 v[156:159], v[228:231], v[84:87], v[156:159]
    s_waitcnt lgkmcnt(3)
    ds_read_b128 v[252:255], v2 offset:64512
    v_mfma_f32_16x16x32_bf16 v[160:163], v[232:235], v[80:83], v[160:163]
    s_waitcnt vmcnt(12)
    s_barrier
    v_mfma_f32_16x16x32_bf16 v[168:171], v[232:235], v[84:87], v[168:171]
    ds_read_b128 v[224:227], v3 offset:0
    v_mfma_f32_16x16x32_bf16 v[164:167], v[236:239], v[80:83], v[164:167]
    buffer_load_dwordx4 v[52:55], v4, s[8:11], s56 offen offset:256 sc1
    v_mfma_f32_16x16x32_bf16 v[172:175], v[236:239], v[84:87], v[172:175]
    s_waitcnt lgkmcnt(3)
    ds_read_b128 v[228:231], v3 offset:1024
    v_lshlrev_b32 v17, 16, v17
    v_mfma_f32_16x16x32_bf16 v[176:179], v[240:243], v[80:83], v[176:179]
    buffer_load_dwordx4 v1, s[8:11], s57 offen offset:3072 sc1 lds
    v_mfma_f32_16x16x32_bf16 v[184:187], v[240:243], v[84:87], v[184:187]
    ds_read_b128 v[232:235], v3 offset:2048
    v_mfma_f32_16x16x32_bf16 v[180:183], v[244:247], v[80:83], v[180:183]
    v_mfma_f32_16x16x32_bf16 v[188:191], v[244:247], v[84:87], v[188:191]
    s_waitcnt lgkmcnt(3)
    ds_read_b128 v[236:239], v3 offset:3072
    v_mfma_f32_16x16x32_bf16 v[192:195], v[248:251], v[80:83], v[192:195]
    s_add_u32 s57, s99, 147456
    v_sqrt_f32 v17, v17
    v_mfma_f32_16x16x32_bf16 v[200:203], v[248:251], v[84:87], v[200:203]
    s_add_u32 m0, s97, 16384
    ds_read_b128 v[240:243], v3 offset:4096
    v_mfma_f32_16x16x32_bf16 v[196:199], v[252:255], v[80:83], v[196:199]
    buffer_load_dwordx4 v1, s[8:11], s57 offen offset:0 sc1 lds
    v_mfma_f32_16x16x32_bf16 v[204:207], v[252:255], v[84:87], v[204:207]
    s_waitcnt lgkmcnt(3)
    ds_read_b128 v[244:247], v3 offset:5120
    v_mfma_f32_16x16x32_bf16 v[208:211], v[224:227], v[80:83], v[208:211]
    v_cvt_pk_bf16_f32 v17, v17, v17
    v_mfma_f32_16x16x32_bf16 v[216:219], v[224:227], v[84:87], v[216:219]
    ds_read_b128 v[248:251], v3 offset:6144
    v_mfma_f32_16x16x32_bf16 v[212:215], v[228:231], v[80:83], v[212:215]
    buffer_load_dwordx4 v[56:59], v4, s[8:11], s56 offen offset:2048 sc1
    v_mfma_f32_16x16x32_bf16 v[220:223], v[228:231], v[84:87], v[220:223]
    s_waitcnt lgkmcnt(3)
    ds_read_b128 v[252:255], v3 offset:7168
    v_mfma_f32_16x16x32_bf16 v[112:115], v[232:235], v[88:91], v[112:115]
    v_lshlrev_b32 v17, 16, v17
    v_mfma_f32_16x16x32_bf16 v[120:123], v[232:235], v[92:95], v[120:123]
    ds_read_b128 v[224:227], v3 offset:8192
    v_mfma_f32_16x16x32_bf16 v[116:119], v[236:239], v[88:91], v[116:119]
    buffer_load_dwordx4 v1, s[8:11], s57 offen offset:1024 sc1 lds
    v_mfma_f32_16x16x32_bf16 v[124:127], v[236:239], v[92:95], v[124:127]
    s_waitcnt lgkmcnt(3)
    ds_read_b128 v[228:231], v3 offset:9216
    v_mfma_f32_16x16x32_bf16 v[128:131], v[240:243], v[88:91], v[128:131]
    v_mfma_f32_16x16x32_bf16 v[136:139], v[240:243], v[92:95], v[136:139]
    ds_read_b128 v[232:235], v3 offset:10240
    v_mfma_f32_16x16x32_bf16 v[132:135], v[244:247], v[88:91], v[132:135]
    v_rcp_f32 v17, v17
    v_mfma_f32_16x16x32_bf16 v[140:143], v[244:247], v[92:95], v[140:143]
    s_waitcnt lgkmcnt(3)
    ds_read_b128 v[236:239], v3 offset:11264
    v_mfma_f32_16x16x32_bf16 v[144:147], v[248:251], v[88:91], v[144:147]
    buffer_load_dwordx4 v[60:63], v4, s[8:11], s56 offen offset:2304 sc1
    v_mfma_f32_16x16x32_bf16 v[152:155], v[248:251], v[92:95], v[152:155]
    ds_read_b128 v[240:243], v3 offset:12288
    v_cvt_pk_bf16_f32 v24, -v16, -v16
    v_mfma_f32_16x16x32_bf16 v[148:151], v[252:255], v[88:91], v[148:151]
    v_mfma_f32_16x16x32_bf16 v[156:159], v[252:255], v[92:95], v[156:159]
    s_waitcnt lgkmcnt(3)
    ds_read_b128 v[244:247], v3 offset:13312
    v_mfma_f32_16x16x32_bf16 v[160:163], v[224:227], v[88:91], v[160:163]
    buffer_load_dwordx4 v1, s[8:11], s57 offen offset:2048 sc1 lds
    v_mfma_f32_16x16x32_bf16 v[168:171], v[224:227], v[92:95], v[168:171]
    ds_read_b128 v[248:251], v3 offset:14336
    v_mfma_f32_16x16x32_bf16 v[164:167], v[228:231], v[88:91], v[164:167]
    v_cvt_pk_bf16_f32 v25, -v16, -v16
    v_mfma_f32_16x16x32_bf16 v[172:175], v[228:231], v[92:95], v[172:175]
    s_waitcnt lgkmcnt(3)
    ds_read_b128 v[252:255], v3 offset:15360
    v_mfma_f32_16x16x32_bf16 v[176:179], v[232:235], v[88:91], v[176:179]
    s_waitcnt vmcnt(12)
    s_barrier
    v_mfma_f32_16x16x32_bf16 v[184:187], v[232:235], v[92:95], v[184:187]
    ds_read_b128 v[224:227], v3 offset:16384
    v_mfma_f32_16x16x32_bf16 v[180:183], v[236:239], v[88:91], v[180:183]
    buffer_load_dwordx4 v1, s[8:11], s57 offen offset:3072 sc1 lds
    v_mfma_f32_16x16x32_bf16 v[188:191], v[236:239], v[92:95], v[188:191]
    s_waitcnt lgkmcnt(3)
    ds_read_b128 v[228:231], v3 offset:17408
    v_cvt_pk_bf16_f32 v26, -v16, -v16
    v_mfma_f32_16x16x32_bf16 v[192:195], v[240:243], v[88:91], v[192:195]
    s_add_u32 s56, s29, 28672
    buffer_load_dwordx4 v[64:67], v4, s[8:11], s56 offen offset:0 sc1
    v_mfma_f32_16x16x32_bf16 v[200:203], v[240:243], v[92:95], v[200:203]
    ds_read_b128 v[232:235], v3 offset:18432
    v_mfma_f32_16x16x32_bf16 v[196:199], v[244:247], v[88:91], v[196:199]
    v_cvt_pk_bf16_f32 v27, -v16, -v16
    v_mfma_f32_16x16x32_bf16 v[204:207], v[244:247], v[92:95], v[204:207]
    s_waitcnt lgkmcnt(3)
    ds_read_b128 v[236:239], v3 offset:19456
    v_mfma_f32_16x16x32_bf16 v[208:211], v[248:251], v[88:91], v[208:211]
    s_add_u32 s57, s99, 163840
    s_add_u32 m0, s97, 32768
    v_mfma_f32_16x16x32_bf16 v[216:219], v[248:251], v[92:95], v[216:219]
    ds_read_b128 v[240:243], v3 offset:20480
    v_mfma_f32_16x16x32_bf16 v[212:215], v[252:255], v[88:91], v[212:215]
    buffer_load_dwordx4 v1, s[8:11], s57 offen offset:0 sc1 lds
    v_mfma_f32_16x16x32_bf16 v[220:223], v[252:255], v[92:95], v[220:223]
    s_waitcnt lgkmcnt(3)
    ds_read_b128 v[244:247], v3 offset:21504
    v_mul_f32 v17, v17, v17
    v_mfma_f32_16x16x32_bf16 v[112:115], v[224:227], v[96:99], v[112:115]
    v_mfma_f32_16x16x32_bf16 v[120:123], v[224:227], v[100:103], v[120:123]
    ds_read_b128 v[248:251], v3 offset:22528
    v_mfma_f32_16x16x32_bf16 v[116:119], v[228:231], v[96:99], v[116:119]
    buffer_load_dwordx4 v[68:71], v4, s[8:11], s56 offen offset:256 sc1
    v_mfma_f32_16x16x32_bf16 v[124:127], v[228:231], v[100:103], v[124:127]
    s_waitcnt lgkmcnt(3)
    ds_read_b128 v[252:255], v3 offset:23552
    s_lshr_b32 s60, s39, 3
    v_mfma_f32_16x16x32_bf16 v[128:131], v[232:235], v[96:99], v[128:131]
    s_add_u32 s60, s60, 110592
    v_mfma_f32_16x16x32_bf16 v[136:139], v[232:235], v[100:103], v[136:139]
    ds_read_b128 v[224:227], v3 offset:24576
    v_mfma_f32_16x16x32_bf16 v[132:135], v[236:239], v[96:99], v[132:135]
    buffer_load_dwordx4 v1, s[8:11], s57 offen offset:1024 sc1 lds
    v_mfma_f32_16x16x32_bf16 v[140:143], v[236:239], v[100:103], v[140:143]
    s_waitcnt lgkmcnt(3)
    ds_read_b128 v[228:231], v3 offset:25600
    v_mfma_f32_16x16x32_bf16 v[144:147], v[240:243], v[96:99], v[144:147]
    v_and_or_b32 v16, v6, 63, s60
    v_mfma_f32_16x16x32_bf16 v[152:155], v[240:243], v[100:103], v[152:155]
    ds_read_b128 v[232:235], v3 offset:26624
    v_mfma_f32_16x16x32_bf16 v[148:151], v[244:247], v[96:99], v[148:151]
    v_mfma_f32_16x16x32_bf16 v[156:159], v[244:247], v[100:103], v[156:159]
    s_waitcnt lgkmcnt(3)
    ds_read_b128 v[236:239], v3 offset:27648
    v_mfma_f32_16x16x32_bf16 v[160:163], v[248:251], v[96:99], v[160:163]
    buffer_load_dwordx4 v[72:75], v4, s[8:11], s56 offen offset:2048 sc1
    v_mfma_f32_16x16x32_bf16 v[168:171], v[248:251], v[100:103], v[168:171]
    ds_read_b128 v[240:243], v3 offset:28672
    v_and_b32 v18, 32, v0
    v_mfma_f32_16x16x32_bf16 v[164:167], v[252:255], v[96:99], v[164:167]
    v_mfma_f32_16x16x32_bf16 v[172:175], v[252:255], v[100:103], v[172:175]
    s_waitcnt lgkmcnt(3)
    ds_read_b128 v[244:247], v3 offset:29696
    v_mfma_f32_16x16x32_bf16 v[176:179], v[224:227], v[96:99], v[176:179]
    buffer_load_dwordx4 v1, s[8:11], s57 offen offset:2048 sc1 lds
    v_mfma_f32_16x16x32_bf16 v[184:187], v[224:227], v[100:103], v[184:187]
    ds_read_b128 v[248:251], v3 offset:30720
    v_lshl_add_u32 v16, v18, 1, v16
    v_mfma_f32_16x16x32_bf16 v[180:183], v[228:231], v[96:99], v[180:183]
    v_mfma_f32_16x16x32_bf16 v[188:191], v[228:231], v[100:103], v[188:191]
    s_waitcnt lgkmcnt(3)
    ds_read_b128 v[252:255], v3 offset:31744
    v_mfma_f32_16x16x32_bf16 v[192:195], v[232:235], v[96:99], v[192:195]
    s_waitcnt vmcnt(12)
    s_barrier
    v_mfma_f32_16x16x32_bf16 v[200:203], v[232:235], v[100:103], v[200:203]
    ds_read_b128 v[224:227], v1 offset:0
    v_mfma_f32_16x16x32_bf16 v[196:199], v[236:239], v[96:99], v[196:199]
    buffer_load_dwordx4 v[76:79], v4, s[8:11], s56 offen offset:2304 sc1
    v_mfma_f32_16x16x32_bf16 v[204:207], v[236:239], v[100:103], v[204:207]
    s_waitcnt lgkmcnt(3)
    ds_read_b128 v[228:231], v1 offset:1024
    v_mfma_f32_16x16x32_bf16 v[208:211], v[240:243], v[96:99], v[208:211]
    v_permlane32_swap_b32 v24, v26
    v_mfma_f32_16x16x32_bf16 v[216:219], v[240:243], v[100:103], v[216:219]
    ds_read_b128 v[232:235], v1 offset:2048
    v_mfma_f32_16x16x32_bf16 v[212:215], v[244:247], v[96:99], v[212:215]
    buffer_load_dwordx4 v1, s[8:11], s57 offen offset:3072 sc1 lds
    v_mfma_f32_16x16x32_bf16 v[220:223], v[244:247], v[100:103], v[220:223]
    s_waitcnt lgkmcnt(3)
    ds_read_b128 v[236:239], v1 offset:3072
    v_mfma_f32_16x16x32_bf16 v[112:115], v[248:251], v[104:107], v[112:115]
    s_add_u32 s57, s99, 180224
    v_permlane32_swap_b32 v25, v27
    v_mfma_f32_16x16x32_bf16 v[120:123], v[248:251], v[108:111], v[120:123]
    s_add_u32 m0, s97, 49152
    ds_read_b128 v[240:243], v1 offset:4096
    v_mfma_f32_16x16x32_bf16 v[116:119], v[252:255], v[104:107], v[116:119]
    buffer_load_dwordx4 v1, s[8:11], s57 offen offset:0 sc1 lds
    v_mfma_f32_16x16x32_bf16 v[124:127], v[252:255], v[108:111], v[124:127]
    s_waitcnt lgkmcnt(3)
    ds_read_b128 v[244:247], v1 offset:5120
    v_mfma_f32_16x16x32_bf16 v[128:131], v[224:227], v[104:107], v[128:131]
    v_mfma_f32_16x16x32_bf16 v[136:139], v[224:227], v[108:111], v[136:139]
    ds_read_b128 v[248:251], v1 offset:6144
    v_mfma_f32_16x16x32_bf16 v[132:135], v[228:231], v[104:107], v[132:135]
    buffer_load_dwordx4 v1, s[8:11], s57 offen offset:1024 sc1 lds
    v_mfma_f32_16x16x32_bf16 v[140:143], v[228:231], v[108:111], v[140:143]
    s_waitcnt lgkmcnt(3)
    ds_read_b128 v[252:255], v1 offset:7168
    v_mfma_f32_16x16x32_bf16 v[144:147], v[232:235], v[104:107], v[144:147]
    v_mfma_f32_16x16x32_bf16 v[152:155], v[232:235], v[108:111], v[152:155]
    ds_read_b128 v[224:227], v1 offset:8192
    v_mfma_f32_16x16x32_bf16 v[148:151], v[236:239], v[104:107], v[148:151]
    v_mfma_f32_16x16x32_bf16 v[156:159], v[236:239], v[108:111], v[156:159]
    s_waitcnt lgkmcnt(3)
    ds_read_b128 v[228:231], v1 offset:9216
    v_mfma_f32_16x16x32_bf16 v[160:163], v[240:243], v[104:107], v[160:163]
    buffer_load_dwordx4 v1, s[8:11], s57 offen offset:2048 sc1 lds
    v_mfma_f32_16x16x32_bf16 v[168:171], v[240:243], v[108:111], v[168:171]
    ds_read_b128 v[232:235], v1 offset:10240
    v_mfma_f32_16x16x32_bf16 v[164:167], v[244:247], v[104:107], v[164:167]
    v_mfma_f32_16x16x32_bf16 v[172:175], v[244:247], v[108:111], v[172:175]
    s_waitcnt lgkmcnt(3)
    ds_read_b128 v[236:239], v1 offset:11264
    v_mfma_f32_16x16x32_bf16 v[176:179], v[248:251], v[104:107], v[176:179]
    v_mfma_f32_16x16x32_bf16 v[184:187], v[248:251], v[108:111], v[184:187]
    ds_read_b128 v[240:243], v1 offset:12288
    v_mfma_f32_16x16x32_bf16 v[180:183], v[252:255], v[104:107], v[180:183]
    buffer_load_dwordx4 v1, s[8:11], s57 offen offset:3072 sc1 lds
    v_mfma_f32_16x16x32_bf16 v[188:191], v[252:255], v[108:111], v[188:191]
    s_waitcnt lgkmcnt(3)
    ds_read_b128 v[244:247], v1 offset:13312
    v_mfma_f32_16x16x32_bf16 v[192:195], v[224:227], v[104:107], v[192:195]
    v_mfma_f32_16x16x32_bf16 v[200:203], v[224:227], v[108:111], v[200:203]
    ds_read_b128 v[248:251], v1 offset:14336
    v_mfma_f32_16x16x32_bf16 v[196:199], v[228:231], v[104:107], v[196:199]
    v_mfma_f32_16x16x32_bf16 v[204:207], v[228:231], v[108:111], v[204:207]
    s_waitcnt lgkmcnt(3)
    ds_read_b128 v[252:255], v1 offset:15360
    s_add_u32 s57, s99, 196608
    v_mfma_f32_16x16x32_bf16 v[208:211], v[232:235], v[104:107], v[208:211]
    s_waitcnt vmcnt(12)
    s_barrier
    v_mfma_f32_16x16x32_bf16 v[216:219], v[232:235], v[108:111], v[216:219]
    s_add_u32 m0, s97, 65536
    ds_read_b128 v[224:227], v1 offset:16384
    v_mfma_f32_16x16x32_bf16 v[212:215], v[236:239], v[104:107], v[212:215]
    buffer_load_dwordx4 v1, s[8:11], s57 offen offset:0 sc1 lds
    v_mfma_f32_16x16x32_bf16 v[220:223], v[236:239], v[108:111], v[220:223]
    s_waitcnt lgkmcnt(3)
    ds_read_b128 v[228:231], v1 offset:17408
    v_mfma_f32_16x16x32_bf16 v[112:115], v[240:243], v[32:35], v[112:115]
    s_add_u32 s15, s13, L_dn1-L_pc+0
    ds_write_b32 v16, v17
    s_min_u32 s15, s15, L_code_end-L_pc-4
    v_mfma_f32_16x16x32_bf16 v[120:123], v[240:243], v[36:39], v[120:123]
    ds_read_b128 v[232:235], v1 offset:18432
    v_mov_b32 v19, s15
    v_mfma_f32_16x16x32_bf16 v[116:119], v[244:247], v[32:35], v[116:119]
    buffer_load_dwordx4 v1, s[8:11], s57 offen offset:1024 sc1 lds
    v_mfma_f32_16x16x32_bf16 v[124:127], v[244:247], v[36:39], v[124:127]
    s_waitcnt lgkmcnt(4)
    ds_read_b128 v[236:239], v1 offset:19456
    v_mfma_f32_16x16x32_bf16 v[112:115], v[248:251], v[40:43], v[112:115]
    global_load_dword a255, v19, s[4:5]
    v_mfma_f32_16x16x32_bf16 v[120:123], v[248:251], v[44:47], v[120:123]
    ds_read_b128 v[240:243], v1 offset:20480
    v_mfma_f32_16x16x32_bf16 v[116:119], v[252:255], v[40:43], v[116:119]
    v_mfma_f32_16x16x32_bf16 v[124:127], v[252:255], v[44:47], v[124:127]
    s_waitcnt lgkmcnt(4)
    ds_read_b128 v[244:247], v1 offset:21504
    v_mfma_f32_16x16x32_bf16 v[112:115], v[224:227], v[48:51], v[112:115]
    buffer_load_dwordx4 v1, s[8:11], s57 offen offset:2048 sc1 lds
    v_mfma_f32_16x16x32_bf16 v[120:123], v[224:227], v[52:55], v[120:123]
    ds_read_b128 v[248:251], v1 offset:22528
    v_mfma_f32_16x16x32_bf16 v[116:119], v[228:231], v[48:51], v[116:119]
    v_mfma_f32_16x16x32_bf16 v[124:127], v[228:231], v[52:55], v[124:127]
    s_waitcnt lgkmcnt(3)
    ds_read_b128 v[252:255], v1 offset:23552
    v_mfma_f32_16x16x32_bf16 v[112:115], v[232:235], v[56:59], v[112:115]
    v_mfma_f32_16x16x32_bf16 v[120:123], v[232:235], v[60:63], v[120:123]
    ds_read2st64_b32 v[224:225], v21 offset0:96 offset1:97
    ds_read2st64_b32 v[226:227], v21 offset0:98 offset1:99
    v_mfma_f32_16x16x32_bf16 v[116:119], v[236:239], v[56:59], v[116:119]
    buffer_load_dwordx4 v1, s[8:11], s57 offen offset:3072 sc1 lds
    v_mfma_f32_16x16x32_bf16 v[124:127], v[236:239], v[60:63], v[124:127]
    s_waitcnt vmcnt(14) lgkmcnt(4)
    ds_read_b128 v[228:231], v1 offset:25600
    v_mfma_f32_16x16x32_bf16 v[112:115], v[240:243], v[64:67], v[112:115]
    v_mfma_f32_16x16x32_bf16 v[120:123], v[240:243], v[68:71], v[120:123]
    ds_read_b128 v[232:235], v1 offset:26624
    v_mfma_f32_16x16x32_bf16 v[116:119], v[244:247], v[64:67], v[116:119]
    v_mfma_f32_16x16x32_bf16 v[124:127], v[244:247], v[68:71], v[124:127]
    s_waitcnt vmcnt(10) lgkmcnt(4)
    ds_read_b128 v[236:239], v1 offset:27648
    s_add_u32 s57, s99, 212992
    v_mfma_f32_16x16x32_bf16 v[112:115], v[248:251], v[72:75], v[112:115]
    s_add_u32 m0, s97, 81920
    v_mfma_f32_16x16x32_bf16 v[120:123], v[248:251], v[76:79], v[120:123]
    ds_read_b128 v[240:243], v1 offset:28672
    v_mfma_f32_16x16x32_bf16 v[116:119], v[252:255], v[72:75], v[116:119]
    buffer_load_dwordx4 v1, s[8:11], s57 offen offset:0 sc1 lds
    v_mfma_f32_16x16x32_bf16 v[124:127], v[252:255], v[76:79], v[124:127]
    s_waitcnt lgkmcnt(3)
    ds_read_b128 v[244:247], v1 offset:29696
    v_mfma_f32_16x16x16_bf16 v[112:115], v[224:225], v[24:25], v[112:115]
    v_mfma_f32_16x16x16_bf16 v[120:123], v[224:225], v[26:27], v[120:123]
    v_mfma_f32_16x16x16_bf16 v[116:119], v[226:227], v[24:25], v[116:119]
    buffer_load_dwordx4 v1, s[8:11], s57 offen offset:1024 sc1 lds
    v_mfma_f32_16x16x16_bf16 v[124:127], v[226:227], v[26:27], v[124:127]
    ds_read_b128 v[248:251], v1 offset:30720
    v_mfma_f32_16x16x32_bf16 v[128:131], v[228:231], v[32:35], v[128:131]
    v_mfma_f32_16x16x32_bf16 v[136:139], v[228:231], v[36:39], v[136:139]
    s_waitcnt lgkmcnt(3)
    ds_read_b128 v[252:255], v1 offset:31744
    v_max_f32 v112, 0, v112
    v_mfma_f32_16x16x32_bf16 v[132:135], v[232:235], v[32:35], v[132:135]
    s_waitcnt vmcnt(11)
    s_barrier
    v_mfma_f32_16x16x32_bf16 v[140:143], v[232:235], v[36:39], v[140:143]
    ds_read_b128 v[224:227], v1 offset:32768
    v_max_f32 v113, 0, v113
    v_mfma_f32_16x16x32_bf16 v[128:131], v[236:239], v[40:43], v[128:131]
    buffer_load_dwordx4 v1, s[8:11], s57 offen offset:2048 sc1 lds
    v_mfma_f32_16x16x32_bf16 v[136:139], v[236:239], v[44:47], v[136:139]
    s_waitcnt lgkmcnt(3)
    ds_read_b128 v[228:231], v1 offset:33792
    v_max_f32 v114, 0, v114
    v_mfma_f32_16x16x32_bf16 v[132:135], v[240:243], v[40:43], v[132:135]
    v_max_f32 v115, 0, v115
    v_mul_f32 v112, v112, v116
    v_mfma_f32_16x16x32_bf16 v[140:143], v[240:243], v[44:47], v[140:143]
    ds_read_b128 v[232:235], v1 offset:34816
    v_mul_f32 v113, v113, v117
    v_mfma_f32_16x16x32_bf16 v[128:131], v[244:247], v[48:51], v[128:131]
    v_mul_f32 v114, v114, v118
    v_mul_f32 v115, v115, v119
    v_mfma_f32_16x16x32_bf16 v[136:139], v[244:247], v[52:55], v[136:139]
    s_waitcnt lgkmcnt(3)
    ds_read_b128 v[236:239], v1 offset:35840
    v_cvt_pk_bf16_f32 v116, v112, v113
    v_mfma_f32_16x16x32_bf16 v[132:135], v[248:251], v[48:51], v[132:135]
    buffer_load_dwordx4 v1, s[8:11], s57 offen offset:3072 sc1 lds
    v_mfma_f32_16x16x32_bf16 v[140:143], v[248:251], v[52:55], v[140:143]
    ds_read_b128 v[240:243], v1 offset:36864
    v_cvt_pk_bf16_f32 v117, v114, v115
    v_mfma_f32_16x16x32_bf16 v[128:131], v[252:255], v[56:59], v[128:131]
    v_max_f32 v120, 0, v120
    v_max_f32 v121, 0, v121
    v_mfma_f32_16x16x32_bf16 v[136:139], v[252:255], v[60:63], v[136:139]
    s_waitcnt lgkmcnt(3)
    ds_read2st64_b32 v[244:245], v21 offset0:148 offset1:149
    ds_read2st64_b32 v[246:247], v21 offset0:150 offset1:151
    v_mfma_f32_16x16x32_bf16 v[132:135], v[224:227], v[56:59], v[132:135]
    v_max_f32 v122, 0, v122
    v_max_f32 v123, 0, v123
    v_mfma_f32_16x16x32_bf16 v[140:143], v[224:227], v[60:63], v[140:143]
    s_add_u32 s57, s36, 229376
    ds_read_b128 v[248:251], v1 offset:38912
    s_add_u32 m0, s96, 98304
    v_mfma_f32_16x16x32_bf16 v[128:131], v[228:231], v[64:67], v[128:131]
    buffer_load_dwordx4 v1, s[8:11], s57 offen offset:0 sc1 lds
    v_mfma_f32_16x16x32_bf16 v[136:139], v[228:231], v[68:71], v[136:139]
    s_waitcnt lgkmcnt(4)
    ds_read_b128 v[252:255], v1 offset:39936
    v_mul_f32 v120, v120, v124
    v_mfma_f32_16x16x32_bf16 v[132:135], v[232:235], v[64:67], v[132:135]
    v_mul_f32 v121, v121, v125
    v_mul_f32 v122, v122, v126
    v_mfma_f32_16x16x32_bf16 v[140:143], v[232:235], v[68:71], v[140:143]
    ds_read_b128 v[224:227], v1 offset:40960
    v_mul_f32 v123, v123, v127
    v_mfma_f32_16x16x32_bf16 v[128:131], v[236:239], v[72:75], v[128:131]
    v_cvt_pk_bf16_f32 v118, v120, v121
    v_cvt_pk_bf16_f32 v119, v122, v123
    v_mfma_f32_16x16x32_bf16 v[136:139], v[236:239], v[76:79], v[136:139]
    s_waitcnt lgkmcnt(3)
    ds_read_b128 v[228:231], v1 offset:41984
    s_add_u32 s59, s33, 262144
    v_mfma_f32_16x16x32_bf16 v[132:135], v[240:243], v[72:75], v[132:135]
    buffer_load_dwordx4 v1, s[8:11], s57 offen offset:1024 sc1 lds
    v_mfma_f32_16x16x32_bf16 v[140:143], v[240:243], v[76:79], v[140:143]
    ds_read_b128 v[232:235], v1 offset:43008
    v_mfma_f32_16x16x16_bf16 v[128:131], v[244:245], v[24:25], v[128:131]
    v_permlane16_swap_b32 v116, v118
    v_mfma_f32_16x16x16_bf16 v[136:139], v[244:245], v[26:27], v[136:139]
    v_permlane16_swap_b32 v117, v119
    v_mfma_f32_16x16x16_bf16 v[132:135], v[246:247], v[24:25], v[132:135]
    buffer_store_dwordx4 v[116:119], v1, s[8:11], s59 offen sc1
    v_mfma_f32_16x16x16_bf16 v[140:143], v[246:247], v[26:27], v[140:143]
    s_waitcnt lgkmcnt(3)
    ds_read_b128 v[236:239], v1 offset:44032
    v_mfma_f32_16x16x32_bf16 v[144:147], v[248:251], v[32:35], v[144:147]
    v_max_f32 v128, 0, v128
    v_max_f32 v129, 0, v129
    v_mfma_f32_16x16x32_bf16 v[152:155], v[248:251], v[36:39], v[152:155]
    ds_read_b128 v[240:243], v1 offset:45056
    v_max_f32 v130, 0, v130
    v_mfma_f32_16x16x32_bf16 v[148:151], v[252:255], v[32:35], v[148:151]
    v_max_f32 v131, 0, v131
    v_mfma_f32_16x16x32_bf16 v[156:159], v[252:255], v[36:39], v[156:159]
    s_waitcnt lgkmcnt(3)
    ds_read_b128 v[244:247], v1 offset:46080
    v_mul_f32 v128, v128, v132
    v_mfma_f32_16x16x32_bf16 v[144:147], v[224:227], v[40:43], v[144:147]
    v_mul_f32 v129, v129, v133
    v_mfma_f32_16x16x32_bf16 v[152:155], v[224:227], v[44:47], v[152:155]
    ds_read_b128 v[248:251], v1 offset:47104
    v_mul_f32 v130, v130, v134
    v_mfma_f32_16x16x32_bf16 v[148:151], v[228:231], v[40:43], v[148:151]
    v_mul_f32 v131, v131, v135
    v_mfma_f32_16x16x32_bf16 v[156:159], v[228:231], v[44:47], v[156:159]
    s_waitcnt lgkmcnt(3)
    ds_read_b128 v[252:255], v1 offset:48128
    v_cvt_pk_bf16_f32 v132, v128, v129
    v_mfma_f32_16x16x32_bf16 v[144:147], v[232:235], v[48:51], v[144:147]
    s_waitcnt vmcnt(12)
    s_barrier
    v_mfma_f32_16x16x32_bf16 v[152:155], v[232:235], v[52:55], v[152:155]
    ds_read_b128 v[224:227], v1 offset:49152
    v_cvt_pk_bf16_f32 v133, v130, v131
    v_mfma_f32_16x16x32_bf16 v[148:151], v[236:239], v[48:51], v[148:151]
    v_max_f32 v136, 0, v136
    v_max_f32 v137, 0, v137
    v_mfma_f32_16x16x32_bf16 v[156:159], v[236:239], v[52:55], v[156:159]
    s_waitcnt lgkmcnt(3)
    ds_read_b128 v[228:231], v1 offset:50176
    v_max_f32 v138, 0, v138
    v_mfma_f32_16x16x32_bf16 v[144:147], v[240:243], v[56:59], v[144:147]
    v_max_f32 v139, 0, v139
    v_mul_f32 v136, v136, v140
    v_mfma_f32_16x16x32_bf16 v[152:155], v[240:243], v[60:63], v[152:155]
    ds_read2st64_b32 v[232:233], v21 offset0:200 offset1:201
    ds_read2st64_b32 v[234:235], v21 offset0:202 offset1:203
    v_mfma_f32_16x16x32_bf16 v[148:151], v[244:247], v[56:59], v[148:151]
    v_mul_f32 v137, v137, v141
    v_mul_f32 v138, v138, v142
    v_mfma_f32_16x16x32_bf16 v[156:159], v[244:247], v[60:63], v[156:159]
    s_waitcnt lgkmcnt(4)
    ds_read_b128 v[236:239], v1 offset:52224
    v_mul_f32 v139, v139, v143
    v_mfma_f32_16x16x32_bf16 v[144:147], v[248:251], v[64:67], v[144:147]
    v_cvt_pk_bf16_f32 v134, v136, v137
    v_mfma_f32_16x16x32_bf16 v[152:155], v[248:251], v[68:71], v[152:155]
    ds_read_b128 v[240:243], v1 offset:53248
    v_cvt_pk_bf16_f32 v135, v138, v139
    v_mfma_f32_16x16x32_bf16 v[148:151], v[252:255], v[64:67], v[148:151]
    s_add_u32 s59, s59, s65
    v_mfma_f32_16x16x32_bf16 v[156:159], v[252:255], v[68:71], v[156:159]
    s_waitcnt lgkmcnt(4)
    ds_read_b128 v[244:247], v1 offset:54272
    v_mfma_f32_16x16x32_bf16 v[144:147], v[224:227], v[72:75], v[144:147]
    v_permlane16_swap_b32 v132, v134
    v_mfma_f32_16x16x32_bf16 v[152:155], v[224:227], v[76:79], v[152:155]
    ds_read_b128 v[248:251], v1 offset:55296
    v_mfma_f32_16x16x32_bf16 v[148:151], v[228:231], v[72:75], v[148:151]
    v_permlane16_swap_b32 v133, v135
    v_mfma_f32_16x16x32_bf16 v[156:159], v[228:231], v[76:79], v[156:159]
    s_waitcnt lgkmcnt(3)
    ds_read_b128 v[252:255], v1 offset:56320
    v_mfma_f32_16x16x16_bf16 v[144:147], v[232:233], v[24:25], v[144:147]
    buffer_store_dwordx4 v[132:135], v1, s[8:11], s59 offen sc1
    v_mfma_f32_16x16x16_bf16 v[152:155], v[232:233], v[26:27], v[152:155]
    v_mfma_f32_16x16x16_bf16 v[148:151], v[234:235], v[24:25], v[148:151]
    v_mfma_f32_16x16x16_bf16 v[156:159], v[234:235], v[26:27], v[156:159]
    ds_read_b128 v[224:227], v1 offset:57344
    v_mfma_f32_16x16x32_bf16 v[160:163], v[236:239], v[32:35], v[160:163]
    v_mfma_f32_16x16x32_bf16 v[168:171], v[236:239], v[36:39], v[168:171]
    s_waitcnt lgkmcnt(3)
    ds_read_b128 v[228:231], v1 offset:58368
    v_max_f32 v144, 0, v144
    v_mfma_f32_16x16x32_bf16 v[164:167], v[240:243], v[32:35], v[164:167]
    v_max_f32 v145, 0, v145
    v_max_f32 v146, 0, v146
    v_mfma_f32_16x16x32_bf16 v[172:175], v[240:243], v[36:39], v[172:175]
    ds_read_b128 v[232:235], v1 offset:59392
    v_max_f32 v147, 0, v147
    v_mfma_f32_16x16x32_bf16 v[160:163], v[244:247], v[40:43], v[160:163]
    v_mul_f32 v144, v144, v148
    v_mul_f32 v145, v145, v149
    v_mfma_f32_16x16x32_bf16 v[168:171], v[244:247], v[44:47], v[168:171]
    s_waitcnt lgkmcnt(3)
    ds_read_b128 v[236:239], v1 offset:60416
    v_mul_f32 v146, v146, v150
    v_mfma_f32_16x16x32_bf16 v[164:167], v[248:251], v[40:43], v[164:167]
    v_mul_f32 v147, v147, v151
    v_mfma_f32_16x16x32_bf16 v[172:175], v[248:251], v[44:47], v[172:175]
    ds_read_b128 v[240:243], v1 offset:61440
    v_cvt_pk_bf16_f32 v148, v144, v145
    v_mfma_f32_16x16x32_bf16 v[160:163], v[252:255], v[48:51], v[160:163]
    v_cvt_pk_bf16_f32 v149, v146, v147
    v_mfma_f32_16x16x32_bf16 v[168:171], v[252:255], v[52:55], v[168:171]
    s_waitcnt lgkmcnt(3)
    ds_read_b128 v[244:247], v1 offset:62464
    v_max_f32 v152, 0, v152
    v_mfma_f32_16x16x32_bf16 v[164:167], v[224:227], v[48:51], v[164:167]
    v_max_f32 v153, 0, v153
    v_mfma_f32_16x16x32_bf16 v[172:175], v[224:227], v[52:55], v[172:175]
    ds_read_b128 v[248:251], v1 offset:63488
    v_max_f32 v154, 0, v154
    v_mfma_f32_16x16x32_bf16 v[160:163], v[228:231], v[56:59], v[160:163]
    v_max_f32 v155, 0, v155
    v_mul_f32 v152, v152, v156
    v_mfma_f32_16x16x32_bf16 v[168:171], v[228:231], v[60:63], v[168:171]
    s_waitcnt lgkmcnt(3)
    ds_read2st64_b32 v[252:253], v21 offset0:252 offset1:253
    ds_read2st64_b32 v[254:255], v21 offset0:254 offset1:255
    v_mfma_f32_16x16x32_bf16 v[164:167], v[232:235], v[56:59], v[164:167]
    s_waitcnt vmcnt(8)
    s_barrier
    v_mfma_f32_16x16x32_bf16 v[172:175], v[232:235], v[60:63], v[172:175]
    ds_read_b128 v[224:227], v2 offset:0
    v_mul_f32 v153, v153, v157
    v_mfma_f32_16x16x32_bf16 v[160:163], v[236:239], v[64:67], v[160:163]
    v_mul_f32 v154, v154, v158
    v_mul_f32 v155, v155, v159
    v_mfma_f32_16x16x32_bf16 v[168:171], v[236:239], v[68:71], v[168:171]
    s_waitcnt lgkmcnt(4)
    ds_read_b128 v[228:231], v2 offset:1024
    v_cvt_pk_bf16_f32 v150, v152, v153
    v_mfma_f32_16x16x32_bf16 v[164:167], v[240:243], v[64:67], v[164:167]
    v_cvt_pk_bf16_f32 v151, v154, v155
    s_add_u32 s59, s59, s65
    v_mfma_f32_16x16x32_bf16 v[172:175], v[240:243], v[68:71], v[172:175]
    ds_read_b128 v[232:235], v2 offset:2048
    v_mfma_f32_16x16x32_bf16 v[160:163], v[244:247], v[72:75], v[160:163]
    v_permlane16_swap_b32 v148, v150
    v_mfma_f32_16x16x32_bf16 v[168:171], v[244:247], v[76:79], v[168:171]
    s_waitcnt lgkmcnt(3)
    ds_read_b128 v[236:239], v2 offset:3072
    v_mfma_f32_16x16x32_bf16 v[164:167], v[248:251], v[72:75], v[164:167]
    v_permlane16_swap_b32 v149, v151
    v_mfma_f32_16x16x32_bf16 v[172:175], v[248:251], v[76:79], v[172:175]
    ds_read_b128 v[240:243], v2 offset:4096
    v_mfma_f32_16x16x16_bf16 v[160:163], v[252:253], v[24:25], v[160:163]
    buffer_store_dwordx4 v[148:151], v1, s[8:11], s59 offen
    v_mfma_f32_16x16x16_bf16 v[168:171], v[252:253], v[26:27], v[168:171]
    v_mfma_f32_16x16x16_bf16 v[164:167], v[254:255], v[24:25], v[164:167]
    s_nop 0
    v_mfma_f32_16x16x16_bf16 v[172:175], v[254:255], v[26:27], v[172:175]
    s_waitcnt lgkmcnt(3)
    ds_read_b128 v[244:247], v2 offset:5120
    v_mfma_f32_16x16x32_bf16 v[176:179], v[224:227], v[32:35], v[176:179]
    v_mfma_f32_16x16x32_bf16 v[184:187], v[224:227], v[36:39], v[184:187]
    ds_read_b128 v[248:251], v2 offset:6144
    v_max_f32 v160, 0, v160
    v_mfma_f32_16x16x32_bf16 v[180:183], v[228:231], v[32:35], v[180:183]
    v_max_f32 v161, 0, v161
    v_max_f32 v162, 0, v162
    v_mfma_f32_16x16x32_bf16 v[188:191], v[228:231], v[36:39], v[188:191]
    s_waitcnt lgkmcnt(3)
    ds_read_b128 v[252:255], v2 offset:7168
    v_max_f32 v163, 0, v163
    v_mfma_f32_16x16x32_bf16 v[176:179], v[232:235], v[40:43], v[176:179]
    v_mul_f32 v160, v160, v164
    v_mul_f32 v161, v161, v165
    v_mfma_f32_16x16x32_bf16 v[184:187], v[232:235], v[44:47], v[184:187]
    ds_read_b128 v[224:227], v2 offset:8192
    v_mul_f32 v162, v162, v166
    v_mfma_f32_16x16x32_bf16 v[180:183], v[236:239], v[40:43], v[180:183]
    v_mul_f32 v163, v163, v167
    v_mfma_f32_16x16x32_bf16 v[188:191], v[236:239], v[44:47], v[188:191]
    s_waitcnt lgkmcnt(3)
    ds_read_b128 v[228:231], v2 offset:9216
    v_cvt_pk_bf16_f32 v164, v160, v161
    v_mfma_f32_16x16x32_bf16 v[176:179], v[240:243], v[48:51], v[176:179]
    v_cvt_pk_bf16_f32 v165, v162, v163
    v_mfma_f32_16x16x32_bf16 v[184:187], v[240:243], v[52:55], v[184:187]
    ds_read_b128 v[232:235], v2 offset:10240
    v_max_f32 v168, 0, v168
    v_mfma_f32_16x16x32_bf16 v[180:183], v[244:247], v[48:51], v[180:183]
    v_max_f32 v169, 0, v169
    v_mfma_f32_16x16x32_bf16 v[188:191], v[244:247], v[52:55], v[188:191]
    s_waitcnt lgkmcnt(3)
    ds_read_b128 v[236:239], v2 offset:11264
    v_max_f32 v170, 0, v170
    v_mfma_f32_16x16x32_bf16 v[176:179], v[248:251], v[56:59], v[176:179]
    v_max_f32 v171, 0, v171
    v_mul_f32 v168, v168, v172
    v_mfma_f32_16x16x32_bf16 v[184:187], v[248:251], v[60:63], v[184:187]
    ds_read2st64_b32 v[240:241], v22 offset0:48 offset1:49
    ds_read2st64_b32 v[242:243], v22 offset0:50 offset1:51
    v_mfma_f32_16x16x32_bf16 v[180:183], v[252:255], v[56:59], v[180:183]
    v_mul_f32 v169, v169, v173
    v_mul_f32 v170, v170, v174
    v_mfma_f32_16x16x32_bf16 v[188:191], v[252:255], v[60:63], v[188:191]
    s_waitcnt lgkmcnt(4)
    ds_read_b128 v[244:247], v2 offset:13312
    s_add_u32 s12, s26, 9
    v_mfma_f32_16x16x32_bf16 v[176:179], v[224:227], v[64:67], v[176:179]
    v_mov_b32 v20, s12
    s_waitcnt vmcnt(0)
    v_mfma_f32_16x16x32_bf16 v[184:187], v[224:227], v[68:71], v[184:187]
    ds_read_b128 v[248:251], v2 offset:14336
    v_mul_f32 v171, v171, v175
    v_mfma_f32_16x16x32_bf16 v[180:183], v[228:231], v[64:67], v[180:183]
    s_cmp_lg_u32 s27, 0
    s_cbranch_scc1 L_slow_66
    buffer_store_dword v20, v5, s[8:11], s45 offen
L_sig_67:
    v_mfma_f32_16x16x32_bf16 v[188:191], v[228:231], v[68:71], v[188:191]
    s_waitcnt lgkmcnt(4)
    ds_read_b128 v[252:255], v2 offset:15360
    v_cvt_pk_bf16_f32 v166, v168, v169
    v_mfma_f32_16x16x32_bf16 v[176:179], v[232:235], v[72:75], v[176:179]
    s_barrier
    v_mfma_f32_16x16x32_bf16 v[184:187], v[232:235], v[76:79], v[184:187]
    ds_read_b128 v[224:227], v2 offset:16384
    v_cvt_pk_bf16_f32 v167, v170, v171
    v_mfma_f32_16x16x32_bf16 v[180:183], v[236:239], v[72:75], v[180:183]
    s_add_u32 s59, s59, s65
    v_permlane16_swap_b32 v164, v166
    v_mfma_f32_16x16x32_bf16 v[188:191], v[236:239], v[76:79], v[188:191]
    s_waitcnt lgkmcnt(3)
    ds_read_b128 v[228:231], v2 offset:17408
    v_mfma_f32_16x16x16_bf16 v[176:179], v[240:241], v[24:25], v[176:179]
    v_permlane16_swap_b32 v165, v167
    v_mfma_f32_16x16x16_bf16 v[184:187], v[240:241], v[26:27], v[184:187]
    buffer_store_dwordx4 v[164:167], v1, s[8:11], s59 offen sc1
    v_mfma_f32_16x16x16_bf16 v[180:183], v[242:243], v[24:25], v[180:183]
    v_mfma_f32_16x16x16_bf16 v[188:191], v[242:243], v[26:27], v[188:191]
    ds_read_b128 v[232:235], v2 offset:18432
    v_mfma_f32_16x16x32_bf16 v[192:195], v[244:247], v[32:35], v[192:195]
    v_mfma_f32_16x16x32_bf16 v[200:203], v[244:247], v[36:39], v[200:203]
    s_waitcnt lgkmcnt(3)
    ds_read_b128 v[236:239], v2 offset:19456
    v_max_f32 v176, 0, v176
    v_mfma_f32_16x16x32_bf16 v[196:199], v[248:251], v[32:35], v[196:199]
    v_max_f32 v177, 0, v177
    v_max_f32 v178, 0, v178
    v_mfma_f32_16x16x32_bf16 v[204:207], v[248:251], v[36:39], v[204:207]
    ds_read_b128 v[240:243], v2 offset:20480
    v_max_f32 v179, 0, v179
    v_mfma_f32_16x16x32_bf16 v[192:195], v[252:255], v[40:43], v[192:195]
    v_mul_f32 v176, v176, v180
    v_mul_f32 v177, v177, v181
    v_mfma_f32_16x16x32_bf16 v[200:203], v[252:255], v[44:47], v[200:203]
    s_waitcnt lgkmcnt(3)
    ds_read_b128 v[244:247], v2 offset:21504
    v_mul_f32 v178, v178, v182
    v_mfma_f32_16x16x32_bf16 v[196:199], v[224:227], v[40:43], v[196:199]
    v_mul_f32 v179, v179, v183
    v_mfma_f32_16x16x32_bf16 v[204:207], v[224:227], v[44:47], v[204:207]
    ds_read_b128 v[248:251], v2 offset:22528
    v_cvt_pk_bf16_f32 v180, v176, v177
    v_mfma_f32_16x16x32_bf16 v[192:195], v[228:231], v[48:51], v[192:195]
    v_cvt_pk_bf16_f32 v181, v178, v179
    v_mfma_f32_16x16x32_bf16 v[200:203], v[228:231], v[52:55], v[200:203]
    s_waitcnt lgkmcnt(3)
    ds_read_b128 v[252:255], v2 offset:23552
    v_max_f32 v184, 0, v184
    v_mfma_f32_16x16x32_bf16 v[196:199], v[232:235], v[48:51], v[196:199]
    v_max_f32 v185, 0, v185
    v_mfma_f32_16x16x32_bf16 v[204:207], v[232:235], v[52:55], v[204:207]
    ds_read_b128 v[224:227], v2 offset:24576
    v_max_f32 v186, 0, v186
    v_mfma_f32_16x16x32_bf16 v[192:195], v[236:239], v[56:59], v[192:195]
    v_max_f32 v187, 0, v187
    v_mul_f32 v184, v184, v188
    v_mfma_f32_16x16x32_bf16 v[200:203], v[236:239], v[60:63], v[200:203]
    s_waitcnt lgkmcnt(3)
    ds_read2st64_b32 v[228:229], v22 offset0:100 offset1:101
    ds_read2st64_b32 v[230:231], v22 offset0:102 offset1:103
    v_mfma_f32_16x16x32_bf16 v[196:199], v[240:243], v[56:59], v[196:199]
    v_mul_f32 v185, v185, v189
    v_mul_f32 v186, v186, v190
    v_mfma_f32_16x16x32_bf16 v[204:207], v[240:243], v[60:63], v[204:207]
    ds_read_b128 v[232:235], v2 offset:26624
    v_mul_f32 v187, v187, v191
    v_mfma_f32_16x16x32_bf16 v[192:195], v[244:247], v[64:67], v[192:195]
    v_cvt_pk_bf16_f32 v182, v184, v185
    v_mfma_f32_16x16x32_bf16 v[200:203], v[244:247], v[68:71], v[200:203]
    s_waitcnt lgkmcnt(4)
    ds_read_b128 v[236:239], v2 offset:27648
    v_cvt_pk_bf16_f32 v183, v186, v187
    v_mfma_f32_16x16x32_bf16 v[196:199], v[248:251], v[64:67], v[196:199]
    s_add_u32 s59, s59, s65
    buffer_load_dword v19, v6, s[8:11], s44 offen nt
    v_mfma_f32_16x16x32_bf16 v[204:207], v[248:251], v[68:71], v[204:207]
    ds_read_b128 v[240:243], v2 offset:28672
    v_mfma_f32_16x16x32_bf16 v[192:195], v[252:255], v[72:75], v[192:195]
    v_permlane16_swap_b32 v180, v182
    v_mfma_f32_16x16x32_bf16 v[200:203], v[252:255], v[76:79], v[200:203]
    s_waitcnt lgkmcnt(3)
    ds_read_b128 v[244:247], v2 offset:29696
    v_mfma_f32_16x16x32_bf16 v[196:199], v[224:227], v[72:75], v[196:199]
    v_permlane16_swap_b32 v181, v183
    v_mfma_f32_16x16x32_bf16 v[204:207], v[224:227], v[76:79], v[204:207]
    ds_read_b128 v[248:251], v2 offset:30720
    v_mfma_f32_16x16x16_bf16 v[192:195], v[228:229], v[24:25], v[192:195]
    buffer_store_dwordx4 v[180:183], v1, s[8:11], s59 offen sc1
    v_mfma_f32_16x16x16_bf16 v[200:203], v[228:229], v[26:27], v[200:203]
    v_mfma_f32_16x16x16_bf16 v[196:199], v[230:231], v[24:25], v[196:199]
    s_nop 0
    v_mfma_f32_16x16x16_bf16 v[204:207], v[230:231], v[26:27], v[204:207]
    s_waitcnt lgkmcnt(3)
    ds_read_b128 v[252:255], v2 offset:31744
    v_mfma_f32_16x16x32_bf16 v[208:211], v[232:235], v[32:35], v[208:211]
    v_mfma_f32_16x16x32_bf16 v[216:219], v[232:235], v[36:39], v[216:219]
    s_add_u32 s3, s26, 9
    ds_read_b128 v[224:227], v2 offset:32768
    s_waitcnt vmcnt(1)
    v_mfma_f32_16x16x32_bf16 v[212:215], v[236:239], v[32:35], v[212:215]
    v_subrev_u32 v19, s3, v19
    v_cmp_lt_u32 vcc, 15, v19
    v_mfma_f32_16x16x32_bf16 v[220:223], v[236:239], v[36:39], v[220:223]
    s_waitcnt lgkmcnt(3)
    ds_read_b128 v[228:231], v2 offset:33792
    v_max_f32 v192, 0, v192
    v_mfma_f32_16x16x32_bf16 v[208:211], v[240:243], v[40:43], v[208:211]
    s_and_b64 vcc, vcc, s[42:43]
    s_or_b64 vcc, vcc, s[0:1]
    s_cbranch_scc1 L_cspin_64
L_cback_65:
    v_mfma_f32_16x16x32_bf16 v[216:219], v[240:243], v[44:47], v[216:219]
    s_add_u32 s56, s68, 266240
    ds_read_b128 v[232:235], v2 offset:34816
    v_max_f32 v193, 0, v193
    v_mfma_f32_16x16x32_bf16 v[212:215], v[244:247], v[40:43], v[212:215]
    buffer_load_dwordx4 v[80:83], v4, s[8:11], s56 offen offset:0 sc1
    v_mfma_f32_16x16x32_bf16 v[220:223], v[244:247], v[44:47], v[220:223]
    s_waitcnt lgkmcnt(3)
    ds_read_b128 v[236:239], v2 offset:35840
    v_max_f32 v194, 0, v194
    v_mfma_f32_16x16x32_bf16 v[208:211], v[248:251], v[48:51], v[208:211]
    buffer_load_dwordx4 v[84:87], v4, s[8:11], s56 offen offset:2048 sc1
    v_mfma_f32_16x16x32_bf16 v[216:219], v[248:251], v[52:55], v[216:219]
    s_add_u32 s56, s68, 270336
    ds_read_b128 v[240:243], v2 offset:36864
    v_max_f32 v195, 0, v195
    v_mfma_f32_16x16x32_bf16 v[212:215], v[252:255], v[48:51], v[212:215]
    buffer_load_dwordx4 v[88:91], v4, s[8:11], s56 offen offset:0 sc1
    v_mfma_f32_16x16x32_bf16 v[220:223], v[252:255], v[52:55], v[220:223]
    s_waitcnt lgkmcnt(3)
    ds_read_b128 v[244:247], v2 offset:37888
    v_mul_f32 v192, v192, v196
    v_mfma_f32_16x16x32_bf16 v[208:211], v[224:227], v[56:59], v[208:211]
    v_mul_f32 v193, v193, v197
    v_mul_f32 v194, v194, v198
    v_mfma_f32_16x16x32_bf16 v[216:219], v[224:227], v[60:63], v[216:219]
    s_add_u32 s56, s68, 280576
    ds_read2st64_b32 v[248:249], v22 offset0:152 offset1:153
    ds_read2st64_b32 v[250:251], v22 offset0:154 offset1:155
    v_mfma_f32_16x16x32_bf16 v[212:215], v[228:231], v[56:59], v[212:215]
    buffer_load_dwordx4 v[92:95], v4, s[8:11], s56 offen offset:0 sc1
    v_mfma_f32_16x16x32_bf16 v[220:223], v[228:231], v[60:63], v[220:223]
    s_waitcnt lgkmcnt(4)
    s_add_u32 s12, s26, 10
    v_mov_b32 v20, s12
    v_mfma_f32_16x16x32_bf16 v[208:211], v[232:235], v[64:67], v[208:211]
    s_waitcnt vmcnt(4)
    v_mul_f32 v195, v195, v199
    v_cvt_pk_bf16_f32 v196, v192, v193
    v_mfma_f32_16x16x32_bf16 v[216:219], v[232:235], v[68:71], v[216:219]
    s_cmp_lg_u32 s27, 0
    s_cbranch_scc1 L_slow_68
    buffer_store_dword v20, v5, s[8:11], s45 offen
L_sig_69:
    v_mfma_f32_16x16x32_bf16 v[212:215], v[236:239], v[64:67], v[212:215]
    buffer_load_dwordx4 v[96:99], v4, s[8:11], s56 offen offset:2048 sc1
    v_cvt_pk_bf16_f32 v197, v194, v195
    v_mfma_f32_16x16x32_bf16 v[220:223], v[236:239], v[68:71], v[220:223]
    s_waitcnt lgkmcnt(2)
    v_max_f32 v200, 0, v200
    v_max_f32 v201, 0, v201
    v_mfma_f32_16x16x32_bf16 v[208:211], v[240:243], v[72:75], v[208:211]
    v_max_f32 v202, 0, v202
    v_max_f32 v203, 0, v203
    v_mfma_f32_16x16x32_bf16 v[216:219], v[240:243], v[76:79], v[216:219]
    s_add_u32 s56, s68, 284672
    v_mul_f32 v200, v200, v204
    v_mul_f32 v201, v201, v205
    v_mfma_f32_16x16x32_bf16 v[212:215], v[244:247], v[72:75], v[212:215]
    buffer_load_dwordx4 v[100:103], v4, s[8:11], s56 offen offset:0 sc1
    v_mfma_f32_16x16x32_bf16 v[220:223], v[244:247], v[76:79], v[220:223]
    s_waitcnt lgkmcnt(0)
    v_mul_f32 v202, v202, v206
    v_mul_f32 v203, v203, v207
    v_mfma_f32_16x16x16_bf16 v[208:211], v[248:249], v[24:25], v[208:211]
    v_cvt_pk_bf16_f32 v198, v200, v201
    v_cvt_pk_bf16_f32 v199, v202, v203
    v_mfma_f32_16x16x16_bf16 v[216:219], v[248:249], v[26:27], v[216:219]
    s_add_u32 s59, s59, s65
    v_permlane16_swap_b32 v196, v198
    v_mfma_f32_16x16x16_bf16 v[212:215], v[250:251], v[24:25], v[212:215]
    v_permlane16_swap_b32 v197, v199
    v_mfma_f32_16x16x16_bf16 v[220:223], v[250:251], v[26:27], v[220:223]
    buffer_store_dwordx4 v[196:199], v1, s[8:11], s59 offen sc1
    v_max_f32 v208, 0, v208
    v_max_f32 v209, 0, v209
    v_max_f32 v210, 0, v210
    v_max_f32 v211, 0, v211
    s_nop 0
    v_pk_mul_f32 v[208:209], v[208:209], v[212:213]
    v_pk_mul_f32 v[210:211], v[210:211], v[214:215]
    v_cvt_pk_bf16_f32 v212, v208, v209
    v_cvt_pk_bf16_f32 v213, v210, v211
    v_max_f32 v216, 0, v216
    v_max_f32 v217, 0, v217
    v_max_f32 v218, 0, v218
    v_max_f32 v219, 0, v219
    v_pk_mul_f32 v[216:217], v[216:217], v[220:221]
    v_pk_mul_f32 v[218:219], v[218:219], v[222:223]
    v_cvt_pk_bf16_f32 v214, v216, v217
    v_cvt_pk_bf16_f32 v215, v218, v219
    s_add_u32 s59, s59, s65
    v_permlane16_swap_b32 v212, v214
    v_permlane16_swap_b32 v213, v215
    buffer_store_dwordx4 v[212:215], v1, s[8:11], s59 offen sc1
L_dn1:
    s_add_u32 s56, s69, 266240
    buffer_load_dwordx4 v[104:107], v4, s[8:11], s56 offen offset:0 sc1
    buffer_load_dwordx4 v[108:111], v4, s[8:11], s56 offen offset:2048 sc1
    s_waitcnt vmcnt(10)
    v_mfma_f32_16x16x32_bf16 v[32:35], a[32:35], v[80:83], 0
    s_add_u32 s56, s69, 270336
    buffer_load_dwordx4 v[112:115], v4, s[8:11], s56 offen offset:0 sc1
    v_mfma_f32_16x16x32_bf16 v[36:39], a[36:39], v[80:83], 0
    v_mfma_f32_16x16x32_bf16 v[40:43], a[40:43], v[80:83], 0
    v_mfma_f32_16x16x32_bf16 v[44:47], a[44:47], v[80:83], 0
    s_waitcnt vmcnt(10)
    v_mfma_f32_16x16x32_bf16 v[32:35], a[48:51], v[84:87], v[32:35]
    s_add_u32 s56, s69, 280576
    buffer_load_dwordx4 v[116:119], v4, s[8:11], s56 offen offset:0 sc1
    v_mfma_f32_16x16x32_bf16 v[36:39], a[52:55], v[84:87], v[36:39]
    v_mfma_f32_16x16x32_bf16 v[40:43], a[56:59], v[84:87], v[40:43]
    v_mfma_f32_16x16x32_bf16 v[44:47], a[60:63], v[84:87], v[44:47]
    s_waitcnt vmcnt(10)
    v_mfma_f32_16x16x32_bf16 v[32:35], a[64:67], v[88:91], v[32:35]
    buffer_load_dwordx4 v[120:123], v4, s[8:11], s56 offen offset:2048 sc1
    v_mfma_f32_16x16x32_bf16 v[36:39], a[68:71], v[88:91], v[36:39]
    v_mfma_f32_16x16x32_bf16 v[40:43], a[72:75], v[88:91], v[40:43]
    v_mfma_f32_16x16x32_bf16 v[44:47], a[76:79], v[88:91], v[44:47]
    s_waitcnt vmcnt(10)
    v_mfma_f32_16x16x32_bf16 v[32:35], a[144:147], v[92:95], v[32:35]
    buffer_load_dword v22, v6, s[8:11], s44 offen nt
    v_mfma_f32_16x16x32_bf16 v[36:39], a[148:151], v[92:95], v[36:39]
    s_add_u32 s56, s69, 284672
    buffer_load_dwordx4 v[124:127], v4, s[8:11], s56 offen offset:0 sc1
    v_mfma_f32_16x16x32_bf16 v[40:43], a[152:155], v[92:95], v[40:43]
    v_mfma_f32_16x16x32_bf16 v[44:47], a[156:159], v[92:95], v[44:47]
    s_waitcnt vmcnt(10)
    v_mfma_f32_16x16x32_bf16 v[32:35], a[160:163], v[96:99], v[32:35]
    s_add_u32 s12, s26, 11
    v_mov_b32 v23, s12
    s_waitcnt vmcnt(7)
    v_mfma_f32_16x16x32_bf16 v[36:39], a[164:167], v[96:99], v[36:39]
    s_add_u32 s56, s70, 266240
    buffer_load_dwordx4 v[128:131], v4, s[8:11], s56 offen offset:0 sc1
    v_mfma_f32_16x16x32_bf16 v[40:43], a[168:171], v[96:99], v[40:43]
    s_cmp_lg_u32 s27, 0
    s_cbranch_scc1 L_slow_74
    buffer_store_dword v23, v5, s[8:11], s45 offen
L_sig_75:
    v_mfma_f32_16x16x32_bf16 v[44:47], a[172:175], v[96:99], v[44:47]
    v_mfma_f32_16x16x32_bf16 v[32:35], a[176:179], v[100:103], v[32:35]
    buffer_load_dwordx4 v[132:135], v4, s[8:11], s56 offen offset:2048 sc1
    v_mfma_f32_16x16x32_bf16 v[36:39], a[180:183], v[100:103], v[36:39]
    v_mfma_f32_16x16x32_bf16 v[40:43], a[184:187], v[100:103], v[40:43]
    v_mfma_f32_16x16x32_bf16 v[44:47], a[188:191], v[100:103], v[44:47]
    s_waitcnt vmcnt(9)
    v_mfma_f32_16x16x32_bf16 v[48:51], a[32:35], v[104:107], 0
    s_add_u32 s56, s70, 270336
    buffer_load_dwordx4 v[136:139], v4, s[8:11], s56 offen offset:0 sc1
    v_mfma_f32_16x16x32_bf16 v[52:55], a[36:39], v[104:107], 0
    v_mfma_f32_16x16x32_bf16 v[56:59], a[40:43], v[104:107], 0
    v_mfma_f32_16x16x32_bf16 v[60:63], a[44:47], v[104:107], 0
    s_waitcnt vmcnt(9)
    v_mfma_f32_16x16x32_bf16 v[48:51], a[48:51], v[108:111], v[48:51]
    s_add_u32 s56, s70, 280576
    buffer_load_dwordx4 v[140:143], v4, s[8:11], s56 offen offset:0 sc1
    v_mfma_f32_16x16x32_bf16 v[52:55], a[52:55], v[108:111], v[52:55]
    v_mfma_f32_16x16x32_bf16 v[56:59], a[56:59], v[108:111], v[56:59]
    v_add_u32 v16, s72, v2
    v_mfma_f32_16x16x32_bf16 v[60:63], a[60:63], v[108:111], v[60:63]
    s_waitcnt vmcnt(9)
    v_mfma_f32_16x16x32_bf16 v[48:51], a[64:67], v[112:115], v[48:51]
    buffer_load_dwordx4 v[80:83], v4, s[8:11], s56 offen offset:2048 sc1
    v_mfma_f32_16x16x32_bf16 v[52:55], a[68:71], v[112:115], v[52:55]
    v_add_u32 v17, s73, v2
    v_mfma_f32_16x16x32_bf16 v[56:59], a[72:75], v[112:115], v[56:59]
    v_add_u32 v18, s74, v2
    v_mfma_f32_16x16x32_bf16 v[60:63], a[76:79], v[112:115], v[60:63]
    s_waitcnt vmcnt(9)
    v_mfma_f32_16x16x32_bf16 v[48:51], a[144:147], v[116:119], v[48:51]
    s_add_u32 s56, s70, 284672
    buffer_load_dwordx4 v[84:87], v4, s[8:11], s56 offen offset:0 sc1
    v_mfma_f32_16x16x32_bf16 v[52:55], a[148:151], v[116:119], v[52:55]
    v_add_u32 v19, s32, v2
    v_mfma_f32_16x16x32_bf16 v[56:59], a[152:155], v[116:119], v[56:59]
    v_mfma_f32_16x16x32_bf16 v[60:63], a[156:159], v[116:119], v[60:63]
    s_waitcnt vmcnt(9)
    s_lshl_b32 s60, s22, 2
    s_add_u32 s60, s60, s20
    v_mfma_f32_16x16x32_bf16 v[48:51], a[160:163], v[120:123], v[48:51]
    s_add_u32 s3, s26, 10
    s_waitcnt vmcnt(8)
    v_subrev_u32 v22, s3, v22
    v_mfma_f32_16x16x32_bf16 v[52:55], a[164:167], v[120:123], v[52:55]
    s_lshl_b32 s60, s60, 6
    s_add_u32 s60, s60, 110592
    v_and_or_b32 v20, v6, 63, s60
    v_mfma_f32_16x16x32_bf16 v[56:59], a[168:171], v[120:123], v[56:59]
    v_cmp_lt_u32 vcc, 15, v22
    ds_read_b32 v20, v20
    v_mfma_f32_16x16x32_bf16 v[60:63], a[172:175], v[120:123], v[60:63]
    s_waitcnt vmcnt(7)
    v_lshlrev_b32 v208, 16, v8
    v_mfma_f32_16x16x32_bf16 v[48:51], a[176:179], v[124:127], v[48:51]
    s_and_b64 vcc, vcc, s[42:43]
    s_or_b64 vcc, vcc, s[0:1]
    s_cbranch_scc1 L_cspin_70
L_cback_71:
    v_mfma_f32_16x16x32_bf16 v[52:55], a[180:183], v[124:127], v[52:55]
    s_add_u32 s56, s68, 264192
    buffer_load_dwordx4 v[88:91], v4, s[8:11], s56 offen offset:0 sc1
    v_mfma_f32_16x16x32_bf16 v[56:59], a[184:187], v[124:127], v[56:59]
    s_add_u32 s56, s68, 272384
    v_and_b32 v209, 0xffff0000, v8
    v_mfma_f32_16x16x32_bf16 v[60:63], a[188:191], v[124:127], v[60:63]
    s_waitcnt vmcnt(7)
    buffer_load_dwordx4 v[92:95], v4, s[8:11], s56 offen offset:0 sc1
    v_mfma_f32_16x16x32_bf16 v[64:67], a[32:35], v[128:131], 0
    s_add_u32 s56, s68, 278528
    v_lshlrev_b32 v210, 16, v9
    v_mfma_f32_16x16x32_bf16 v[68:71], a[36:39], v[128:131], 0
    buffer_load_dwordx4 v[96:99], v4, s[8:11], s56 offen offset:0 sc1
    v_mfma_f32_16x16x32_bf16 v[72:75], a[40:43], v[128:131], 0
    v_and_b32 v211, 0xffff0000, v9
    v_mfma_f32_16x16x32_bf16 v[76:79], a[44:47], v[128:131], 0
    s_waitcnt vmcnt(7)
    v_lshlrev_b32 v212, 16, v10
    v_mfma_f32_16x16x32_bf16 v[64:67], a[48:51], v[132:135], v[64:67]
    s_add_u32 s56, s68, 286720
    buffer_load_dwordx4 v[100:103], v4, s[8:11], s56 offen offset:0 sc1
    v_mfma_f32_16x16x32_bf16 v[68:71], a[52:55], v[132:135], v[68:71]
    v_mfma_f32_16x16x32_bf16 v[72:75], a[56:59], v[132:135], v[72:75]
    v_and_b32 v213, 0xffff0000, v10
    v_mfma_f32_16x16x32_bf16 v[76:79], a[60:63], v[132:135], v[76:79]
    s_waitcnt vmcnt(7)
    v_mfma_f32_16x16x32_bf16 v[64:67], a[64:67], v[136:139], v[64:67]
    s_add_u32 s56, s69, 264192
    buffer_load_dwordx4 v[104:107], v4, s[8:11], s56 offen offset:0 sc1
    v_mfma_f32_16x16x32_bf16 v[68:71], a[68:71], v[136:139], v[68:71]
    v_lshlrev_b32 v214, 16, v11
    v_mfma_f32_16x16x32_bf16 v[72:75], a[72:75], v[136:139], v[72:75]
    v_mfma_f32_16x16x32_bf16 v[76:79], a[76:79], v[136:139], v[76:79]
    s_waitcnt vmcnt(7)
    v_and_b32 v215, 0xffff0000, v11
    v_mfma_f32_16x16x32_bf16 v[64:67], a[144:147], v[140:143], v[64:67]
    buffer_load_dword v22, v6, s[8:11], s44 offen nt
    v_mfma_f32_16x16x32_bf16 v[68:71], a[148:151], v[140:143], v[68:71]
    s_add_u32 s56, s69, 272384
    v_lshlrev_b32 v216, 16, v12
    v_mfma_f32_16x16x32_bf16 v[72:75], a[152:155], v[140:143], v[72:75]
    buffer_load_dwordx4 v[108:111], v4, s[8:11], s56 offen offset:0 sc1
    v_mfma_f32_16x16x32_bf16 v[76:79], a[156:159], v[140:143], v[76:79]
    s_waitcnt vmcnt(8)
    v_mfma_f32_16x16x32_bf16 v[64:67], a[160:163], v[80:83], v[64:67]
    s_add_u32 s56, s69, 278528
    v_and_b32 v217, 0xffff0000, v12
    v_mfma_f32_16x16x32_bf16 v[68:71], a[164:167], v[80:83], v[68:71]
    buffer_load_dwordx4 v[112:115], v4, s[8:11], s56 offen offset:0 sc1
    v_mfma_f32_16x16x32_bf16 v[72:75], a[168:171], v[80:83], v[72:75]
    v_lshlrev_b32 v218, 16, v13
    v_mfma_f32_16x16x32_bf16 v[76:79], a[172:175], v[80:83], v[76:79]
    s_waitcnt vmcnt(8)
    v_mfma_f32_16x16x32_bf16 v[64:67], a[176:179], v[84:87], v[64:67]
    s_add_u32 s56, s69, 286720
    buffer_load_dwordx4 v[116:119], v4, s[8:11], s56 offen offset:0 sc1
    v_mfma_f32_16x16x32_bf16 v[68:71], a[180:183], v[84:87], v[68:71]
    v_and_b32 v219, 0xffff0000, v13
    v_mfma_f32_16x16x32_bf16 v[72:75], a[184:187], v[84:87], v[72:75]
    v_mfma_f32_16x16x32_bf16 v[76:79], a[188:191], v[84:87], v[76:79]
    s_waitcnt vmcnt(8)
    v_lshlrev_b32 v220, 16, v14
    v_mfma_f32_16x16x32_bf16 v[32:35], a[16:19], v[88:91], v[32:35]
    s_add_u32 s56, s70, 264192
    buffer_load_dwordx4 v[120:123], v4, s[8:11], s56 offen offset:0 sc1
    v_mfma_f32_16x16x32_bf16 v[36:39], a[20:23], v[88:91], v[36:39]
    v_and_b32 v221, 0xffff0000, v14
    v_mfma_f32_16x16x32_bf16 v[40:43], a[24:27], v[88:91], v[40:43]
    v_mfma_f32_16x16x32_bf16 v[44:47], a[28:31], v[88:91], v[44:47]
    s_waitcnt vmcnt(8)
    v_mfma_f32_16x16x32_bf16 v[32:35], a[80:83], v[92:95], v[32:35]
    s_add_u32 s56, s70, 272384
    buffer_load_dwordx4 v[124:127], v4, s[8:11], s56 offen offset:0 sc1
    v_mfma_f32_16x16x32_bf16 v[36:39], a[84:87], v[92:95], v[36:39]
    v_lshlrev_b32 v222, 16, v15
    v_mfma_f32_16x16x32_bf16 v[40:43], a[88:91], v[92:95], v[40:43]
    v_and_b32 v223, 0xffff0000, v15
    v_mfma_f32_16x16x32_bf16 v[44:47], a[92:95], v[92:95], v[44:47]
    s_waitcnt vmcnt(8)
    v_mfma_f32_16x16x32_bf16 v[32:35], a[128:131], v[96:99], v[32:35]
    s_add_u32 s56, s70, 278528
    buffer_load_dwordx4 v[128:131], v4, s[8:11], s56 offen offset:0 sc1
    v_mfma_f32_16x16x32_bf16 v[36:39], a[132:135], v[96:99], v[36:39]
    v_mfma_f32_16x16x32_bf16 v[40:43], a[136:139], v[96:99], v[40:43]
    v_mfma_f32_16x16x32_bf16 v[44:47], a[140:143], v[96:99], v[44:47]
    s_waitcnt vmcnt(8)
    v_mfma_f32_16x16x32_bf16 v[32:35], a[192:195], v[100:103], v[32:35]
    s_add_u32 s56, s70, 286720
    buffer_load_dwordx4 v[132:135], v4, s[8:11], s56 offen offset:0 sc1
    v_mfma_f32_16x16x32_bf16 v[36:39], a[196:199], v[100:103], v[36:39]
    v_mfma_f32_16x16x32_bf16 v[40:43], a[200:203], v[100:103], v[40:43]
    v_mfma_f32_16x16x32_bf16 v[44:47], a[204:207], v[100:103], v[44:47]
    s_waitcnt vmcnt(8)
    v_mfma_f32_16x16x32_bf16 v[48:51], a[16:19], v[104:107], v[48:51]
    s_add_u32 s3, s26, 11
    s_waitcnt vmcnt(7)
    v_subrev_u32 v22, s3, v22
    v_mfma_f32_16x16x32_bf16 v[52:55], a[20:23], v[104:107], v[52:55]
    v_cmp_lt_u32 vcc, 15, v22
    v_mfma_f32_16x16x32_bf16 v[56:59], a[24:27], v[104:107], v[56:59]
    s_and_b64 vcc, vcc, s[42:43]
    s_or_b64 vcc, vcc, s[0:1]
    s_cbranch_scc1 L_cspin_72
L_cback_73:
    v_mfma_f32_16x16x32_bf16 v[60:63], a[28:31], v[104:107], v[60:63]
    s_waitcnt vmcnt(6)
    s_add_u32 s56, s68, 262144
    v_mfma_f32_16x16x32_bf16 v[48:51], a[80:83], v[108:111], v[48:51]
    buffer_load_dwordx4 v[136:139], v4, s[8:11], s56 offen offset:0 sc1
    v_mfma_f32_16x16x32_bf16 v[52:55], a[84:87], v[108:111], v[52:55]
    s_add_u32 s56, s68, 274432
    buffer_load_dwordx4 v[140:143], v4, s[8:11], s56 offen offset:0 sc1
    v_mfma_f32_16x16x32_bf16 v[56:59], a[88:91], v[108:111], v[56:59]
    v_mfma_f32_16x16x32_bf16 v[60:63], a[92:95], v[108:111], v[60:63]
    s_waitcnt vmcnt(7)
    v_mfma_f32_16x16x32_bf16 v[48:51], a[128:131], v[112:115], v[48:51]
    buffer_load_dwordx4 v[80:83], v4, s[8:11], s56 offen offset:2048 sc1
    v_mfma_f32_16x16x32_bf16 v[52:55], a[132:135], v[112:115], v[52:55]
    v_mfma_f32_16x16x32_bf16 v[56:59], a[136:139], v[112:115], v[56:59]
    v_mfma_f32_16x16x32_bf16 v[60:63], a[140:143], v[112:115], v[60:63]
    s_waitcnt vmcnt(7)
    v_mfma_f32_16x16x32_bf16 v[48:51], a[192:195], v[116:119], v[48:51]
    s_add_u32 s56, s68, 288768
    buffer_load_dwordx4 v[84:87], v4, s[8:11], s56 offen offset:0 sc1
    v_mfma_f32_16x16x32_bf16 v[52:55], a[196:199], v[116:119], v[52:55]
    v_mfma_f32_16x16x32_bf16 v[56:59], a[200:203], v[116:119], v[56:59]
    v_mfma_f32_16x16x32_bf16 v[60:63], a[204:207], v[116:119], v[60:63]
    s_waitcnt vmcnt(7)
    v_mfma_f32_16x16x32_bf16 v[64:67], a[16:19], v[120:123], v[64:67]
    s_add_u32 s56, s69, 262144
    buffer_load_dwordx4 v[88:91], v4, s[8:11], s56 offen offset:0 sc1
    v_mfma_f32_16x16x32_bf16 v[68:71], a[20:23], v[120:123], v[68:71]
    v_mfma_f32_16x16x32_bf16 v[72:75], a[24:27], v[120:123], v[72:75]
    v_mfma_f32_16x16x32_bf16 v[76:79], a[28:31], v[120:123], v[76:79]
    s_waitcnt vmcnt(7)
    v_mfma_f32_16x16x32_bf16 v[64:67], a[80:83], v[124:127], v[64:67]
    s_add_u32 s56, s69, 274432
    buffer_load_dwordx4 v[92:95], v4, s[8:11], s56 offen offset:0 sc1
    v_mfma_f32_16x16x32_bf16 v[68:71], a[84:87], v[124:127], v[68:71]
    v_mfma_f32_16x16x32_bf16 v[72:75], a[88:91], v[124:127], v[72:75]
    v_mfma_f32_16x16x32_bf16 v[76:79], a[92:95], v[124:127], v[76:79]
    s_waitcnt vmcnt(7)
    v_mfma_f32_16x16x32_bf16 v[64:67], a[128:131], v[128:131], v[64:67]
    buffer_load_dwordx4 v[96:99], v4, s[8:11], s56 offen offset:2048 sc1
    v_mfma_f32_16x16x32_bf16 v[68:71], a[132:135], v[128:131], v[68:71]
    v_mfma_f32_16x16x32_bf16 v[72:75], a[136:139], v[128:131], v[72:75]
    v_mfma_f32_16x16x32_bf16 v[76:79], a[140:143], v[128:131], v[76:79]
    s_waitcnt vmcnt(7)
    v_mfma_f32_16x16x32_bf16 v[64:67], a[192:195], v[132:135], v[64:67]
    s_add_u32 s56, s69, 288768
    buffer_load_dwordx4 v[100:103], v4, s[8:11], s56 offen offset:0 sc1
    v_mfma_f32_16x16x32_bf16 v[68:71], a[196:199], v[132:135], v[68:71]
    v_mfma_f32_16x16x32_bf16 v[72:75], a[200:203], v[132:135], v[72:75]
    v_mfma_f32_16x16x32_bf16 v[76:79], a[204:207], v[132:135], v[76:79]
    s_waitcnt vmcnt(7)
    v_mfma_f32_16x16x32_bf16 v[32:35], a[0:3], v[136:139], v[32:35]
    s_add_u32 s56, s70, 262144
    buffer_load_dwordx4 v[104:107], v4, s[8:11], s56 offen offset:0 sc1
    v_mfma_f32_16x16x32_bf16 v[36:39], a[4:7], v[136:139], v[36:39]
    v_mfma_f32_16x16x32_bf16 v[40:43], a[8:11], v[136:139], v[40:43]
    v_mfma_f32_16x16x32_bf16 v[44:47], a[12:15], v[136:139], v[44:47]
    s_waitcnt vmcnt(7)
    v_mfma_f32_16x16x32_bf16 v[32:35], a[96:99], v[140:143], v[32:35]
    s_add_u32 s56, s70, 274432
    buffer_load_dwordx4 v[108:111], v4, s[8:11], s56 offen offset:0 sc1
    v_mfma_f32_16x16x32_bf16 v[36:39], a[100:103], v[140:143], v[36:39]
    v_mfma_f32_16x16x32_bf16 v[40:43], a[104:107], v[140:143], v[40:43]
    v_mfma_f32_16x16x32_bf16 v[44:47], a[108:111], v[140:143], v[44:47]
    s_waitcnt vmcnt(7)
    v_mfma_f32_16x16x32_bf16 v[32:35], a[112:115], v[80:83], v[32:35]
    buffer_load_dwordx4 v[112:115], v4, s[8:11], s56 offen offset:2048 sc1
    v_mfma_f32_16x16x32_bf16 v[36:39], a[116:119], v[80:83], v[36:39]
    v_mfma_f32_16x16x32_bf16 v[40:43], a[120:123], v[80:83], v[40:43]
    v_mfma_f32_16x16x32_bf16 v[44:47], a[124:127], v[80:83], v[44:47]
    s_waitcnt vmcnt(7)
    v_mfma_f32_16x16x32_bf16 v[32:35], a[208:211], v[84:87], v[32:35]
    s_add_u32 s56, s70, 288768
    buffer_load_dwordx4 v[116:119], v4, s[8:11], s56 offen offset:0 sc1
    v_mfma_f32_16x16x32_bf16 v[36:39], a[212:215], v[84:87], v[36:39]
    v_mfma_f32_16x16x32_bf16 v[40:43], a[216:219], v[84:87], v[40:43]
    v_mfma_f32_16x16x32_bf16 v[44:47], a[220:223], v[84:87], v[44:47]
    s_waitcnt vmcnt(7)
    v_mfma_f32_16x16x32_bf16 v[48:51], a[0:3], v[88:91], v[48:51]
    s_add_u32 s56, s71, 262144
    buffer_load_dwordx4 v[120:123], v4, s[8:11], s56 offen offset:0 sc1
    v_mfma_f32_16x16x32_bf16 v[52:55], a[4:7], v[88:91], v[52:55]
    ds_write_b128 v16, v[32:35] offset:49152
    v_mfma_f32_16x16x32_bf16 v[56:59], a[8:11], v[88:91], v[56:59]
    v_mfma_f32_16x16x32_bf16 v[60:63], a[12:15], v[88:91], v[60:63]
    s_waitcnt vmcnt(7)
    v_mfma_f32_16x16x32_bf16 v[48:51], a[96:99], v[92:95], v[48:51]
    buffer_load_dwordx4 v[124:127], v4, s[8:11], s56 offen offset:2048 sc1
    v_mfma_f32_16x16x32_bf16 v[52:55], a[100:103], v[92:95], v[52:55]
    ds_write_b128 v16, v[36:39] offset:50176
    v_mfma_f32_16x16x32_bf16 v[56:59], a[104:107], v[92:95], v[56:59]
    v_mfma_f32_16x16x32_bf16 v[60:63], a[108:111], v[92:95], v[60:63]
    s_waitcnt vmcnt(7)
    v_mfma_f32_16x16x32_bf16 v[48:51], a[112:115], v[96:99], v[48:51]
    s_add_u32 s56, s71, 266240
    buffer_load_dwordx4 v[128:131], v4, s[8:11], s56 offen offset:0 sc1
    v_mfma_f32_16x16x32_bf16 v[52:55], a[116:119], v[96:99], v[52:55]
    ds_write_b128 v16, v[40:43] offset:51200
    v_mfma_f32_16x16x32_bf16 v[56:59], a[120:123], v[96:99], v[56:59]
    v_mfma_f32_16x16x32_bf16 v[60:63], a[124:127], v[96:99], v[60:63]
    s_waitcnt vmcnt(7)
    v_mfma_f32_16x16x32_bf16 v[48:51], a[208:211], v[100:103], v[48:51]
    buffer_load_dwordx4 v[132:135], v4, s[8:11], s56 offen offset:2048 sc1
    v_mfma_f32_16x16x32_bf16 v[52:55], a[212:215], v[100:103], v[52:55]
    ds_write_b128 v16, v[44:47] offset:52224
    v_mfma_f32_16x16x32_bf16 v[56:59], a[216:219], v[100:103], v[56:59]
    v_mfma_f32_16x16x32_bf16 v[60:63], a[220:223], v[100:103], v[60:63]
    s_waitcnt vmcnt(7)
    v_mfma_f32_16x16x32_bf16 v[64:67], a[0:3], v[104:107], v[64:67]
    s_add_u32 s56, s71, 270336
    buffer_load_dwordx4 v[136:139], v4, s[8:11], s56 offen offset:0 sc1
    v_mfma_f32_16x16x32_bf16 v[68:71], a[4:7], v[104:107], v[68:71]
    ds_write_b128 v17, v[48:51] offset:49152
    v_mfma_f32_16x16x32_bf16 v[72:75], a[8:11], v[104:107], v[72:75]
    v_mfma_f32_16x16x32_bf16 v[76:79], a[12:15], v[104:107], v[76:79]
    s_waitcnt vmcnt(7)
    v_mfma_f32_16x16x32_bf16 v[64:67], a[96:99], v[108:111], v[64:67]
    buffer_load_dwordx4 v[140:143], v4, s[8:11], s56 offen offset:2048 sc1
    v_mfma_f32_16x16x32_bf16 v[68:71], a[100:103], v[108:111], v[68:71]
    ds_write_b128 v17, v[52:55] offset:50176
    v_mfma_f32_16x16x32_bf16 v[72:75], a[104:107], v[108:111], v[72:75]
    v_mfma_f32_16x16x32_bf16 v[76:79], a[108:111], v[108:111], v[76:79]
    s_waitcnt vmcnt(7)
    v_mfma_f32_16x16x32_bf16 v[64:67], a[112:115], v[112:115], v[64:67]
    s_add_u32 s56, s71, 274432
    buffer_load_dwordx4 v[80:83], v4, s[8:11], s56 offen offset:0 sc1
    v_mfma_f32_16x16x32_bf16 v[68:71], a[116:119], v[112:115], v[68:71]
    ds_write_b128 v17, v[56:59] offset:51200
    v_mfma_f32_16x16x32_bf16 v[72:75], a[120:123], v[112:115], v[72:75]
    v_mfma_f32_16x16x32_bf16 v[76:79], a[124:127], v[112:115], v[76:79]
    s_waitcnt vmcnt(7)
    v_mfma_f32_16x16x32_bf16 v[64:67], a[208:211], v[116:119], v[64:67]
    buffer_load_dwordx4 v[84:87], v4, s[8:11], s56 offen offset:2048 sc1
    v_mfma_f32_16x16x32_bf16 v[68:71], a[212:215], v[116:119], v[68:71]
    ds_write_b128 v17, v[60:63] offset:52224
    v_mfma_f32_16x16x32_bf16 v[72:75], a[216:219], v[116:119], v[72:75]
    v_mfma_f32_16x16x32_bf16 v[76:79], a[220:223], v[116:119], v[76:79]
    s_waitcnt vmcnt(7)
    v_mfma_f32_16x16x32_bf16 v[144:147], a[0:3], v[120:123], 0
    s_add_u32 s56, s71, 278528
    buffer_load_dwordx4 v[88:91], v4, s[8:11], s56 offen offset:0 sc1
    v_mfma_f32_16x16x32_bf16 v[148:151], a[4:7], v[120:123], 0
    ds_write_b128 v18, v[64:67] offset:49152
    v_mfma_f32_16x16x32_bf16 v[152:155], a[8:11], v[120:123], 0
    v_mfma_f32_16x16x32_bf16 v[156:159], a[12:15], v[120:123], 0
    s_waitcnt vmcnt(7)
    v_mfma_f32_16x16x32_bf16 v[144:147], a[16:19], v[124:127], v[144:147]
    buffer_load_dwordx4 v[92:95], v4, s[8:11], s56 offen offset:2048 sc1
    v_mfma_f32_16x16x32_bf16 v[148:151], a[20:23], v[124:127], v[148:151]
    ds_write_b128 v18, v[68:71] offset:50176
    v_mfma_f32_16x16x32_bf16 v[152:155], a[24:27], v[124:127], v[152:155]
    v_mfma_f32_16x16x32_bf16 v[156:159], a[28:31], v[124:127], v[156:159]
    s_waitcnt vmcnt(7)
    v_mfma_f32_16x16x32_bf16 v[144:147], a[32:35], v[128:131], v[144:147]
    s_add_u32 s56, s71, 282624
    buffer_load_dwordx4 v[96:99], v4, s[8:11], s56 offen offset:0 sc1
    v_mfma_f32_16x16x32_bf16 v[148:151], a[36:39], v[128:131], v[148:151]
    ds_write_b128 v18, v[72:75] offset:51200
    v_mfma_f32_16x16x32_bf16 v[152:155], a[40:43], v[128:131], v[152:155]
    v_mfma_f32_16x16x32_bf16 v[156:159], a[44:47], v[128:131], v[156:159]
    s_waitcnt vmcnt(7)
    v_mfma_f32_16x16x32_bf16 v[144:147], a[48:51], v[132:135], v[144:147]
    buffer_load_dwordx4 v[100:103], v4, s[8:11], s56 offen offset:2048 sc1
    v_mfma_f32_16x16x32_bf16 v[148:151], a[52:55], v[132:135], v[148:151]
    ds_write_b128 v18, v[76:79] offset:52224
    v_mfma_f32_16x16x32_bf16 v[152:155], a[56:59], v[132:135], v[152:155]
    v_mfma_f32_16x16x32_bf16 v[156:159], a[60:63], v[132:135], v[156:159]
    s_waitcnt vmcnt(7)
    v_mfma_f32_16x16x32_bf16 v[144:147], a[64:67], v[136:139], v[144:147]
    s_add_u32 s56, s71, 286720
    buffer_load_dwordx4 v[104:107], v4, s[8:11], s56 offen offset:0 sc1
    v_mfma_f32_16x16x32_bf16 v[148:151], a[68:71], v[136:139], v[148:151]
    v_mfma_f32_16x16x32_bf16 v[152:155], a[72:75], v[136:139], v[152:155]
    v_mfma_f32_16x16x32_bf16 v[156:159], a[76:79], v[136:139], v[156:159]
    s_waitcnt vmcnt(7)
    s_waitcnt lgkmcnt(0)
    v_mfma_f32_16x16x32_bf16 v[144:147], a[80:83], v[140:143], v[144:147]
    s_barrier
    v_mfma_f32_16x16x32_bf16 v[148:151], a[84:87], v[140:143], v[148:151]
    ds_read_b128 v[160:163], v19 offset:49152
    ds_read_b128 v[164:167], v19 offset:50176
    v_mfma_f32_16x16x32_bf16 v[152:155], a[88:91], v[140:143], v[152:155]
    buffer_load_dwordx4 v[108:111], v4, s[8:11], s56 offen offset:2048 sc1
    v_mfma_f32_16x16x32_bf16 v[156:159], a[92:95], v[140:143], v[156:159]
    s_waitcnt vmcnt(7)
    ds_read_b128 v[168:171], v19 offset:51200
    ds_read_b128 v[172:175], v19 offset:52224
    v_mfma_f32_16x16x32_bf16 v[144:147], a[96:99], v[80:83], v[144:147]
    ds_read_b128 v[176:179], v19 offset:53248
    ds_read_b128 v[180:183], v19 offset:54272
    v_mfma_f32_16x16x32_bf16 v[148:151], a[100:103], v[80:83], v[148:151]
    ds_read_b128 v[184:187], v19 offset:55296
    ds_read_b128 v[188:191], v19 offset:56320
    v_mfma_f32_16x16x32_bf16 v[152:155], a[104:107], v[80:83], v[152:155]
    ds_read_b128 v[192:195], v19 offset:57344
    ds_read_b128 v[196:199], v19 offset:58368
    v_mfma_f32_16x16x32_bf16 v[156:159], a[108:111], v[80:83], v[156:159]
    s_waitcnt vmcnt(6)
    ds_read_b128 v[200:203], v19 offset:59392
    ds_read_b128 v[204:207], v19 offset:60416
    v_mfma_f32_16x16x32_bf16 v[144:147], a[112:115], v[84:87], v[144:147]
    s_waitcnt lgkmcnt(4)
    v_add_f32 v160, v160, v176
    v_add_f32 v161, v161, v177
    v_mfma_f32_16x16x32_bf16 v[148:151], a[116:119], v[84:87], v[148:151]
    v_add_f32 v162, v162, v178
    v_add_f32 v163, v163, v179
    v_mfma_f32_16x16x32_bf16 v[152:155], a[120:123], v[84:87], v[152:155]
    v_add_f32 v164, v164, v180
    v_add_f32 v165, v165, v181
    v_mfma_f32_16x16x32_bf16 v[156:159], a[124:127], v[84:87], v[156:159]
    s_waitcnt vmcnt(5)
    v_add_f32 v166, v166, v182
    v_add_f32 v167, v167, v183
    v_mfma_f32_16x16x32_bf16 v[144:147], a[128:131], v[88:91], v[144:147]
    v_add_f32 v168, v168, v184
    v_add_f32 v169, v169, v185
    v_mfma_f32_16x16x32_bf16 v[148:151], a[132:135], v[88:91], v[148:151]
    v_add_f32 v170, v170, v186
    v_add_f32 v171, v171, v187
    v_mfma_f32_16x16x32_bf16 v[152:155], a[136:139], v[88:91], v[152:155]
    v_add_f32 v172, v172, v188
    v_add_f32 v173, v173, v189
    v_mfma_f32_16x16x32_bf16 v[156:159], a[140:143], v[88:91], v[156:159]
    s_waitcnt vmcnt(4)
    v_add_f32 v174, v174, v190
    v_add_f32 v175, v175, v191
    v_mfma_f32_16x16x32_bf16 v[144:147], a[144:147], v[92:95], v[144:147]
    s_waitcnt lgkmcnt(0)
    v_add_f32 v160, v160, v192
    v_add_f32 v161, v161, v193
    v_mfma_f32_16x16x32_bf16 v[148:151], a[148:151], v[92:95], v[148:151]
    v_add_f32 v162, v162, v194
    v_add_f32 v163, v163, v195
    v_mfma_f32_16x16x32_bf16 v[152:155], a[152:155], v[92:95], v[152:155]
    v_add_f32 v164, v164, v196
    v_mfma_f32_16x16x32_bf16 v[156:159], a[156:159], v[92:95], v[156:159]
    s_waitcnt vmcnt(3)
    v_add_f32 v165, v165, v197
    v_add_f32 v166, v166, v198
    v_mfma_f32_16x16x32_bf16 v[144:147], a[160:163], v[96:99], v[144:147]
    v_add_f32 v167, v167, v199
    v_add_f32 v168, v168, v200
    v_mfma_f32_16x16x32_bf16 v[148:151], a[164:167], v[96:99], v[148:151]
    v_add_f32 v169, v169, v201
    v_add_f32 v170, v170, v202
    v_mfma_f32_16x16x32_bf16 v[152:155], a[168:171], v[96:99], v[152:155]
    v_add_f32 v171, v171, v203
    v_add_f32 v172, v172, v204
    v_mfma_f32_16x16x32_bf16 v[156:159], a[172:175], v[96:99], v[156:159]
    s_waitcnt vmcnt(2)
    v_add_f32 v173, v173, v205
    v_mfma_f32_16x16x32_bf16 v[144:147], a[176:179], v[100:103], v[144:147]
    v_add_f32 v174, v174, v206
    v_add_f32 v175, v175, v207
    v_mfma_f32_16x16x32_bf16 v[148:151], a[180:183], v[100:103], v[148:151]
    v_fma_f32 v208, v160, v20, v208
    v_fma_f32 v209, v161, v20, v209
    v_mfma_f32_16x16x32_bf16 v[152:155], a[184:187], v[100:103], v[152:155]
    v_fma_f32 v210, v162, v20, v210
    v_fma_f32 v211, v163, v20, v211
    v_mfma_f32_16x16x32_bf16 v[156:159], a[188:191], v[100:103], v[156:159]
    s_waitcnt vmcnt(1)
    v_fma_f32 v212, v164, v20, v212
    v_fma_f32 v213, v165, v20, v213
    v_mfma_f32_16x16x32_bf16 v[144:147], a[192:195], v[104:107], v[144:147]
    v_fma_f32 v214, v166, v20, v214
    v_mfma_f32_16x16x32_bf16 v[148:151], a[196:199], v[104:107], v[148:151]
    v_fma_f32 v215, v167, v20, v215
    v_fma_f32 v216, v168, v20, v216
    v_mfma_f32_16x16x32_bf16 v[152:155], a[200:203], v[104:107], v[152:155]
    v_fma_f32 v217, v169, v20, v217
    v_fma_f32 v218, v170, v20, v218
    v_mfma_f32_16x16x32_bf16 v[156:159], a[204:207], v[104:107], v[156:159]
    s_waitcnt vmcnt(0)
    v_fma_f32 v219, v171, v20, v219
    v_fma_f32 v220, v172, v20, v220
    v_mfma_f32_16x16x32_bf16 v[144:147], a[208:211], v[108:111], v[144:147]
    v_fma_f32 v221, v173, v20, v221
    v_fma_f32 v222, v174, v20, v222
    v_mfma_f32_16x16x32_bf16 v[148:151], a[212:215], v[108:111], v[148:151]
    v_fma_f32 v223, v175, v20, v223
    v_mfma_f32_16x16x32_bf16 v[152:155], a[216:219], v[108:111], v[152:155]
    v_mfma_f32_16x16x32_bf16 v[156:159], a[220:223], v[108:111], v[156:159]
    s_nop 1
    v_pk_fma_f32 v[144:145], v[144:145], v[20:21], v[208:209] op_sel_hi:[1,0,1]
    v_pk_fma_f32 v[146:147], v[146:147], v[20:21], v[210:211] op_sel_hi:[1,0,1]
    s_nop 0
    v_pk_fma_f32 v[148:149], v[148:149], v[20:21], v[212:213] op_sel_hi:[1,0,1]
    v_pk_fma_f32 v[150:151], v[150:151], v[20:21], v[214:215] op_sel_hi:[1,0,1]
    v_pk_fma_f32 v[152:153], v[152:153], v[20:21], v[216:217] op_sel_hi:[1,0,1]
    v_pk_fma_f32 v[154:155], v[154:155], v[20:21], v[218:219] op_sel_hi:[1,0,1]
    v_pk_fma_f32 v[156:157], v[156:157], v[20:21], v[220:221] op_sel_hi:[1,0,1]
    v_pk_fma_f32 v[158:159], v[158:159], v[20:21], v[222:223] op_sel_hi:[1,0,1]
    v_cvt_pk_bf16_f32 v8, v144, v145
    v_cvt_pk_bf16_f32 v9, v146, v147
    v_cvt_pk_bf16_f32 v10, v148, v149
    v_cvt_pk_bf16_f32 v11, v150, v151
    v_cvt_pk_bf16_f32 v12, v152, v153
    v_cvt_pk_bf16_f32 v13, v154, v155
    v_cvt_pk_bf16_f32 v14, v156, v157
    v_cvt_pk_bf16_f32 v15, v158, v159
    v_accvgpr_read_b32 v16, a224
    s_mov_b32 vcc_lo, 0x55555555
    s_mov_b32 vcc_hi, 0x55555555
    v_cndmask_b32_dpp v224, v12, v8, vcc quad_perm:[1,0,3,2] row_mask:0xf bank_mask:0xf
    v_cndmask_b32_dpp v225, v13, v9, vcc quad_perm:[1,0,3,2] row_mask:0xf bank_mask:0xf
    v_cndmask_b32_dpp v226, v14, v10, vcc quad_perm:[1,0,3,2] row_mask:0xf bank_mask:0xf
    v_cndmask_b32_dpp v227, v15, v11, vcc quad_perm:[1,0,3,2] row_mask:0xf bank_mask:0xf
    s_not_b64 vcc, vcc
    v_cndmask_b32_dpp v228, v8, v12, vcc quad_perm:[1,0,3,2] row_mask:0xf bank_mask:0xf
    v_cndmask_b32_dpp v229, v9, v13, vcc quad_perm:[1,0,3,2] row_mask:0xf bank_mask:0xf
    v_cndmask_b32_dpp v230, v10, v14, vcc quad_perm:[1,0,3,2] row_mask:0xf bank_mask:0xf
    v_cndmask_b32_dpp v231, v11, v15, vcc quad_perm:[1,0,3,2] row_mask:0xf bank_mask:0xf
    buffer_store_dwordx4 v[224:227], v16, s[16:19], 0 offen offset:0 nt
    buffer_store_dwordx4 v[228:231], v16, s[16:19], 0 offen offset:2048 nt
L_main_done:
    s_endpgm
L_xspin_1:
    s_mov_b32 s63, 0x40000
L_xspin_1_l:
    buffer_load_dword v31, v241, s[8:11], 0 offen sc1
    s_sub_u32 s63, s63, 1
    s_cbranch_scc1 L_main_done
    s_waitcnt vmcnt(0)
    v_xor_b32 v29, s26, v31
    v_cmp_lt_u32 vcc, 15, v29
    s_nop 0
    s_and_b64 vcc, vcc, exec
    s_cbranch_scc1 L_xspin_1_l
    s_branch L_xback_2
L_halo_5:
    v_mov_b32 v27, v26
    v_accvgpr_read_b32 v24, a232
    v_accvgpr_read_b32 v25, a233
    s_add_u32 s59, s51, 729088
    v_permlane32_swap_b32 v26, v27
    buffer_store_dwordx2 v[26:27], v25, s[8:11], s59 offen sc1
    s_waitcnt vmcnt(10)
    s_branch L_hback_6
L_slow_3:
    buffer_wbl2 sc1
    s_waitcnt vmcnt(0)
    buffer_store_dword v30, v5, s[8:11], s45 offen sc1
    s_branch L_sig_4
L_halo_7:
    s_add_u32 s59, s52, 0
    v_mov_b32 v24, s26
    v_accvgpr_read_b32 v25, a235
    s_waitcnt vmcnt(1)
    buffer_store_dword v24, v25, s[8:11], s59 offen sc1
    s_branch L_hback_8
L_lspin_9:
    s_mov_b32 s63, 0x40000
L_lspin_9_l:
    buffer_load_dword v23, v243, s[8:11], 0 offen sc1
    s_sub_u32 s63, s63, 1
    s_cbranch_scc1 L_main_done
    s_waitcnt vmcnt(0)
    v_cmp_ne_u32 vcc, s26, v23
    s_nop 0
    s_and_b64 vcc, vcc, exec
    s_cbranch_scc1 L_lspin_9_l
    s_branch L_lback_10
L_cspin_11:
    s_mov_b32 s63, 0x40000
    s_cmp_lg_u32 s27, 0
    s_cbranch_scc1 L_cspin_11_f
L_cspin_11_n:
    buffer_load_dword v22, v6, s[8:11], s44 offen nt
    s_sub_u32 s63, s63, 1
    s_cbranch_scc1 L_main_done
    s_waitcnt vmcnt(0)
    v_subrev_u32 v22, s3, v22
    v_cmp_lt_u32 vcc, 15, v22
    s_nop 0
    s_and_b64 vcc, vcc, s[40:41]
    s_cbranch_scc1 L_cspin_11_n
    s_branch L_cback_12
L_cspin_11_f:
    buffer_load_dword v22, v6, s[8:11], s44 offen sc1
    s_sub_u32 s63, s63, 1
    s_cbranch_scc1 L_main_done
    s_waitcnt vmcnt(0)
    v_subrev_u32 v22, s3, v22
    v_cmp_lt_u32 vcc, 15, v22
    s_nop 0
    s_and_b64 vcc, vcc, s[40:41]
    s_cbranch_scc1 L_cspin_11_f
    buffer_inv sc1
    s_waitcnt vmcnt(0)
    s_branch L_cback_12
L_lspin_14:
    s_mov_b32 s63, 0x40000
L_lspin_14_l:
    buffer_load_dword v19, v28, s[8:11], s61 offen sc1
    s_sub_u32 s63, s63, 1
    s_cbranch_scc1 L_main_done
    s_waitcnt vmcnt(0)
    v_cmp_ne_u32 vcc, s26, v19
    s_nop 0
    s_and_b64 vcc, vcc, s[54:55]
    s_cbranch_scc1 L_lspin_14_l
    s_branch L_lback_15
L_lspin_16:
    s_mov_b32 s63, 0x40000
L_lspin_16_l:
    v_accvgpr_read_b32 v63, a234
    buffer_load_dword v63, v63, s[8:11], 0 offen sc1
    s_sub_u32 s63, s63, 1
    s_cbranch_scc1 L_main_done
    s_waitcnt vmcnt(0)
    v_cmp_ne_u32 vcc, s26, v63
    s_nop 0
    s_and_b64 vcc, vcc, exec
    s_cbranch_scc1 L_lspin_16_l
    s_branch L_lback_17
L_slow_18:
    buffer_wbl2 sc1
    s_waitcnt vmcnt(0)
    buffer_store_dword v30, v5, s[8:11], s45 offen sc1
    s_branch L_sig_19
L_far_20:
    buffer_load_dword v22, v6, s[8:11], s44 offen sc1
    s_sub_u32 s63, s63, 1
    s_cbranch_scc1 L_main_done
    s_waitcnt vmcnt(0)
    v_subrev_u32 v22, s12, v22
    v_cmp_lt_u32 vcc, 15, v22
    s_nop 0
    s_and_b64 vcc, vcc, s[66:67]
    s_cbranch_scc1 L_far_20
    buffer_inv sc1
    s_waitcnt vmcnt(0)
    s_branch L_ok_21
L_slow_23:
    buffer_wbl2 sc1
    s_waitcnt vmcnt(0)
    buffer_store_dword v30, v5, s[8:11], s45 offen sc1
    s_branch L_sig_24
L_far_26:
    buffer_load_dword v22, v6, s[8:11], s44 offen sc1
    s_sub_u32 s63, s63, 1
    s_cbranch_scc1 L_main_done
    s_waitcnt vmcnt(0)
    v_subrev_u32 v22, s12, v22
    v_cmp_lt_u32 vcc, 15, v22
    s_nop 0
    s_and_b64 vcc, vcc, s[40:41]
    s_cbranch_scc1 L_far_26
    buffer_inv sc1
    s_waitcnt vmcnt(0)
    s_branch L_ok_27
L_cspin_29:
    s_mov_b32 s63, 0x40000
    s_cmp_lg_u32 s27, 0
    s_cbranch_scc1 L_cspin_29_f
L_cspin_29_n:
    buffer_load_dword v19, v6, s[8:11], s44 offen nt
    s_sub_u32 s63, s63, 1
    s_cbranch_scc1 L_main_done
    s_waitcnt vmcnt(0)
    v_subrev_u32 v19, s3, v19
    v_cmp_lt_u32 vcc, 15, v19
    s_nop 0
    s_and_b64 vcc, vcc, s[42:43]
    s_cbranch_scc1 L_cspin_29_n
    s_branch L_cback_30
L_cspin_29_f:
    buffer_load_dword v19, v6, s[8:11], s44 offen sc1
    s_sub_u32 s63, s63, 1
    s_cbranch_scc1 L_main_done
    s_waitcnt vmcnt(0)
    v_subrev_u32 v19, s3, v19
    v_cmp_lt_u32 vcc, 15, v19
    s_nop 0
    s_and_b64 vcc, vcc, s[42:43]
    s_cbranch_scc1 L_cspin_29_f
    buffer_inv sc1
    s_waitcnt vmcnt(0)
    s_branch L_cback_30
L_slow_31:
    buffer_wbl2 sc1
    s_waitcnt vmcnt(0)
    buffer_store_dword v20, v5, s[8:11], s45 offen sc1
    s_branch L_sig_32
L_slow_33:
    buffer_wbl2 sc1
    s_waitcnt vmcnt(0)
    buffer_store_dword v20, v5, s[8:11], s45 offen sc1
    s_branch L_sig_34
L_cspin_35:
    s_mov_b32 s63, 0x40000
    s_cmp_lg_u32 s27, 0
    s_cbranch_scc1 L_cspin_35_f
L_cspin_35_n:
    buffer_load_dword v22, v6, s[8:11], s44 offen nt
    s_sub_u32 s63, s63, 1
    s_cbranch_scc1 L_main_done
    s_waitcnt vmcnt(0)
    v_subrev_u32 v22, s3, v22
    v_cmp_lt_u32 vcc, 15, v22
    s_nop 0
    s_and_b64 vcc, vcc, s[42:43]
    s_cbranch_scc1 L_cspin_35_n
    s_branch L_cback_36
L_cspin_35_f:
    buffer_load_dword v22, v6, s[8:11], s44 offen sc1
    s_sub_u32 s63, s63, 1
    s_cbranch_scc1 L_main_done
    s_waitcnt vmcnt(0)
    v_subrev_u32 v22, s3, v22
    v_cmp_lt_u32 vcc, 15, v22
    s_nop 0
    s_and_b64 vcc, vcc, s[42:43]
    s_cbranch_scc1 L_cspin_35_f
    buffer_inv sc1
    s_waitcnt vmcnt(0)
    s_branch L_cback_36
L_cspin_37:
    s_mov_b32 s63, 0x40000
    s_cmp_lg_u32 s27, 0
    s_cbranch_scc1 L_cspin_37_f
L_cspin_37_n:
    buffer_load_dword v22, v6, s[8:11], s44 offen nt
    s_sub_u32 s63, s63, 1
    s_cbranch_scc1 L_main_done
    s_waitcnt vmcnt(0)
    v_subrev_u32 v22, s3, v22
    v_cmp_lt_u32 vcc, 15, v22
    s_nop 0
    s_and_b64 vcc, vcc, s[42:43]
    s_cbranch_scc1 L_cspin_37_n
    s_branch L_cback_38
L_cspin_37_f:
    buffer_load_dword v22, v6, s[8:11], s44 offen sc1
    s_sub_u32 s63, s63, 1
    s_cbranch_scc1 L_main_done
    s_waitcnt vmcnt(0)
    v_subrev_u32 v22, s3, v22
    v_cmp_lt_u32 vcc, 15, v22
    s_nop 0
    s_and_b64 vcc, vcc, s[42:43]
    s_cbranch_scc1 L_cspin_37_f
    buffer_inv sc1
    s_waitcnt vmcnt(0)
    s_branch L_cback_38
L_slow_39:
    buffer_wbl2 sc1
    s_waitcnt vmcnt(0)
    buffer_store_dword v23, v5, s[8:11], s45 offen sc1
    s_branch L_sig_40
L_halo_43:
    v_mov_b32 v27, v26
    v_accvgpr_read_b32 v24, a232
    v_accvgpr_read_b32 v25, a233
    s_add_u32 s59, s51, 745472
    buffer_store_dwordx4 v[8:11], v24, s[8:11], s59 offen offset:0 sc1
    buffer_store_dwordx4 v[12:15], v24, s[8:11], s59 offen offset:512 sc1
    v_permlane32_swap_b32 v26, v27
    buffer_store_dwordx2 v[26:27], v25, s[8:11], s59 offen sc1
    s_waitcnt vmcnt(5)
    s_branch L_hback_44
L_slow_41:
    buffer_wbl2 sc1
    s_waitcnt vmcnt(0)
    buffer_store_dword v30, v5, s[8:11], s45 offen sc1
    s_branch L_sig_42
L_halo_45:
    s_add_u32 s59, s52, 16384
    v_mov_b32 v24, s26
    v_accvgpr_read_b32 v25, a235
    s_waitcnt vmcnt(1)
    buffer_store_dword v24, v25, s[8:11], s59 offen sc1
    s_branch L_hback_46
L_far_48:
    buffer_load_dword v22, v6, s[8:11], s44 offen sc1
    s_sub_u32 s63, s63, 1
    s_cbranch_scc1 L_main_done
    s_waitcnt vmcnt(0)
    v_subrev_u32 v22, s12, v22
    v_cmp_lt_u32 vcc, 15, v22
    s_nop 0
    s_and_b64 vcc, vcc, s[40:41]
    s_cbranch_scc1 L_far_48
    buffer_inv sc1
    s_waitcnt vmcnt(0)
    s_branch L_ok_49
L_lspin_51:
    s_mov_b32 s63, 0x40000
L_lspin_51_l:
    buffer_load_dword v19, v28, s[8:11], s61 offen sc1
    s_sub_u32 s63, s63, 1
    s_cbranch_scc1 L_main_done
    s_waitcnt vmcnt(0)
    v_cmp_ne_u32 vcc, s26, v19
    s_nop 0
    s_and_b64 vcc, vcc, s[54:55]
    s_cbranch_scc1 L_lspin_51_l
    s_branch L_lback_52
L_slow_53:
    buffer_wbl2 sc1
    s_waitcnt vmcnt(0)
    buffer_store_dword v30, v5, s[8:11], s45 offen sc1
    s_branch L_sig_54
L_far_55:
    buffer_load_dword v22, v6, s[8:11], s44 offen sc1
    s_sub_u32 s63, s63, 1
    s_cbranch_scc1 L_main_done
    s_waitcnt vmcnt(0)
    v_subrev_u32 v22, s12, v22
    v_cmp_lt_u32 vcc, 15, v22
    s_nop 0
    s_and_b64 vcc, vcc, s[66:67]
    s_cbranch_scc1 L_far_55
    buffer_inv sc1
    s_waitcnt vmcnt(0)
    s_branch L_ok_56
L_slow_58:
    buffer_wbl2 sc1
    s_waitcnt vmcnt(0)
    buffer_store_dword v30, v5, s[8:11], s45 offen sc1
    s_branch L_sig_59
L_far_61:
    buffer_load_dword v22, v6, s[8:11], s44 offen sc1
    s_sub_u32 s63, s63, 1
    s_cbranch_scc1 L_main_done
    s_waitcnt vmcnt(0)
    v_subrev_u32 v22, s12, v22
    v_cmp_lt_u32 vcc, 15, v22
    s_nop 0
    s_and_b64 vcc, vcc, s[40:41]
    s_cbranch_scc1 L_far_61
    buffer_inv sc1
    s_waitcnt vmcnt(0)
    s_branch L_ok_62
L_cspin_64:
    s_mov_b32 s63, 0x40000
    s_cmp_lg_u32 s27, 0
    s_cbranch_scc1 L_cspin_64_f
L_cspin_64_n:
    buffer_load_dword v19, v6, s[8:11], s44 offen nt
    s_sub_u32 s63, s63, 1
    s_cbranch_scc1 L_main_done
    s_waitcnt vmcnt(0)
    v_subrev_u32 v19, s3, v19
    v_cmp_lt_u32 vcc, 15, v19
    s_nop 0
    s_and_b64 vcc, vcc, s[42:43]
    s_cbranch_scc1 L_cspin_64_n
    s_branch L_cback_65
L_cspin_64_f:
    buffer_load_dword v19, v6, s[8:11], s44 offen sc1
    s_sub_u32 s63, s63, 1
    s_cbranch_scc1 L_main_done
    s_waitcnt vmcnt(0)
    v_subrev_u32 v19, s3, v19
    v_cmp_lt_u32 vcc, 15, v19
    s_nop 0
    s_and_b64 vcc, vcc, s[42:43]
    s_cbranch_scc1 L_cspin_64_f
    buffer_inv sc1
    s_waitcnt vmcnt(0)
    s_branch L_cback_65
L_slow_66:
    buffer_wbl2 sc1
    s_waitcnt vmcnt(0)
    buffer_store_dword v20, v5, s[8:11], s45 offen sc1
    s_branch L_sig_67
L_slow_68:
    buffer_wbl2 sc1
    s_waitcnt vmcnt(0)
    buffer_store_dword v20, v5, s[8:11], s45 offen sc1
    s_branch L_sig_69
L_cspin_70:
    s_mov_b32 s63, 0x40000
    s_cmp_lg_u32 s27, 0
    s_cbranch_scc1 L_cspin_70_f
L_cspin_70_n:
    buffer_load_dword v22, v6, s[8:11], s44 offen nt
    s_sub_u32 s63, s63, 1
    s_cbranch_scc1 L_main_done
    s_waitcnt vmcnt(0)
    v_subrev_u32 v22, s3, v22
    v_cmp_lt_u32 vcc, 15, v22
    s_nop 0
    s_and_b64 vcc, vcc, s[42:43]
    s_cbranch_scc1 L_cspin_70_n
    s_branch L_cback_71
L_cspin_70_f:
    buffer_load_dword v22, v6, s[8:11], s44 offen sc1
    s_sub_u32 s63, s63, 1
    s_cbranch_scc1 L_main_done
    s_waitcnt vmcnt(0)
    v_subrev_u32 v22, s3, v22
    v_cmp_lt_u32 vcc, 15, v22
    s_nop 0
    s_and_b64 vcc, vcc, s[42:43]
    s_cbranch_scc1 L_cspin_70_f
    buffer_inv sc1
    s_waitcnt vmcnt(0)
    s_branch L_cback_71
L_cspin_72:
    s_mov_b32 s63, 0x40000
    s_cmp_lg_u32 s27, 0
    s_cbranch_scc1 L_cspin_72_f
L_cspin_72_n:
    buffer_load_dword v22, v6, s[8:11], s44 offen nt
    s_sub_u32 s63, s63, 1
    s_cbranch_scc1 L_main_done
    s_waitcnt vmcnt(0)
    v_subrev_u32 v22, s3, v22
    v_cmp_lt_u32 vcc, 15, v22
    s_nop 0
    s_and_b64 vcc, vcc, s[42:43]
    s_cbranch_scc1 L_cspin_72_n
    s_branch L_cback_73
L_cspin_72_f:
    buffer_load_dword v22, v6, s[8:11], s44 offen sc1
    s_sub_u32 s63, s63, 1
    s_cbranch_scc1 L_main_done
    s_waitcnt vmcnt(0)
    v_subrev_u32 v22, s3, v22
    v_cmp_lt_u32 vcc, 15, v22
    s_nop 0
    s_and_b64 vcc, vcc, s[42:43]
    s_cbranch_scc1 L_cspin_72_f
    buffer_inv sc1
    s_waitcnt vmcnt(0)
    s_branch L_cback_73
L_slow_74:
    buffer_wbl2 sc1
    s_waitcnt vmcnt(0)
    buffer_store_dword v23, v5, s[8:11], s45 offen sc1
    s_branch L_sig_75
L_code_end:
.section .rodata,"a"
.p2align 6
.amdhsa_kernel interleave_layers__sliding_local_dilated__glu_gated_reglu__prompt_kernel
  .amdhsa_next_free_vgpr 512
  .amdhsa_next_free_sgpr 102
  .amdhsa_accum_offset 256
  .amdhsa_group_segment_fixed_size 0
  .amdhsa_kernarg_size 80
  .amdhsa_user_sgpr_count 2
  .amdhsa_user_sgpr_kernarg_segment_ptr 1
  .amdhsa_system_sgpr_workgroup_id_x 1
  .amdhsa_float_denorm_mode_32 3
.end_amdhsa_kernel
```
